```python
import torch

def _softmax(x, axis=-1):
    return torch.softmax(x, dim=axis)
def _gelu(x):
    return torch.nn.functional.gelu(x, approximate="tanh")
def _silu(x):
    return torch.nn.functional.silu(x)
def _sigmoid(x):
    return torch.sigmoid(x)
def _layernorm(x, axis=-1, eps=1e-5):
    m = x.mean(dim=axis, keepdim=True)
    v = x.var(dim=axis, keepdim=True, unbiased=False)
    return (x - m) / torch.sqrt(v + eps)
def _scatter_add(tgt, idx, src, axis=0):
    return tgt.clone().index_add_(axis, idx, src)
def _segment_sum(src, seg, n):
    out = torch.zeros((n,) + src.shape[1:], dtype=src.dtype)
    return out.index_add_(0, seg, src)
def _pad(x, pw):
    flat = tuple(v for pair in reversed(pw) for v in pair)
    return torch.nn.functional.pad(x, flat)

kernel_name = 'interleave_layers__linear_attn_block__moe_arch_mod__prompt'

def setup_inputs():

    _w = (lambda a: (lambda t: t.to(torch.bfloat16) if t.is_floating_point() else t)(torch.as_tensor(a)))
    def _A_setup():
        B, S, D = 1, 2048, 1024
        return {
            "x": _w((lambda *s: torch.randn(*s, dtype=torch.bfloat16) * 0.05)(B, S, D)),
            "wqkv": _w((lambda *s: torch.randn(*s, dtype=torch.bfloat16) * 0.05)(D, 3 * D)),
            "wo": _w((lambda *s: torch.randn(*s, dtype=torch.bfloat16) * 0.05)(D, D)),
        }
    _A_in = _A_setup()

    def _B_setup():
        B, S, D, F, C = 1, 2048, 1024, 3584, 8
        return {
            "x": _w((lambda *s: torch.randn(*s, dtype=torch.bfloat16) * 0.05)(B, S, D)),
            "w_r": _w((lambda *s: torch.randn(*s, dtype=torch.bfloat16) * 0.05)(D)),
            "w_gate": _w((lambda *s: torch.randn(*s, dtype=torch.bfloat16) * 0.05)(D, F)),
            "w_up": _w((lambda *s: torch.randn(*s, dtype=torch.bfloat16) * 0.05)(D, F)),
            "w_down": _w((lambda *s: torch.randn(*s, dtype=torch.bfloat16) * 0.05)(F, D)),
        }
    _B_in = _B_setup()

    return {
        "A_x": _A_in["x"],
        "A_wqkv": _A_in["wqkv"],
        "A_wo": _A_in["wo"],
        "B_x": _B_in["x"],
        "B_w_r": _B_in["w_r"],
        "B_w_gate": _B_in["w_gate"],
        "B_w_up": _B_in["w_up"],
        "B_w_down": _B_in["w_down"],
    }

def reference(A_x, A_wqkv, A_wo, B_x, B_w_r, B_w_gate, B_w_up, B_w_down):
    def _A_ref(x, wqkv, wo):
        B, S, D = x.shape
        H = 32; Dh = D // H
        qkv = (lambda x, *d: x.permute(*d))((x @ wqkv).reshape(B, S, 3, H, Dh), 2, 0, 3, 1, 4)
        q, k, v = qkv[0], qkv[1], qkv[2]
        phi = lambda t: torch.where(t > 0, t + 1, torch.exp(t)) + 1e-6
        pq, pk = phi(q), phi(k)
        kv = torch.einsum("bhsd,bhse->bhde", pk, v)
        z = torch.einsum("bhsd->bhd", pk)
        num = torch.einsum("bhqd,bhde->bhqe", pq, kv)
        den = torch.einsum("bhqd,bhd->bhq", pq, z)[..., None] + 1e-6
        o = num / den
        return (lambda x, *d: x.permute(*d))(o, 0, 2, 1, 3).reshape(B, S, D) @ wo

    def _B_ref(x, w_r, w_gate, w_up, w_down):
        B, S, D = x.shape
        C = 8
        r = x @ w_r
        idx = torch.argsort(-r, axis=-1)[:, :C]
        idx_e = (lambda x, n, axis: torch.repeat_interleave(x, n, dim=axis))(idx.reshape(B, C, 1), D, axis=2)
        x_sel = (lambda x, i, axis: torch.take_along_dim(x, i, dim=axis))(x, idx_e, axis=1)
        g = _silu(x_sel @ w_gate)
        u = x_sel @ w_up
        y = (g * u) @ w_down
        r_sel = _sigmoid((lambda x, i, axis: torch.take_along_dim(x, i, dim=axis))(r, idx, axis=1))
        y = y * r_sel.reshape(B, C, 1)
        b_off = (torch.arange(B) * S).reshape(B, 1)
        flat_idx = (idx + b_off).reshape(B * C)
        zero = (x * 0.0).reshape(B * S, D)
        upd = _scatter_add(zero, flat_idx, y.reshape(B * C, D), axis=0)
        return x + upd.reshape(B, S, D)

    x = A_x
    x = x + _A_ref(_layernorm(x, axis=-1), A_wqkv, A_wo)
    x = x + _B_ref(_layernorm(x, axis=-1), B_w_r, B_w_gate, B_w_up, B_w_down)
    x = x + _A_ref(_layernorm(x, axis=-1), A_wqkv, A_wo)
    x = x + _B_ref(_layernorm(x, axis=-1), B_w_r, B_w_gate, B_w_up, B_w_down)
    return x
```

```asm
; @launch kernel=prep_kernel grid=(384,1,1) block=(512,1,1) lds=16512
; @launch kernel=qkv_kernel grid=(256,1,1) block=(256,1,1) lds=163840
; @launch kernel=ko_kernel grid=(256,1,1) block=(256,1,1) lds=18432
; @launch kernel=wo0_kernel grid=(256,1,1) block=(256,1,1) lds=98304
; @launch kernel=ln2_0_kernel grid=(256,1,1) block=(512,1,1) lds=16512
; @launch kernel=ffn1_kernel grid=(224,1,1) block=(256,1,1) lds=40960
; @launch kernel=ffn2_kernel grid=(224,1,1) block=(256,1,1) lds=24576
; @launch kernel=fix0_kernel grid=(8,1,1) block=(256,1,1) lds=64
; @launch kernel=qkv_kernel grid=(256,1,1) block=(256,1,1) lds=163840
; @launch kernel=ko_kernel grid=(256,1,1) block=(256,1,1) lds=18432
; @launch kernel=wo1_kernel grid=(256,1,1) block=(256,1,1) lds=98304
; @launch kernel=ln2_1_kernel grid=(256,1,1) block=(512,1,1) lds=16512
; @launch kernel=ffn1_kernel grid=(224,1,1) block=(256,1,1) lds=40960
; @launch kernel=ffn2_kernel grid=(224,1,1) block=(256,1,1) lds=24576
; @launch kernel=fix1_kernel grid=(8,1,1) block=(256,1,1) lds=64
.amdgcn_target "amdgcn-amd-amdhsa--gfx950"

.text
.globl prep_kernel
.p2align 8
.type prep_kernel,@function
prep_kernel:
    s_cmp_ge_u32 s2, 384
    s_cbranch_scc1 prep_kernel_exit4
    s_load_dwordx2 s[4:5], s[0:1], 0
    s_load_dwordx2 s[6:7], s[0:1], 8
    s_load_dwordx2 s[8:9], s[0:1], 16
    s_load_dwordx2 s[10:11], s[0:1], 80
    v_lshrrev_b32 v1, 6, v0
    v_and_b32 v0, 63, v0
    s_nop 0
    v_readfirstlane_b32 s20, v1
    s_waitcnt lgkmcnt(0)
    s_cmp_ge_u32 s2, 128
    s_cbranch_scc1 prep_kernel_ln1
    s_lshl_b32 s21, s2, 3
    s_add_u32 s21, s21, s20
    s_lshl_b32 s21, s21, 3
    v_lshrrev_b32 v2, 5, v0
    v_and_b32 v3, 31, v0
    s_cmp_ge_u32 s21, 6144
    s_cbranch_scc1 prep_kernel_wo2
    s_mov_b32 s12, s6
    s_and_b32 s13, s7, 0xffff
    s_mov_b32 s14, 0x600000
    s_mov_b32 s15, 0x20000
    s_lshr_b32 s22, s21, 6
    s_and_b32 s23, s21, 63
    s_mul_i32 s23, s23, 98304
    s_lshl_b32 s22, s22, 6
    s_add_u32 s22, s22, s23
    s_mov_b32 s23, 98304
    v_mul_u32_u24 v4, 49152, v2
    v_lshl_add_u32 v4, v3, 1, v4
    s_mov_b32 s24, 0
    s_mov_b32 s25, 6144
    s_mov_b32 s26, 12288
    s_mov_b32 s27, 18432
    s_mov_b32 s28, 24576
    s_mov_b32 s29, 30720
    s_mov_b32 s30, 36864
    s_mov_b32 s31, 43008
    s_branch prep_kernel_st3
prep_kernel_wo2:
    s_mov_b32 s12, s8
    s_and_b32 s13, s9, 0xffff
    s_mov_b32 s14, 0x200000
    s_mov_b32 s15, 0x20000
    s_sub_u32 s22, s21, 6144
    s_and_b32 s23, s22, 63
    s_lshr_b32 s22, s22, 6
    s_lshl_b32 s23, s23, 15
    s_lshl_b32 s22, s22, 6
    s_add_u32 s22, s22, s23
    s_mov_b32 s23, 32768
    v_bfe_u32 v5, v3, 2, 1
    v_lshlrev_b32 v5, 4, v5
    v_and_b32 v6, 3, v3
    v_add_u32 v5, v5, v6
    v_lshrrev_b32 v6, 3, v3
    v_lshl_add_u32 v5, v6, 2, v5
    v_lshlrev_b32 v4, 13, v2
    v_lshl_add_u32 v4, v5, 1, v4
    s_mov_b32 s24, 0
    s_mov_b32 s25, 2048
    s_mov_b32 s26, 4096
    s_mov_b32 s27, 6144
    s_mov_b32 s28, 16384
    s_mov_b32 s29, 18432
    s_mov_b32 s30, 20480
    s_mov_b32 s31, 22528
prep_kernel_st3:
    s_mov_b32 s16, s10
    s_and_b32 s17, s11, 0xffff
    s_mov_b32 s18, 0x800000
    s_mov_b32 s19, 0x20000
    v_add_u32 v5, s22, v4
    buffer_load_ushort v16, v5, s[12:15], s24 offen
    buffer_load_ushort v17, v5, s[12:15], s25 offen
    buffer_load_ushort v18, v5, s[12:15], s26 offen
    buffer_load_ushort v19, v5, s[12:15], s27 offen
    buffer_load_ushort v20, v5, s[12:15], s28 offen
    buffer_load_ushort v21, v5, s[12:15], s29 offen
    buffer_load_ushort v22, v5, s[12:15], s30 offen
    buffer_load_ushort v23, v5, s[12:15], s31 offen
    s_add_u32 s22, s22, s23
    v_add_u32 v5, s22, v4
    buffer_load_ushort v24, v5, s[12:15], s24 offen
    buffer_load_ushort v25, v5, s[12:15], s25 offen
    buffer_load_ushort v26, v5, s[12:15], s26 offen
    buffer_load_ushort v27, v5, s[12:15], s27 offen
    buffer_load_ushort v28, v5, s[12:15], s28 offen
    buffer_load_ushort v29, v5, s[12:15], s29 offen
    buffer_load_ushort v30, v5, s[12:15], s30 offen
    buffer_load_ushort v31, v5, s[12:15], s31 offen
    s_add_u32 s22, s22, s23
    v_add_u32 v5, s22, v4
    buffer_load_ushort v32, v5, s[12:15], s24 offen
    buffer_load_ushort v33, v5, s[12:15], s25 offen
    buffer_load_ushort v34, v5, s[12:15], s26 offen
    buffer_load_ushort v35, v5, s[12:15], s27 offen
    buffer_load_ushort v36, v5, s[12:15], s28 offen
    buffer_load_ushort v37, v5, s[12:15], s29 offen
    buffer_load_ushort v38, v5, s[12:15], s30 offen
    buffer_load_ushort v39, v5, s[12:15], s31 offen
    s_add_u32 s22, s22, s23
    v_add_u32 v5, s22, v4
    buffer_load_ushort v40, v5, s[12:15], s24 offen
    buffer_load_ushort v41, v5, s[12:15], s25 offen
    buffer_load_ushort v42, v5, s[12:15], s26 offen
    buffer_load_ushort v43, v5, s[12:15], s27 offen
    buffer_load_ushort v44, v5, s[12:15], s28 offen
    buffer_load_ushort v45, v5, s[12:15], s29 offen
    buffer_load_ushort v46, v5, s[12:15], s30 offen
    buffer_load_ushort v47, v5, s[12:15], s31 offen
    s_add_u32 s22, s22, s23
    v_add_u32 v5, s22, v4
    buffer_load_ushort v48, v5, s[12:15], s24 offen
    buffer_load_ushort v49, v5, s[12:15], s25 offen
    buffer_load_ushort v50, v5, s[12:15], s26 offen
    buffer_load_ushort v51, v5, s[12:15], s27 offen
    buffer_load_ushort v52, v5, s[12:15], s28 offen
    buffer_load_ushort v53, v5, s[12:15], s29 offen
    buffer_load_ushort v54, v5, s[12:15], s30 offen
    buffer_load_ushort v55, v5, s[12:15], s31 offen
    s_add_u32 s22, s22, s23
    v_add_u32 v5, s22, v4
    buffer_load_ushort v56, v5, s[12:15], s24 offen
    buffer_load_ushort v57, v5, s[12:15], s25 offen
    buffer_load_ushort v58, v5, s[12:15], s26 offen
    buffer_load_ushort v59, v5, s[12:15], s27 offen
    buffer_load_ushort v60, v5, s[12:15], s28 offen
    buffer_load_ushort v61, v5, s[12:15], s29 offen
    buffer_load_ushort v62, v5, s[12:15], s30 offen
    buffer_load_ushort v63, v5, s[12:15], s31 offen
    s_add_u32 s22, s22, s23
    v_add_u32 v5, s22, v4
    buffer_load_ushort v64, v5, s[12:15], s24 offen
    buffer_load_ushort v65, v5, s[12:15], s25 offen
    buffer_load_ushort v66, v5, s[12:15], s26 offen
    buffer_load_ushort v67, v5, s[12:15], s27 offen
    buffer_load_ushort v68, v5, s[12:15], s28 offen
    buffer_load_ushort v69, v5, s[12:15], s29 offen
    buffer_load_ushort v70, v5, s[12:15], s30 offen
    buffer_load_ushort v71, v5, s[12:15], s31 offen
    s_add_u32 s22, s22, s23
    v_add_u32 v5, s22, v4
    buffer_load_ushort v72, v5, s[12:15], s24 offen
    buffer_load_ushort v73, v5, s[12:15], s25 offen
    buffer_load_ushort v74, v5, s[12:15], s26 offen
    buffer_load_ushort v75, v5, s[12:15], s27 offen
    buffer_load_ushort v76, v5, s[12:15], s28 offen
    buffer_load_ushort v77, v5, s[12:15], s29 offen
    buffer_load_ushort v78, v5, s[12:15], s30 offen
    buffer_load_ushort v79, v5, s[12:15], s31 offen
    s_add_u32 s22, s22, s23
    s_lshl_b32 s21, s21, 10
    v_lshlrev_b32 v6, 4, v0
    s_waitcnt vmcnt(56)
    v_lshl_or_b32 v80, v17, 16, v16
    v_lshl_or_b32 v81, v19, 16, v18
    v_lshl_or_b32 v82, v21, 16, v20
    v_lshl_or_b32 v83, v23, 16, v22
    buffer_store_dwordx4 v[80:83], v6, s[16:19], s21 offen
    s_add_u32 s21, s21, 1024
    s_waitcnt vmcnt(48)
    v_lshl_or_b32 v84, v25, 16, v24
    v_lshl_or_b32 v85, v27, 16, v26
    v_lshl_or_b32 v86, v29, 16, v28
    v_lshl_or_b32 v87, v31, 16, v30
    buffer_store_dwordx4 v[84:87], v6, s[16:19], s21 offen
    s_add_u32 s21, s21, 1024
    s_waitcnt vmcnt(40)
    v_lshl_or_b32 v88, v33, 16, v32
    v_lshl_or_b32 v89, v35, 16, v34
    v_lshl_or_b32 v90, v37, 16, v36
    v_lshl_or_b32 v91, v39, 16, v38
    buffer_store_dwordx4 v[88:91], v6, s[16:19], s21 offen
    s_add_u32 s21, s21, 1024
    s_waitcnt vmcnt(32)
    v_lshl_or_b32 v92, v41, 16, v40
    v_lshl_or_b32 v93, v43, 16, v42
    v_lshl_or_b32 v94, v45, 16, v44
    v_lshl_or_b32 v95, v47, 16, v46
    buffer_store_dwordx4 v[92:95], v6, s[16:19], s21 offen
    s_add_u32 s21, s21, 1024
    s_waitcnt vmcnt(24)
    v_lshl_or_b32 v96, v49, 16, v48
    v_lshl_or_b32 v97, v51, 16, v50
    v_lshl_or_b32 v98, v53, 16, v52
    v_lshl_or_b32 v99, v55, 16, v54
    buffer_store_dwordx4 v[96:99], v6, s[16:19], s21 offen
    s_add_u32 s21, s21, 1024
    s_waitcnt vmcnt(16)
    v_lshl_or_b32 v100, v57, 16, v56
    v_lshl_or_b32 v101, v59, 16, v58
    v_lshl_or_b32 v102, v61, 16, v60
    v_lshl_or_b32 v103, v63, 16, v62
    buffer_store_dwordx4 v[100:103], v6, s[16:19], s21 offen
    s_add_u32 s21, s21, 1024
    s_waitcnt vmcnt(8)
    v_lshl_or_b32 v104, v65, 16, v64
    v_lshl_or_b32 v105, v67, 16, v66
    v_lshl_or_b32 v106, v69, 16, v68
    v_lshl_or_b32 v107, v71, 16, v70
    buffer_store_dwordx4 v[104:107], v6, s[16:19], s21 offen
    s_add_u32 s21, s21, 1024
    s_waitcnt vmcnt(0)
    v_lshl_or_b32 v108, v73, 16, v72
    v_lshl_or_b32 v109, v75, 16, v74
    v_lshl_or_b32 v110, v77, 16, v76
    v_lshl_or_b32 v111, v79, 16, v78
    buffer_store_dwordx4 v[108:111], v6, s[16:19], s21 offen
    s_add_u32 s21, s21, 1024
    s_branch prep_kernel_exit4
prep_kernel_ln1:
    s_mov_b32 s12, s4
    s_and_b32 s13, s5, 0xffff
    s_mov_b32 s14, 0x400000
    s_mov_b32 s15, 0x20000
    s_add_u32 s16, s10, 0x800000
    s_addc_u32 s17, s11, 0
    s_and_b32 s17, s17, 0xffff
    s_mov_b32 s18, 0x400000
    s_mov_b32 s19, 0x20000
    s_sub_u32 s21, s2, 128
    s_lshl_b32 s21, s21, 3
    s_add_u32 s22, s21, s20
    s_lshl_b32 s23, s22, 11
    v_lshlrev_b32 v2, 5, v0
    buffer_load_dwordx4 v[8:11], v2, s[12:15], s23 offen
    buffer_load_dwordx4 v[12:15], v2, s[12:15], s23 offen offset:16
    s_waitcnt vmcnt(0)
    v_lshlrev_b32 v32, 16, v8
    v_and_b32 v33, 0xffff0000, v8
    v_lshlrev_b32 v34, 16, v9
    v_and_b32 v35, 0xffff0000, v9
    v_lshlrev_b32 v36, 16, v10
    v_and_b32 v37, 0xffff0000, v10
    v_lshlrev_b32 v38, 16, v11
    v_and_b32 v39, 0xffff0000, v11
    v_lshlrev_b32 v40, 16, v12
    v_and_b32 v41, 0xffff0000, v12
    v_lshlrev_b32 v42, 16, v13
    v_and_b32 v43, 0xffff0000, v13
    v_lshlrev_b32 v44, 16, v14
    v_and_b32 v45, 0xffff0000, v14
    v_lshlrev_b32 v46, 16, v15
    v_and_b32 v47, 0xffff0000, v15
    v_add_f32 v48, v32, v33
    v_add_f32 v49, v34, v35
    v_add_f32 v48, v48, v36
    v_add_f32 v49, v49, v37
    v_add_f32 v48, v48, v38
    v_add_f32 v49, v49, v39
    v_add_f32 v48, v48, v40
    v_add_f32 v49, v49, v41
    v_add_f32 v48, v48, v42
    v_add_f32 v49, v49, v43
    v_add_f32 v48, v48, v44
    v_add_f32 v49, v49, v45
    v_add_f32 v48, v48, v46
    v_add_f32 v49, v49, v47
    v_add_f32 v48, v48, v49
    s_nop 1
    v_add_f32_dpp v48, v48, v48 quad_perm:[1,0,3,2] row_mask:0xf bank_mask:0xf
    s_nop 1
    v_add_f32_dpp v48, v48, v48 quad_perm:[2,3,0,1] row_mask:0xf bank_mask:0xf
    s_nop 1
    v_add_f32_dpp v48, v48, v48 row_half_mirror row_mask:0xf bank_mask:0xf
    s_nop 1
    v_add_f32_dpp v48, v48, v48 row_mirror row_mask:0xf bank_mask:0xf
    s_nop 1
    v_readlane_b32 s40, v48, 0
    v_readlane_b32 s41, v48, 16
    v_readlane_b32 s42, v48, 32
    v_readlane_b32 s43, v48, 48
    s_nop 1
    v_mov_b32 v48, s40
    v_add_f32 v48, s41, v48
    v_add_f32 v48, s42, v48
    v_add_f32 v48, s43, v48
    v_mul_f32 v50, 0x3a800000, v48
    v_mov_b32 v48, 0
    v_mov_b32 v49, 0
    v_sub_f32 v54, v32, v50
    v_sub_f32 v55, v33, v50
    v_fmac_f32 v48, v54, v54
    v_fmac_f32 v49, v55, v55
    v_sub_f32 v54, v34, v50
    v_sub_f32 v55, v35, v50
    v_fmac_f32 v48, v54, v54
    v_fmac_f32 v49, v55, v55
    v_sub_f32 v54, v36, v50
    v_sub_f32 v55, v37, v50
    v_fmac_f32 v48, v54, v54
    v_fmac_f32 v49, v55, v55
    v_sub_f32 v54, v38, v50
    v_sub_f32 v55, v39, v50
    v_fmac_f32 v48, v54, v54
    v_fmac_f32 v49, v55, v55
    v_sub_f32 v54, v40, v50
    v_sub_f32 v55, v41, v50
    v_fmac_f32 v48, v54, v54
    v_fmac_f32 v49, v55, v55
    v_sub_f32 v54, v42, v50
    v_sub_f32 v55, v43, v50
    v_fmac_f32 v48, v54, v54
    v_fmac_f32 v49, v55, v55
    v_sub_f32 v54, v44, v50
    v_sub_f32 v55, v45, v50
    v_fmac_f32 v48, v54, v54
    v_fmac_f32 v49, v55, v55
    v_sub_f32 v54, v46, v50
    v_sub_f32 v55, v47, v50
    v_fmac_f32 v48, v54, v54
    v_fmac_f32 v49, v55, v55
    v_add_f32 v48, v48, v49
    s_nop 1
    v_add_f32_dpp v48, v48, v48 quad_perm:[1,0,3,2] row_mask:0xf bank_mask:0xf
    s_nop 1
    v_add_f32_dpp v48, v48, v48 quad_perm:[2,3,0,1] row_mask:0xf bank_mask:0xf
    s_nop 1
    v_add_f32_dpp v48, v48, v48 row_half_mirror row_mask:0xf bank_mask:0xf
    s_nop 1
    v_add_f32_dpp v48, v48, v48 row_mirror row_mask:0xf bank_mask:0xf
    s_nop 1
    v_readlane_b32 s40, v48, 0
    v_readlane_b32 s41, v48, 16
    v_readlane_b32 s42, v48, 32
    v_readlane_b32 s43, v48, 48
    s_nop 1
    v_mov_b32 v48, s40
    v_add_f32 v48, s41, v48
    v_add_f32 v48, s42, v48
    v_add_f32 v48, s43, v48
    v_mul_f32 v48, 0x3a800000, v48
    v_cvt_pk_bf16_f32 v54, v50, v48
    v_lshlrev_b32 v51, 16, v54
    v_and_b32 v48, 0xffff0000, v54
    v_add_f32 v48, 0x3727c5ac, v48
    v_cvt_pk_bf16_f32 v48, v48, v48
    v_lshlrev_b32 v48, 16, v48
    v_sqrt_f32 v48, v48
    s_nop 0
    v_cvt_pk_bf16_f32 v48, v48, v48
    v_lshlrev_b32 v52, 16, v48
    v_rcp_f32 v53, v52
    s_nop 0
    v_sub_f32 v48, v32, v51
    v_sub_f32 v49, v33, v51
    v_cvt_pk_bf16_f32 v48, v48, v49
    v_and_b32 v49, 0xffff0000, v48
    v_lshlrev_b32 v48, 16, v48
    v_mul_f32 v54, v48, v53
    v_mul_f32 v55, v49, v53
    v_fma_f32 v56, -v54, v52, v48
    v_fma_f32 v57, -v55, v52, v49
    v_fma_f32 v54, v56, v53, v54
    v_fma_f32 v55, v57, v53, v55
    v_cvt_pk_bf16_f32 v24, v54, v55
    v_sub_f32 v48, v34, v51
    v_sub_f32 v49, v35, v51
    v_cvt_pk_bf16_f32 v48, v48, v49
    v_and_b32 v49, 0xffff0000, v48
    v_lshlrev_b32 v48, 16, v48
    v_mul_f32 v54, v48, v53
    v_mul_f32 v55, v49, v53
    v_fma_f32 v56, -v54, v52, v48
    v_fma_f32 v57, -v55, v52, v49
    v_fma_f32 v54, v56, v53, v54
    v_fma_f32 v55, v57, v53, v55
    v_cvt_pk_bf16_f32 v25, v54, v55
    v_sub_f32 v48, v36, v51
    v_sub_f32 v49, v37, v51
    v_cvt_pk_bf16_f32 v48, v48, v49
    v_and_b32 v49, 0xffff0000, v48
    v_lshlrev_b32 v48, 16, v48
    v_mul_f32 v54, v48, v53
    v_mul_f32 v55, v49, v53
    v_fma_f32 v56, -v54, v52, v48
    v_fma_f32 v57, -v55, v52, v49
    v_fma_f32 v54, v56, v53, v54
    v_fma_f32 v55, v57, v53, v55
    v_cvt_pk_bf16_f32 v26, v54, v55
    v_sub_f32 v48, v38, v51
    v_sub_f32 v49, v39, v51
    v_cvt_pk_bf16_f32 v48, v48, v49
    v_and_b32 v49, 0xffff0000, v48
    v_lshlrev_b32 v48, 16, v48
    v_mul_f32 v54, v48, v53
    v_mul_f32 v55, v49, v53
    v_fma_f32 v56, -v54, v52, v48
    v_fma_f32 v57, -v55, v52, v49
    v_fma_f32 v54, v56, v53, v54
    v_fma_f32 v55, v57, v53, v55
    v_cvt_pk_bf16_f32 v27, v54, v55
    v_sub_f32 v48, v40, v51
    v_sub_f32 v49, v41, v51
    v_cvt_pk_bf16_f32 v48, v48, v49
    v_and_b32 v49, 0xffff0000, v48
    v_lshlrev_b32 v48, 16, v48
    v_mul_f32 v54, v48, v53
    v_mul_f32 v55, v49, v53
    v_fma_f32 v56, -v54, v52, v48
    v_fma_f32 v57, -v55, v52, v49
    v_fma_f32 v54, v56, v53, v54
    v_fma_f32 v55, v57, v53, v55
    v_cvt_pk_bf16_f32 v28, v54, v55
    v_sub_f32 v48, v42, v51
    v_sub_f32 v49, v43, v51
    v_cvt_pk_bf16_f32 v48, v48, v49
    v_and_b32 v49, 0xffff0000, v48
    v_lshlrev_b32 v48, 16, v48
    v_mul_f32 v54, v48, v53
    v_mul_f32 v55, v49, v53
    v_fma_f32 v56, -v54, v52, v48
    v_fma_f32 v57, -v55, v52, v49
    v_fma_f32 v54, v56, v53, v54
    v_fma_f32 v55, v57, v53, v55
    v_cvt_pk_bf16_f32 v29, v54, v55
    v_sub_f32 v48, v44, v51
    v_sub_f32 v49, v45, v51
    v_cvt_pk_bf16_f32 v48, v48, v49
    v_and_b32 v49, 0xffff0000, v48
    v_lshlrev_b32 v48, 16, v48
    v_mul_f32 v54, v48, v53
    v_mul_f32 v55, v49, v53
    v_fma_f32 v56, -v54, v52, v48
    v_fma_f32 v57, -v55, v52, v49
    v_fma_f32 v54, v56, v53, v54
    v_fma_f32 v55, v57, v53, v55
    v_cvt_pk_bf16_f32 v30, v54, v55
    v_sub_f32 v48, v46, v51
    v_sub_f32 v49, v47, v51
    v_cvt_pk_bf16_f32 v48, v48, v49
    v_and_b32 v49, 0xffff0000, v48
    v_lshlrev_b32 v48, 16, v48
    v_mul_f32 v54, v48, v53
    v_mul_f32 v55, v49, v53
    v_fma_f32 v56, -v54, v52, v48
    v_fma_f32 v57, -v55, v52, v49
    v_fma_f32 v54, v56, v53, v54
    v_fma_f32 v55, v57, v53, v55
    v_cvt_pk_bf16_f32 v31, v54, v55
    s_mul_i32 s44, s20, 2064
    v_lshlrev_b32 v3, 5, v0
    v_add_u32 v3, s44, v3
    ds_write_b128 v3, v[24:27]
    ds_write_b128 v3, v[28:31] offset:16
    s_lshl_b32 s44, s20, 6
    v_add_u32 v3, s44, v0
    v_and_b32 v4, 7, v3
    v_lshrrev_b32 v3, 3, v3
    v_mul_u32_u24 v5, 2064, v4
    v_lshl_add_u32 v5, v3, 4, v5
    s_waitcnt lgkmcnt(0)
    s_barrier
    ds_read_b128 v[24:27], v5
    ds_read_b128 v[28:31], v5 offset:1024
    s_and_b32 s44, s21, 31
    v_add_u32 v4, s44, v4
    v_lshlrev_b32 v4, 4, v4
    v_and_b32 v5, 1, v3
    v_lshl_add_u32 v4, v5, 9, v4
    v_lshrrev_b32 v3, 1, v3
    v_lshl_add_u32 v4, v3, 10, v4
    s_lshr_b32 s44, s21, 5
    s_lshl_b32 s44, s44, 16
    s_waitcnt lgkmcnt(0)
    buffer_store_dwordx4 v[24:27], v4, s[16:19], s44 offen
    s_add_u32 s44, s44, 32768
    buffer_store_dwordx4 v[28:31], v4, s[16:19], s44 offen
prep_kernel_exit4:
    s_endpgm
.section .rodata,"a"
.p2align 6
.amdhsa_kernel prep_kernel
  .amdhsa_next_free_vgpr 144
  .amdhsa_next_free_sgpr 56
  .amdhsa_accum_offset 144
  .amdhsa_group_segment_fixed_size 0
  .amdhsa_kernarg_size 88
  .amdhsa_user_sgpr_count 2
  .amdhsa_user_sgpr_kernarg_segment_ptr 1
  .amdhsa_system_sgpr_workgroup_id_x 1
.end_amdhsa_kernel

.text
.globl qkv_kernel
.p2align 8
.type qkv_kernel,@function
qkv_kernel:
    s_cmp_ge_u32 s2, 256
    s_cbranch_scc1 qkv_kernel_exit1
    s_load_dwordx2 s[10:11], s[0:1], 80
    v_lshrrev_b32 v1, 6, v0
    v_and_b32 v0, 63, v0
    s_nop 0
    v_readfirstlane_b32 s20, v1
    s_and_b32 s21, s2, 7
    s_lshr_b32 s22, s2, 3
    s_and_b32 s23, s21, 1
    s_lshl_b32 s23, s23, 3
    s_and_b32 s24, s22, 7
    s_add_u32 s23, s23, s24
    s_lshr_b32 s24, s21, 1
    s_lshl_b32 s24, s24, 2
    s_lshr_b32 s25, s22, 3
    s_add_u32 s24, s24, s25
    s_lshr_b32 s25, s20, 1
    s_and_b32 s26, s20, 1
    s_waitcnt lgkmcnt(0)
    s_mov_b32 s12, s10
    s_and_b32 s13, s11, 0xffff
    s_mov_b32 s14, 0x1400000
    s_mov_b32 s15, 0x20000
    s_lshl_b32 s27, s23, 18
    s_add_u32 s40, s27, 0x800000
    s_add_u32 s41, s27, 0x810000
    s_add_u32 s42, s27, 0x820000
    s_add_u32 s43, s27, 0x830000
    s_lshl_b32 s27, s24, 17
    s_add_u32 s44, s27, 0x0
    s_add_u32 s45, s27, 0x10000
    s_add_u32 s46, s27, 0x200000
    s_add_u32 s47, s27, 0x210000
    s_add_u32 s48, s27, 0x400000
    s_add_u32 s49, s27, 0x410000
    s_lshl_b32 s28, s20, 10
    v_lshlrev_b32 v1, 4, v0
    v_add_u32 v1, s28, v1
    v_lshlrev_b32 v2, 4, v0
    s_lshl_b32 s29, s25, 13
    v_add_u32 v2, s29, v2
    s_lshl_b32 s29, s26, 12
    s_add_u32 s29, s29, 16384
    v_lshlrev_b32 v3, 4, v0
    v_add_u32 v3, s29, v3
    s_sub_u32 s40, s40, 4096
    s_sub_u32 s41, s41, 4096
    s_sub_u32 s42, s42, 4096
    s_sub_u32 s43, s43, 4096
    s_sub_u32 s44, s44, 4096
    s_sub_u32 s45, s45, 4096
    s_sub_u32 s46, s46, 4096
    s_sub_u32 s47, s47, 4096
    s_sub_u32 s48, s48, 4096
    s_sub_u32 s49, s49, 4096
    s_mov_b32 s34, s28
    s_add_u32 m0, s34, 0x0
    s_add_u32 s40, s40, 4096
    buffer_load_dwordx4 v1, s[12:15], s40 offen lds
    s_add_u32 m0, s34, 0x1000
    s_add_u32 s41, s41, 4096
    buffer_load_dwordx4 v1, s[12:15], s41 offen lds
    s_add_u32 m0, s34, 0x2000
    s_add_u32 s42, s42, 4096
    buffer_load_dwordx4 v1, s[12:15], s42 offen lds
    s_add_u32 m0, s34, 0x3000
    s_add_u32 s43, s43, 4096
    buffer_load_dwordx4 v1, s[12:15], s43 offen lds
    s_add_u32 m0, s34, 0x4000
    s_add_u32 s44, s44, 4096
    buffer_load_dwordx4 v1, s[12:15], s44 offen lds
    s_add_u32 m0, s34, 0x5000
    s_add_u32 s45, s45, 4096
    buffer_load_dwordx4 v1, s[12:15], s45 offen lds
    s_add_u32 m0, s34, 0x6000
    s_add_u32 s46, s46, 4096
    buffer_load_dwordx4 v1, s[12:15], s46 offen lds
    s_add_u32 m0, s34, 0x7000
    s_add_u32 s47, s47, 4096
    buffer_load_dwordx4 v1, s[12:15], s47 offen lds
    s_add_u32 m0, s34, 0x8000
    s_add_u32 s48, s48, 4096
    buffer_load_dwordx4 v1, s[12:15], s48 offen lds
    s_add_u32 m0, s34, 0x9000
    s_add_u32 s49, s49, 4096
    buffer_load_dwordx4 v1, s[12:15], s49 offen lds
    s_add_u32 s34, s34, 40960
    s_add_u32 m0, s34, 0x0
    s_add_u32 s40, s40, 4096
    buffer_load_dwordx4 v1, s[12:15], s40 offen lds
    s_add_u32 m0, s34, 0x1000
    s_add_u32 s41, s41, 4096
    buffer_load_dwordx4 v1, s[12:15], s41 offen lds
    s_add_u32 m0, s34, 0x2000
    s_add_u32 s42, s42, 4096
    buffer_load_dwordx4 v1, s[12:15], s42 offen lds
    s_add_u32 m0, s34, 0x3000
    s_add_u32 s43, s43, 4096
    buffer_load_dwordx4 v1, s[12:15], s43 offen lds
    s_add_u32 m0, s34, 0x4000
    s_add_u32 s44, s44, 4096
    buffer_load_dwordx4 v1, s[12:15], s44 offen lds
    s_add_u32 m0, s34, 0x5000
    s_add_u32 s45, s45, 4096
    buffer_load_dwordx4 v1, s[12:15], s45 offen lds
    s_add_u32 m0, s34, 0x6000
    s_add_u32 s46, s46, 4096
    buffer_load_dwordx4 v1, s[12:15], s46 offen lds
    s_add_u32 m0, s34, 0x7000
    s_add_u32 s47, s47, 4096
    buffer_load_dwordx4 v1, s[12:15], s47 offen lds
    s_add_u32 m0, s34, 0x8000
    s_add_u32 s48, s48, 4096
    buffer_load_dwordx4 v1, s[12:15], s48 offen lds
    s_add_u32 m0, s34, 0x9000
    s_add_u32 s49, s49, 4096
    buffer_load_dwordx4 v1, s[12:15], s49 offen lds
    s_add_u32 s34, s34, 40960
    s_add_u32 m0, s34, 0x0
    s_add_u32 s40, s40, 4096
    buffer_load_dwordx4 v1, s[12:15], s40 offen lds
    s_add_u32 m0, s34, 0x1000
    s_add_u32 s41, s41, 4096
    buffer_load_dwordx4 v1, s[12:15], s41 offen lds
    s_add_u32 m0, s34, 0x2000
    s_add_u32 s42, s42, 4096
    buffer_load_dwordx4 v1, s[12:15], s42 offen lds
    s_add_u32 m0, s34, 0x3000
    s_add_u32 s43, s43, 4096
    buffer_load_dwordx4 v1, s[12:15], s43 offen lds
    s_add_u32 m0, s34, 0x4000
    s_add_u32 s44, s44, 4096
    buffer_load_dwordx4 v1, s[12:15], s44 offen lds
    s_add_u32 m0, s34, 0x5000
    s_add_u32 s45, s45, 4096
    buffer_load_dwordx4 v1, s[12:15], s45 offen lds
    s_add_u32 m0, s34, 0x6000
    s_add_u32 s46, s46, 4096
    buffer_load_dwordx4 v1, s[12:15], s46 offen lds
    s_add_u32 m0, s34, 0x7000
    s_add_u32 s47, s47, 4096
    buffer_load_dwordx4 v1, s[12:15], s47 offen lds
    s_add_u32 m0, s34, 0x8000
    s_add_u32 s48, s48, 4096
    buffer_load_dwordx4 v1, s[12:15], s48 offen lds
    s_add_u32 m0, s34, 0x9000
    s_add_u32 s49, s49, 4096
    buffer_load_dwordx4 v1, s[12:15], s49 offen lds
    s_add_u32 s34, s34, 40960
    v_mov_b32 v64, 0
    v_mov_b32 v65, 0
    v_mov_b32 v66, 0
    v_mov_b32 v67, 0
    v_mov_b32 v68, 0
    v_mov_b32 v69, 0
    v_mov_b32 v70, 0
    v_mov_b32 v71, 0
    v_mov_b32 v72, 0
    v_mov_b32 v73, 0
    v_mov_b32 v74, 0
    v_mov_b32 v75, 0
    v_mov_b32 v76, 0
    v_mov_b32 v77, 0
    v_mov_b32 v78, 0
    v_mov_b32 v79, 0
    v_mov_b32 v80, 0
    v_mov_b32 v81, 0
    v_mov_b32 v82, 0
    v_mov_b32 v83, 0
    v_mov_b32 v84, 0
    v_mov_b32 v85, 0
    v_mov_b32 v86, 0
    v_mov_b32 v87, 0
    v_mov_b32 v88, 0
    v_mov_b32 v89, 0
    v_mov_b32 v90, 0
    v_mov_b32 v91, 0
    v_mov_b32 v92, 0
    v_mov_b32 v93, 0
    v_mov_b32 v94, 0
    v_mov_b32 v95, 0
    v_mov_b32 v96, 0
    v_mov_b32 v97, 0
    v_mov_b32 v98, 0
    v_mov_b32 v99, 0
    v_mov_b32 v100, 0
    v_mov_b32 v101, 0
    v_mov_b32 v102, 0
    v_mov_b32 v103, 0
    v_mov_b32 v104, 0
    v_mov_b32 v105, 0
    v_mov_b32 v106, 0
    v_mov_b32 v107, 0
    v_mov_b32 v108, 0
    v_mov_b32 v109, 0
    v_mov_b32 v110, 0
    v_mov_b32 v111, 0
    v_mov_b32 v112, 0
    v_mov_b32 v113, 0
    v_mov_b32 v114, 0
    v_mov_b32 v115, 0
    v_mov_b32 v116, 0
    v_mov_b32 v117, 0
    v_mov_b32 v118, 0
    v_mov_b32 v119, 0
    v_mov_b32 v120, 0
    v_mov_b32 v121, 0
    v_mov_b32 v122, 0
    v_mov_b32 v123, 0
    v_mov_b32 v124, 0
    v_mov_b32 v125, 0
    v_mov_b32 v126, 0
    v_mov_b32 v127, 0
    v_mov_b32 v128, 0
    v_mov_b32 v129, 0
    v_mov_b32 v130, 0
    v_mov_b32 v131, 0
    v_mov_b32 v132, 0
    v_mov_b32 v133, 0
    v_mov_b32 v134, 0
    v_mov_b32 v135, 0
    v_mov_b32 v136, 0
    v_mov_b32 v137, 0
    v_mov_b32 v138, 0
    v_mov_b32 v139, 0
    v_mov_b32 v140, 0
    v_mov_b32 v141, 0
    v_mov_b32 v142, 0
    v_mov_b32 v143, 0
    v_mov_b32 v144, 0
    v_mov_b32 v145, 0
    v_mov_b32 v146, 0
    v_mov_b32 v147, 0
    v_mov_b32 v148, 0
    v_mov_b32 v149, 0
    v_mov_b32 v150, 0
    v_mov_b32 v151, 0
    v_mov_b32 v152, 0
    v_mov_b32 v153, 0
    v_mov_b32 v154, 0
    v_mov_b32 v155, 0
    v_mov_b32 v156, 0
    v_mov_b32 v157, 0
    v_mov_b32 v158, 0
    v_mov_b32 v159, 0
    s_mov_b32 s32, 0
    s_mov_b32 s33, 0
    s_waitcnt vmcnt(20)
    s_barrier
    v_add_u32 v4, s33, v2
    v_add_u32 v5, s33, v3
    ds_read_b128 v[16:19], v4 offset:0
    ds_read_b128 v[20:23], v4 offset:4096
    ds_read_b128 v[24:27], v5 offset:0
    ds_read_b128 v[28:31], v5 offset:8192
    ds_read_b128 v[32:35], v5 offset:16384
qkv_kernel_loop3:
    s_waitcnt lgkmcnt(0)
    v_mfma_f32_32x32x16_bf16 v[64:79], v[24:27], v[16:19], v[64:79]
    ds_read_b128 v[36:39], v4 offset:1024
    ds_read_b128 v[40:43], v4 offset:5120
    v_mfma_f32_32x32x16_bf16 v[96:111], v[16:19], v[28:31], v[96:111]
    ds_read_b128 v[44:47], v5 offset:1024
    ds_read_b128 v[48:51], v5 offset:9216
    v_mfma_f32_32x32x16_bf16 v[128:143], v[16:19], v[32:35], v[128:143]
    ds_read_b128 v[52:55], v5 offset:17408
    v_mfma_f32_32x32x16_bf16 v[80:95], v[24:27], v[20:23], v[80:95]
    s_add_u32 m0, s34, 0x2000
    s_add_u32 s42, s42, 4096
    buffer_load_dwordx4 v1, s[12:15], s42 offen lds
    v_mfma_f32_32x32x16_bf16 v[112:127], v[20:23], v[28:31], v[112:127]
    s_add_u32 m0, s34, 0x1000
    s_add_u32 s41, s41, 4096
    buffer_load_dwordx4 v1, s[12:15], s41 offen lds
    v_mfma_f32_32x32x16_bf16 v[144:159], v[20:23], v[32:35], v[144:159]
    s_add_u32 m0, s34, 0x0
    s_add_u32 s40, s40, 4096
    buffer_load_dwordx4 v1, s[12:15], s40 offen lds
    s_waitcnt lgkmcnt(0)
    v_mfma_f32_32x32x16_bf16 v[64:79], v[44:47], v[36:39], v[64:79]
    ds_read_b128 v[16:19], v4 offset:2048
    ds_read_b128 v[20:23], v4 offset:6144
    v_mfma_f32_32x32x16_bf16 v[96:111], v[36:39], v[48:51], v[96:111]
    ds_read_b128 v[24:27], v5 offset:2048
    ds_read_b128 v[28:31], v5 offset:10240
    v_mfma_f32_32x32x16_bf16 v[128:143], v[36:39], v[52:55], v[128:143]
    ds_read_b128 v[32:35], v5 offset:18432
    v_mfma_f32_32x32x16_bf16 v[80:95], v[44:47], v[40:43], v[80:95]
    s_add_u32 m0, s34, 0x5000
    s_add_u32 s45, s45, 4096
    buffer_load_dwordx4 v1, s[12:15], s45 offen lds
    v_mfma_f32_32x32x16_bf16 v[112:127], v[40:43], v[48:51], v[112:127]
    s_add_u32 m0, s34, 0x4000
    s_add_u32 s44, s44, 4096
    buffer_load_dwordx4 v1, s[12:15], s44 offen lds
    v_mfma_f32_32x32x16_bf16 v[144:159], v[40:43], v[52:55], v[144:159]
    s_add_u32 m0, s34, 0x3000
    s_add_u32 s43, s43, 4096
    buffer_load_dwordx4 v1, s[12:15], s43 offen lds
    s_waitcnt lgkmcnt(0)
    v_mfma_f32_32x32x16_bf16 v[64:79], v[24:27], v[16:19], v[64:79]
    ds_read_b128 v[36:39], v4 offset:3072
    ds_read_b128 v[40:43], v4 offset:7168
    v_mfma_f32_32x32x16_bf16 v[96:111], v[16:19], v[28:31], v[96:111]
    ds_read_b128 v[44:47], v5 offset:3072
    ds_read_b128 v[48:51], v5 offset:11264
    v_mfma_f32_32x32x16_bf16 v[128:143], v[16:19], v[32:35], v[128:143]
    ds_read_b128 v[52:55], v5 offset:19456
    v_mfma_f32_32x32x16_bf16 v[80:95], v[24:27], v[20:23], v[80:95]
    v_mfma_f32_32x32x16_bf16 v[112:127], v[20:23], v[28:31], v[112:127]
    s_add_u32 m0, s34, 0x7000
    s_add_u32 s47, s47, 4096
    buffer_load_dwordx4 v1, s[12:15], s47 offen lds
    v_mfma_f32_32x32x16_bf16 v[144:159], v[20:23], v[32:35], v[144:159]
    s_add_u32 m0, s34, 0x6000
    s_add_u32 s46, s46, 4096
    buffer_load_dwordx4 v1, s[12:15], s46 offen lds
    s_waitcnt lgkmcnt(0)
    v_mfma_f32_32x32x16_bf16 v[64:79], v[44:47], v[36:39], v[64:79]
    s_waitcnt vmcnt(18)
    s_barrier
    s_add_u32 s33, s33, 40960
    s_cmp_eq_u32 s33, 163840
    s_cselect_b32 s33, 0, s33
    v_add_u32 v4, s33, v2
    v_add_u32 v5, s33, v3
    ds_read_b128 v[16:19], v4 offset:0
    ds_read_b128 v[20:23], v4 offset:4096
    v_mfma_f32_32x32x16_bf16 v[96:111], v[36:39], v[48:51], v[96:111]
    ds_read_b128 v[24:27], v5 offset:0
    ds_read_b128 v[28:31], v5 offset:8192
    v_mfma_f32_32x32x16_bf16 v[128:143], v[36:39], v[52:55], v[128:143]
    ds_read_b128 v[32:35], v5 offset:16384
    v_mfma_f32_32x32x16_bf16 v[80:95], v[44:47], v[40:43], v[80:95]
    v_mfma_f32_32x32x16_bf16 v[112:127], v[40:43], v[48:51], v[112:127]
    s_add_u32 m0, s34, 0x9000
    s_add_u32 s49, s49, 4096
    buffer_load_dwordx4 v1, s[12:15], s49 offen lds
    v_mfma_f32_32x32x16_bf16 v[144:159], v[40:43], v[52:55], v[144:159]
    s_add_u32 m0, s34, 0x8000
    s_add_u32 s48, s48, 4096
    buffer_load_dwordx4 v1, s[12:15], s48 offen lds
    s_add_u32 s34, s34, 40960
    s_cmp_ge_u32 s34, 163840
    s_cselect_b32 s35, 163840, 0
    s_sub_u32 s34, s34, s35
    s_add_u32 s32, s32, 1
    s_cmp_lt_u32 s32, 13
    s_cbranch_scc1 qkv_kernel_loop3
    s_waitcnt lgkmcnt(0)
    v_mfma_f32_32x32x16_bf16 v[64:79], v[24:27], v[16:19], v[64:79]
    ds_read_b128 v[36:39], v4 offset:1024
    ds_read_b128 v[40:43], v4 offset:5120
    v_mfma_f32_32x32x16_bf16 v[96:111], v[16:19], v[28:31], v[96:111]
    ds_read_b128 v[44:47], v5 offset:1024
    ds_read_b128 v[48:51], v5 offset:9216
    v_mfma_f32_32x32x16_bf16 v[128:143], v[16:19], v[32:35], v[128:143]
    ds_read_b128 v[52:55], v5 offset:17408
    v_mfma_f32_32x32x16_bf16 v[80:95], v[24:27], v[20:23], v[80:95]
    v_mfma_f32_32x32x16_bf16 v[112:127], v[20:23], v[28:31], v[112:127]
    v_mfma_f32_32x32x16_bf16 v[144:159], v[20:23], v[32:35], v[144:159]
    s_waitcnt lgkmcnt(0)
    v_mfma_f32_32x32x16_bf16 v[64:79], v[44:47], v[36:39], v[64:79]
    ds_read_b128 v[16:19], v4 offset:2048
    ds_read_b128 v[20:23], v4 offset:6144
    v_mfma_f32_32x32x16_bf16 v[96:111], v[36:39], v[48:51], v[96:111]
    ds_read_b128 v[24:27], v5 offset:2048
    ds_read_b128 v[28:31], v5 offset:10240
    v_mfma_f32_32x32x16_bf16 v[128:143], v[36:39], v[52:55], v[128:143]
    ds_read_b128 v[32:35], v5 offset:18432
    v_mfma_f32_32x32x16_bf16 v[80:95], v[44:47], v[40:43], v[80:95]
    v_mfma_f32_32x32x16_bf16 v[112:127], v[40:43], v[48:51], v[112:127]
    v_mfma_f32_32x32x16_bf16 v[144:159], v[40:43], v[52:55], v[144:159]
    s_waitcnt lgkmcnt(0)
    v_mfma_f32_32x32x16_bf16 v[64:79], v[24:27], v[16:19], v[64:79]
    ds_read_b128 v[36:39], v4 offset:3072
    ds_read_b128 v[40:43], v4 offset:7168
    v_mfma_f32_32x32x16_bf16 v[96:111], v[16:19], v[28:31], v[96:111]
    ds_read_b128 v[44:47], v5 offset:3072
    ds_read_b128 v[48:51], v5 offset:11264
    v_mfma_f32_32x32x16_bf16 v[128:143], v[16:19], v[32:35], v[128:143]
    ds_read_b128 v[52:55], v5 offset:19456
    v_mfma_f32_32x32x16_bf16 v[80:95], v[24:27], v[20:23], v[80:95]
    v_mfma_f32_32x32x16_bf16 v[112:127], v[20:23], v[28:31], v[112:127]
    v_mfma_f32_32x32x16_bf16 v[144:159], v[20:23], v[32:35], v[144:159]
    s_waitcnt lgkmcnt(0)
    v_mfma_f32_32x32x16_bf16 v[64:79], v[44:47], v[36:39], v[64:79]
    s_waitcnt vmcnt(10)
    s_barrier
    s_add_u32 s33, s33, 40960
    s_cmp_eq_u32 s33, 163840
    s_cselect_b32 s33, 0, s33
    v_add_u32 v4, s33, v2
    v_add_u32 v5, s33, v3
    ds_read_b128 v[16:19], v4 offset:0
    ds_read_b128 v[20:23], v4 offset:4096
    v_mfma_f32_32x32x16_bf16 v[96:111], v[36:39], v[48:51], v[96:111]
    ds_read_b128 v[24:27], v5 offset:0
    ds_read_b128 v[28:31], v5 offset:8192
    v_mfma_f32_32x32x16_bf16 v[128:143], v[36:39], v[52:55], v[128:143]
    ds_read_b128 v[32:35], v5 offset:16384
    v_mfma_f32_32x32x16_bf16 v[80:95], v[44:47], v[40:43], v[80:95]
    v_mfma_f32_32x32x16_bf16 v[112:127], v[40:43], v[48:51], v[112:127]
    v_mfma_f32_32x32x16_bf16 v[144:159], v[40:43], v[52:55], v[144:159]
    s_waitcnt lgkmcnt(0)
    v_mfma_f32_32x32x16_bf16 v[64:79], v[24:27], v[16:19], v[64:79]
    ds_read_b128 v[36:39], v4 offset:1024
    ds_read_b128 v[40:43], v4 offset:5120
    v_mfma_f32_32x32x16_bf16 v[96:111], v[16:19], v[28:31], v[96:111]
    ds_read_b128 v[44:47], v5 offset:1024
    ds_read_b128 v[48:51], v5 offset:9216
    v_mfma_f32_32x32x16_bf16 v[128:143], v[16:19], v[32:35], v[128:143]
    ds_read_b128 v[52:55], v5 offset:17408
    v_mfma_f32_32x32x16_bf16 v[80:95], v[24:27], v[20:23], v[80:95]
    v_mfma_f32_32x32x16_bf16 v[112:127], v[20:23], v[28:31], v[112:127]
    v_mfma_f32_32x32x16_bf16 v[144:159], v[20:23], v[32:35], v[144:159]
    s_waitcnt lgkmcnt(0)
    v_mfma_f32_32x32x16_bf16 v[64:79], v[44:47], v[36:39], v[64:79]
    ds_read_b128 v[16:19], v4 offset:2048
    ds_read_b128 v[20:23], v4 offset:6144
    v_mfma_f32_32x32x16_bf16 v[96:111], v[36:39], v[48:51], v[96:111]
    ds_read_b128 v[24:27], v5 offset:2048
    ds_read_b128 v[28:31], v5 offset:10240
    v_mfma_f32_32x32x16_bf16 v[128:143], v[36:39], v[52:55], v[128:143]
    ds_read_b128 v[32:35], v5 offset:18432
    v_mfma_f32_32x32x16_bf16 v[80:95], v[44:47], v[40:43], v[80:95]
    v_mfma_f32_32x32x16_bf16 v[112:127], v[40:43], v[48:51], v[112:127]
    v_mfma_f32_32x32x16_bf16 v[144:159], v[40:43], v[52:55], v[144:159]
    s_waitcnt lgkmcnt(0)
    v_mfma_f32_32x32x16_bf16 v[64:79], v[24:27], v[16:19], v[64:79]
    ds_read_b128 v[36:39], v4 offset:3072
    ds_read_b128 v[40:43], v4 offset:7168
    v_mfma_f32_32x32x16_bf16 v[96:111], v[16:19], v[28:31], v[96:111]
    ds_read_b128 v[44:47], v5 offset:3072
    ds_read_b128 v[48:51], v5 offset:11264
    v_mfma_f32_32x32x16_bf16 v[128:143], v[16:19], v[32:35], v[128:143]
    ds_read_b128 v[52:55], v5 offset:19456
    v_mfma_f32_32x32x16_bf16 v[80:95], v[24:27], v[20:23], v[80:95]
    v_mfma_f32_32x32x16_bf16 v[112:127], v[20:23], v[28:31], v[112:127]
    v_mfma_f32_32x32x16_bf16 v[144:159], v[20:23], v[32:35], v[144:159]
    s_waitcnt lgkmcnt(0)
    v_mfma_f32_32x32x16_bf16 v[64:79], v[44:47], v[36:39], v[64:79]
    s_waitcnt vmcnt(0)
    s_barrier
    s_add_u32 s33, s33, 40960
    s_cmp_eq_u32 s33, 163840
    s_cselect_b32 s33, 0, s33
    v_add_u32 v4, s33, v2
    v_add_u32 v5, s33, v3
    ds_read_b128 v[16:19], v4 offset:0
    ds_read_b128 v[20:23], v4 offset:4096
    v_mfma_f32_32x32x16_bf16 v[96:111], v[36:39], v[48:51], v[96:111]
    ds_read_b128 v[24:27], v5 offset:0
    ds_read_b128 v[28:31], v5 offset:8192
    v_mfma_f32_32x32x16_bf16 v[128:143], v[36:39], v[52:55], v[128:143]
    ds_read_b128 v[32:35], v5 offset:16384
    v_mfma_f32_32x32x16_bf16 v[80:95], v[44:47], v[40:43], v[80:95]
    v_mfma_f32_32x32x16_bf16 v[112:127], v[40:43], v[48:51], v[112:127]
    v_mfma_f32_32x32x16_bf16 v[144:159], v[40:43], v[52:55], v[144:159]
    s_waitcnt lgkmcnt(0)
    v_mfma_f32_32x32x16_bf16 v[64:79], v[24:27], v[16:19], v[64:79]
    ds_read_b128 v[36:39], v4 offset:1024
    ds_read_b128 v[40:43], v4 offset:5120
    v_mfma_f32_32x32x16_bf16 v[96:111], v[16:19], v[28:31], v[96:111]
    ds_read_b128 v[44:47], v5 offset:1024
    ds_read_b128 v[48:51], v5 offset:9216
    v_mfma_f32_32x32x16_bf16 v[128:143], v[16:19], v[32:35], v[128:143]
    ds_read_b128 v[52:55], v5 offset:17408
    v_mfma_f32_32x32x16_bf16 v[80:95], v[24:27], v[20:23], v[80:95]
    v_mfma_f32_32x32x16_bf16 v[112:127], v[20:23], v[28:31], v[112:127]
    v_mfma_f32_32x32x16_bf16 v[144:159], v[20:23], v[32:35], v[144:159]
    s_waitcnt lgkmcnt(0)
    v_mfma_f32_32x32x16_bf16 v[64:79], v[44:47], v[36:39], v[64:79]
    ds_read_b128 v[16:19], v4 offset:2048
    ds_read_b128 v[20:23], v4 offset:6144
    v_mfma_f32_32x32x16_bf16 v[96:111], v[36:39], v[48:51], v[96:111]
    ds_read_b128 v[24:27], v5 offset:2048
    ds_read_b128 v[28:31], v5 offset:10240
    v_mfma_f32_32x32x16_bf16 v[128:143], v[36:39], v[52:55], v[128:143]
    ds_read_b128 v[32:35], v5 offset:18432
    v_mfma_f32_32x32x16_bf16 v[80:95], v[44:47], v[40:43], v[80:95]
    v_mfma_f32_32x32x16_bf16 v[112:127], v[40:43], v[48:51], v[112:127]
    v_mfma_f32_32x32x16_bf16 v[144:159], v[40:43], v[52:55], v[144:159]
    s_waitcnt lgkmcnt(0)
    v_mfma_f32_32x32x16_bf16 v[64:79], v[24:27], v[16:19], v[64:79]
    ds_read_b128 v[36:39], v4 offset:3072
    ds_read_b128 v[40:43], v4 offset:7168
    v_mfma_f32_32x32x16_bf16 v[96:111], v[16:19], v[28:31], v[96:111]
    ds_read_b128 v[44:47], v5 offset:3072
    ds_read_b128 v[48:51], v5 offset:11264
    v_mfma_f32_32x32x16_bf16 v[128:143], v[16:19], v[32:35], v[128:143]
    ds_read_b128 v[52:55], v5 offset:19456
    v_mfma_f32_32x32x16_bf16 v[80:95], v[24:27], v[20:23], v[80:95]
    v_mfma_f32_32x32x16_bf16 v[112:127], v[20:23], v[28:31], v[112:127]
    v_mfma_f32_32x32x16_bf16 v[144:159], v[20:23], v[32:35], v[144:159]
    s_waitcnt lgkmcnt(0)
    v_mfma_f32_32x32x16_bf16 v[64:79], v[44:47], v[36:39], v[64:79]
    v_mfma_f32_32x32x16_bf16 v[96:111], v[36:39], v[48:51], v[96:111]
    v_mfma_f32_32x32x16_bf16 v[128:143], v[36:39], v[52:55], v[128:143]
    v_mfma_f32_32x32x16_bf16 v[80:95], v[44:47], v[40:43], v[80:95]
    v_mfma_f32_32x32x16_bf16 v[112:127], v[40:43], v[48:51], v[112:127]
    v_mfma_f32_32x32x16_bf16 v[144:159], v[40:43], v[52:55], v[144:159]
    s_nop 15
    s_nop 15
    v_mov_b32 v200, 0
    s_add_u32 s16, s10, 0xc00000
    s_addc_u32 s17, s11, 0
    s_and_b32 s17, s17, 0xffff
    s_mov_b32 s18, 0x400000
    s_mov_b32 s19, 0x20000
    s_lshl_b32 s27, s23, 2
    s_lshl_b32 s29, s25, 1
    s_add_u32 s27, s27, s29
    s_lshl_b32 s27, s27, 16
    s_lshl_b32 s29, s24, 1
    s_add_u32 s29, s29, s26
    s_lshl_b32 s30, s29, 11
    s_add_u32 s27, s27, s30
    v_lshlrev_b32 v6, 4, v0
    v_cvt_pk_bf16_f32 v10, v64, v65
    v_lshlrev_b32 v8, 16, v10
    v_and_b32 v9, 0xffff0000, v10
    v_mul_f32 v10, 0x3fb8aa3b, v8
    v_mul_f32 v11, 0x3fb8aa3b, v9
    v_exp_f32 v10, v10
    v_exp_f32 v11, v11
    v_add_f32 v12, 1.0, v8
    v_add_f32 v13, 1.0, v9
    v_cmp_lt_f32 vcc, 0, v8
    s_nop 1
    v_cndmask_b32 v10, v10, v12, vcc
    v_cmp_lt_f32 vcc, 0, v9
    s_nop 1
    v_cndmask_b32 v11, v11, v13, vcc
    v_cvt_pk_bf16_f32 v10, v10, v11
    v_lshlrev_b32 v8, 16, v10
    v_and_b32 v9, 0xffff0000, v10
    v_add_f32 v8, 0x358637bd, v8
    v_add_f32 v9, 0x358637bd, v9
    v_cvt_pk_bf16_f32 v192, v8, v9
    v_cvt_pk_bf16_f32 v10, v66, v67
    v_lshlrev_b32 v8, 16, v10
    v_and_b32 v9, 0xffff0000, v10
    v_mul_f32 v10, 0x3fb8aa3b, v8
    v_mul_f32 v11, 0x3fb8aa3b, v9
    v_exp_f32 v10, v10
    v_exp_f32 v11, v11
    v_add_f32 v12, 1.0, v8
    v_add_f32 v13, 1.0, v9
    v_cmp_lt_f32 vcc, 0, v8
    s_nop 1
    v_cndmask_b32 v10, v10, v12, vcc
    v_cmp_lt_f32 vcc, 0, v9
    s_nop 1
    v_cndmask_b32 v11, v11, v13, vcc
    v_cvt_pk_bf16_f32 v10, v10, v11
    v_lshlrev_b32 v8, 16, v10
    v_and_b32 v9, 0xffff0000, v10
    v_add_f32 v8, 0x358637bd, v8
    v_add_f32 v9, 0x358637bd, v9
    v_cvt_pk_bf16_f32 v193, v8, v9
    v_cvt_pk_bf16_f32 v10, v68, v69
    v_lshlrev_b32 v8, 16, v10
    v_and_b32 v9, 0xffff0000, v10
    v_mul_f32 v10, 0x3fb8aa3b, v8
    v_mul_f32 v11, 0x3fb8aa3b, v9
    v_exp_f32 v10, v10
    v_exp_f32 v11, v11
    v_add_f32 v12, 1.0, v8
    v_add_f32 v13, 1.0, v9
    v_cmp_lt_f32 vcc, 0, v8
    s_nop 1
    v_cndmask_b32 v10, v10, v12, vcc
    v_cmp_lt_f32 vcc, 0, v9
    s_nop 1
    v_cndmask_b32 v11, v11, v13, vcc
    v_cvt_pk_bf16_f32 v10, v10, v11
    v_lshlrev_b32 v8, 16, v10
    v_and_b32 v9, 0xffff0000, v10
    v_add_f32 v8, 0x358637bd, v8
    v_add_f32 v9, 0x358637bd, v9
    v_cvt_pk_bf16_f32 v194, v8, v9
    v_cvt_pk_bf16_f32 v10, v70, v71
    v_lshlrev_b32 v8, 16, v10
    v_and_b32 v9, 0xffff0000, v10
    v_mul_f32 v10, 0x3fb8aa3b, v8
    v_mul_f32 v11, 0x3fb8aa3b, v9
    v_exp_f32 v10, v10
    v_exp_f32 v11, v11
    v_add_f32 v12, 1.0, v8
    v_add_f32 v13, 1.0, v9
    v_cmp_lt_f32 vcc, 0, v8
    s_nop 1
    v_cndmask_b32 v10, v10, v12, vcc
    v_cmp_lt_f32 vcc, 0, v9
    s_nop 1
    v_cndmask_b32 v11, v11, v13, vcc
    v_cvt_pk_bf16_f32 v10, v10, v11
    v_lshlrev_b32 v8, 16, v10
    v_and_b32 v9, 0xffff0000, v10
    v_add_f32 v8, 0x358637bd, v8
    v_add_f32 v9, 0x358637bd, v9
    v_cvt_pk_bf16_f32 v195, v8, v9
    v_cvt_pk_bf16_f32 v10, v72, v73
    v_lshlrev_b32 v8, 16, v10
    v_and_b32 v9, 0xffff0000, v10
    v_mul_f32 v10, 0x3fb8aa3b, v8
    v_mul_f32 v11, 0x3fb8aa3b, v9
    v_exp_f32 v10, v10
    v_exp_f32 v11, v11
    v_add_f32 v12, 1.0, v8
    v_add_f32 v13, 1.0, v9
    v_cmp_lt_f32 vcc, 0, v8
    s_nop 1
    v_cndmask_b32 v10, v10, v12, vcc
    v_cmp_lt_f32 vcc, 0, v9
    s_nop 1
    v_cndmask_b32 v11, v11, v13, vcc
    v_cvt_pk_bf16_f32 v10, v10, v11
    v_lshlrev_b32 v8, 16, v10
    v_and_b32 v9, 0xffff0000, v10
    v_add_f32 v8, 0x358637bd, v8
    v_add_f32 v9, 0x358637bd, v9
    v_cvt_pk_bf16_f32 v196, v8, v9
    v_cvt_pk_bf16_f32 v10, v74, v75
    v_lshlrev_b32 v8, 16, v10
    v_and_b32 v9, 0xffff0000, v10
    v_mul_f32 v10, 0x3fb8aa3b, v8
    v_mul_f32 v11, 0x3fb8aa3b, v9
    v_exp_f32 v10, v10
    v_exp_f32 v11, v11
    v_add_f32 v12, 1.0, v8
    v_add_f32 v13, 1.0, v9
    v_cmp_lt_f32 vcc, 0, v8
    s_nop 1
    v_cndmask_b32 v10, v10, v12, vcc
    v_cmp_lt_f32 vcc, 0, v9
    s_nop 1
    v_cndmask_b32 v11, v11, v13, vcc
    v_cvt_pk_bf16_f32 v10, v10, v11
    v_lshlrev_b32 v8, 16, v10
    v_and_b32 v9, 0xffff0000, v10
    v_add_f32 v8, 0x358637bd, v8
    v_add_f32 v9, 0x358637bd, v9
    v_cvt_pk_bf16_f32 v197, v8, v9
    v_cvt_pk_bf16_f32 v10, v76, v77
    v_lshlrev_b32 v8, 16, v10
    v_and_b32 v9, 0xffff0000, v10
    v_mul_f32 v10, 0x3fb8aa3b, v8
    v_mul_f32 v11, 0x3fb8aa3b, v9
    v_exp_f32 v10, v10
    v_exp_f32 v11, v11
    v_add_f32 v12, 1.0, v8
    v_add_f32 v13, 1.0, v9
    v_cmp_lt_f32 vcc, 0, v8
    s_nop 1
    v_cndmask_b32 v10, v10, v12, vcc
    v_cmp_lt_f32 vcc, 0, v9
    s_nop 1
    v_cndmask_b32 v11, v11, v13, vcc
    v_cvt_pk_bf16_f32 v10, v10, v11
    v_lshlrev_b32 v8, 16, v10
    v_and_b32 v9, 0xffff0000, v10
    v_add_f32 v8, 0x358637bd, v8
    v_add_f32 v9, 0x358637bd, v9
    v_cvt_pk_bf16_f32 v198, v8, v9
    v_cvt_pk_bf16_f32 v10, v78, v79
    v_lshlrev_b32 v8, 16, v10
    v_and_b32 v9, 0xffff0000, v10
    v_mul_f32 v10, 0x3fb8aa3b, v8
    v_mul_f32 v11, 0x3fb8aa3b, v9
    v_exp_f32 v10, v10
    v_exp_f32 v11, v11
    v_add_f32 v12, 1.0, v8
    v_add_f32 v13, 1.0, v9
    v_cmp_lt_f32 vcc, 0, v8
    s_nop 1
    v_cndmask_b32 v10, v10, v12, vcc
    v_cmp_lt_f32 vcc, 0, v9
    s_nop 1
    v_cndmask_b32 v11, v11, v13, vcc
    v_cvt_pk_bf16_f32 v10, v10, v11
    v_lshlrev_b32 v8, 16, v10
    v_and_b32 v9, 0xffff0000, v10
    v_add_f32 v8, 0x358637bd, v8
    v_add_f32 v9, 0x358637bd, v9
    v_cvt_pk_bf16_f32 v199, v8, v9
    buffer_store_dwordx4 v[192:195], v6, s[16:19], s27 offen
    buffer_store_dwordx4 v[196:199], v6, s[16:19], s27 offen offset:1024
    s_nop 1
    s_add_u32 s27, s27, 65536
    v_cvt_pk_bf16_f32 v10, v80, v81
    v_lshlrev_b32 v8, 16, v10
    v_and_b32 v9, 0xffff0000, v10
    v_mul_f32 v10, 0x3fb8aa3b, v8
    v_mul_f32 v11, 0x3fb8aa3b, v9
    v_exp_f32 v10, v10
    v_exp_f32 v11, v11
    v_add_f32 v12, 1.0, v8
    v_add_f32 v13, 1.0, v9
    v_cmp_lt_f32 vcc, 0, v8
    s_nop 1
    v_cndmask_b32 v10, v10, v12, vcc
    v_cmp_lt_f32 vcc, 0, v9
    s_nop 1
    v_cndmask_b32 v11, v11, v13, vcc
    v_cvt_pk_bf16_f32 v10, v10, v11
    v_lshlrev_b32 v8, 16, v10
    v_and_b32 v9, 0xffff0000, v10
    v_add_f32 v8, 0x358637bd, v8
    v_add_f32 v9, 0x358637bd, v9
    v_cvt_pk_bf16_f32 v192, v8, v9
    v_cvt_pk_bf16_f32 v10, v82, v83
    v_lshlrev_b32 v8, 16, v10
    v_and_b32 v9, 0xffff0000, v10
    v_mul_f32 v10, 0x3fb8aa3b, v8
    v_mul_f32 v11, 0x3fb8aa3b, v9
    v_exp_f32 v10, v10
    v_exp_f32 v11, v11
    v_add_f32 v12, 1.0, v8
    v_add_f32 v13, 1.0, v9
    v_cmp_lt_f32 vcc, 0, v8
    s_nop 1
    v_cndmask_b32 v10, v10, v12, vcc
    v_cmp_lt_f32 vcc, 0, v9
    s_nop 1
    v_cndmask_b32 v11, v11, v13, vcc
    v_cvt_pk_bf16_f32 v10, v10, v11
    v_lshlrev_b32 v8, 16, v10
    v_and_b32 v9, 0xffff0000, v10
    v_add_f32 v8, 0x358637bd, v8
    v_add_f32 v9, 0x358637bd, v9
    v_cvt_pk_bf16_f32 v193, v8, v9
    v_cvt_pk_bf16_f32 v10, v84, v85
    v_lshlrev_b32 v8, 16, v10
    v_and_b32 v9, 0xffff0000, v10
    v_mul_f32 v10, 0x3fb8aa3b, v8
    v_mul_f32 v11, 0x3fb8aa3b, v9
    v_exp_f32 v10, v10
    v_exp_f32 v11, v11
    v_add_f32 v12, 1.0, v8
    v_add_f32 v13, 1.0, v9
    v_cmp_lt_f32 vcc, 0, v8
    s_nop 1
    v_cndmask_b32 v10, v10, v12, vcc
    v_cmp_lt_f32 vcc, 0, v9
    s_nop 1
    v_cndmask_b32 v11, v11, v13, vcc
    v_cvt_pk_bf16_f32 v10, v10, v11
    v_lshlrev_b32 v8, 16, v10
    v_and_b32 v9, 0xffff0000, v10
    v_add_f32 v8, 0x358637bd, v8
    v_add_f32 v9, 0x358637bd, v9
    v_cvt_pk_bf16_f32 v194, v8, v9
    v_cvt_pk_bf16_f32 v10, v86, v87
    v_lshlrev_b32 v8, 16, v10
    v_and_b32 v9, 0xffff0000, v10
    v_mul_f32 v10, 0x3fb8aa3b, v8
    v_mul_f32 v11, 0x3fb8aa3b, v9
    v_exp_f32 v10, v10
    v_exp_f32 v11, v11
    v_add_f32 v12, 1.0, v8
    v_add_f32 v13, 1.0, v9
    v_cmp_lt_f32 vcc, 0, v8
    s_nop 1
    v_cndmask_b32 v10, v10, v12, vcc
    v_cmp_lt_f32 vcc, 0, v9
    s_nop 1
    v_cndmask_b32 v11, v11, v13, vcc
    v_cvt_pk_bf16_f32 v10, v10, v11
    v_lshlrev_b32 v8, 16, v10
    v_and_b32 v9, 0xffff0000, v10
    v_add_f32 v8, 0x358637bd, v8
    v_add_f32 v9, 0x358637bd, v9
    v_cvt_pk_bf16_f32 v195, v8, v9
    v_cvt_pk_bf16_f32 v10, v88, v89
    v_lshlrev_b32 v8, 16, v10
    v_and_b32 v9, 0xffff0000, v10
    v_mul_f32 v10, 0x3fb8aa3b, v8
    v_mul_f32 v11, 0x3fb8aa3b, v9
    v_exp_f32 v10, v10
    v_exp_f32 v11, v11
    v_add_f32 v12, 1.0, v8
    v_add_f32 v13, 1.0, v9
    v_cmp_lt_f32 vcc, 0, v8
    s_nop 1
    v_cndmask_b32 v10, v10, v12, vcc
    v_cmp_lt_f32 vcc, 0, v9
    s_nop 1
    v_cndmask_b32 v11, v11, v13, vcc
    v_cvt_pk_bf16_f32 v10, v10, v11
    v_lshlrev_b32 v8, 16, v10
    v_and_b32 v9, 0xffff0000, v10
    v_add_f32 v8, 0x358637bd, v8
    v_add_f32 v9, 0x358637bd, v9
    v_cvt_pk_bf16_f32 v196, v8, v9
    v_cvt_pk_bf16_f32 v10, v90, v91
    v_lshlrev_b32 v8, 16, v10
    v_and_b32 v9, 0xffff0000, v10
    v_mul_f32 v10, 0x3fb8aa3b, v8
    v_mul_f32 v11, 0x3fb8aa3b, v9
    v_exp_f32 v10, v10
    v_exp_f32 v11, v11
    v_add_f32 v12, 1.0, v8
    v_add_f32 v13, 1.0, v9
    v_cmp_lt_f32 vcc, 0, v8
    s_nop 1
    v_cndmask_b32 v10, v10, v12, vcc
    v_cmp_lt_f32 vcc, 0, v9
    s_nop 1
    v_cndmask_b32 v11, v11, v13, vcc
    v_cvt_pk_bf16_f32 v10, v10, v11
    v_lshlrev_b32 v8, 16, v10
    v_and_b32 v9, 0xffff0000, v10
    v_add_f32 v8, 0x358637bd, v8
    v_add_f32 v9, 0x358637bd, v9
    v_cvt_pk_bf16_f32 v197, v8, v9
    v_cvt_pk_bf16_f32 v10, v92, v93
    v_lshlrev_b32 v8, 16, v10
    v_and_b32 v9, 0xffff0000, v10
    v_mul_f32 v10, 0x3fb8aa3b, v8
    v_mul_f32 v11, 0x3fb8aa3b, v9
    v_exp_f32 v10, v10
    v_exp_f32 v11, v11
    v_add_f32 v12, 1.0, v8
    v_add_f32 v13, 1.0, v9
    v_cmp_lt_f32 vcc, 0, v8
    s_nop 1
    v_cndmask_b32 v10, v10, v12, vcc
    v_cmp_lt_f32 vcc, 0, v9
    s_nop 1
    v_cndmask_b32 v11, v11, v13, vcc
    v_cvt_pk_bf16_f32 v10, v10, v11
    v_lshlrev_b32 v8, 16, v10
    v_and_b32 v9, 0xffff0000, v10
    v_add_f32 v8, 0x358637bd, v8
    v_add_f32 v9, 0x358637bd, v9
    v_cvt_pk_bf16_f32 v198, v8, v9
    v_cvt_pk_bf16_f32 v10, v94, v95
    v_lshlrev_b32 v8, 16, v10
    v_and_b32 v9, 0xffff0000, v10
    v_mul_f32 v10, 0x3fb8aa3b, v8
    v_mul_f32 v11, 0x3fb8aa3b, v9
    v_exp_f32 v10, v10
    v_exp_f32 v11, v11
    v_add_f32 v12, 1.0, v8
    v_add_f32 v13, 1.0, v9
    v_cmp_lt_f32 vcc, 0, v8
    s_nop 1
    v_cndmask_b32 v10, v10, v12, vcc
    v_cmp_lt_f32 vcc, 0, v9
    s_nop 1
    v_cndmask_b32 v11, v11, v13, vcc
    v_cvt_pk_bf16_f32 v10, v10, v11
    v_lshlrev_b32 v8, 16, v10
    v_and_b32 v9, 0xffff0000, v10
    v_add_f32 v8, 0x358637bd, v8
    v_add_f32 v9, 0x358637bd, v9
    v_cvt_pk_bf16_f32 v199, v8, v9
    buffer_store_dwordx4 v[192:195], v6, s[16:19], s27 offen
    buffer_store_dwordx4 v[196:199], v6, s[16:19], s27 offen offset:1024
    v_cvt_pk_bf16_f32 v10, v96, v97
    v_lshlrev_b32 v8, 16, v10
    v_and_b32 v9, 0xffff0000, v10
    v_mul_f32 v10, 0x3fb8aa3b, v8
    v_mul_f32 v11, 0x3fb8aa3b, v9
    v_exp_f32 v10, v10
    v_exp_f32 v11, v11
    v_add_f32 v12, 1.0, v8
    v_add_f32 v13, 1.0, v9
    v_cmp_lt_f32 vcc, 0, v8
    s_nop 1
    v_cndmask_b32 v10, v10, v12, vcc
    v_cmp_lt_f32 vcc, 0, v9
    s_nop 1
    v_cndmask_b32 v11, v11, v13, vcc
    v_cvt_pk_bf16_f32 v10, v10, v11
    v_lshlrev_b32 v8, 16, v10
    v_and_b32 v9, 0xffff0000, v10
    v_add_f32 v8, 0x358637bd, v8
    v_add_f32 v9, 0x358637bd, v9
    v_cvt_pk_bf16_f32 v160, v8, v9
    v_lshlrev_b32 v8, 16, v160
    v_and_b32 v9, 0xffff0000, v160
    v_add_f32 v200, v200, v8
    v_add_f32 v200, v200, v9
    v_cvt_pk_bf16_f32 v10, v98, v99
    v_lshlrev_b32 v8, 16, v10
    v_and_b32 v9, 0xffff0000, v10
    v_mul_f32 v10, 0x3fb8aa3b, v8
    v_mul_f32 v11, 0x3fb8aa3b, v9
    v_exp_f32 v10, v10
    v_exp_f32 v11, v11
    v_add_f32 v12, 1.0, v8
    v_add_f32 v13, 1.0, v9
    v_cmp_lt_f32 vcc, 0, v8
    s_nop 1
    v_cndmask_b32 v10, v10, v12, vcc
    v_cmp_lt_f32 vcc, 0, v9
    s_nop 1
    v_cndmask_b32 v11, v11, v13, vcc
    v_cvt_pk_bf16_f32 v10, v10, v11
    v_lshlrev_b32 v8, 16, v10
    v_and_b32 v9, 0xffff0000, v10
    v_add_f32 v8, 0x358637bd, v8
    v_add_f32 v9, 0x358637bd, v9
    v_cvt_pk_bf16_f32 v161, v8, v9
    v_lshlrev_b32 v8, 16, v161
    v_and_b32 v9, 0xffff0000, v161
    v_add_f32 v200, v200, v8
    v_add_f32 v200, v200, v9
    v_cvt_pk_bf16_f32 v10, v100, v101
    v_lshlrev_b32 v8, 16, v10
    v_and_b32 v9, 0xffff0000, v10
    v_mul_f32 v10, 0x3fb8aa3b, v8
    v_mul_f32 v11, 0x3fb8aa3b, v9
    v_exp_f32 v10, v10
    v_exp_f32 v11, v11
    v_add_f32 v12, 1.0, v8
    v_add_f32 v13, 1.0, v9
    v_cmp_lt_f32 vcc, 0, v8
    s_nop 1
    v_cndmask_b32 v10, v10, v12, vcc
    v_cmp_lt_f32 vcc, 0, v9
    s_nop 1
    v_cndmask_b32 v11, v11, v13, vcc
    v_cvt_pk_bf16_f32 v10, v10, v11
    v_lshlrev_b32 v8, 16, v10
    v_and_b32 v9, 0xffff0000, v10
    v_add_f32 v8, 0x358637bd, v8
    v_add_f32 v9, 0x358637bd, v9
    v_cvt_pk_bf16_f32 v162, v8, v9
    v_lshlrev_b32 v8, 16, v162
    v_and_b32 v9, 0xffff0000, v162
    v_add_f32 v200, v200, v8
    v_add_f32 v200, v200, v9
    v_cvt_pk_bf16_f32 v10, v102, v103
    v_lshlrev_b32 v8, 16, v10
    v_and_b32 v9, 0xffff0000, v10
    v_mul_f32 v10, 0x3fb8aa3b, v8
    v_mul_f32 v11, 0x3fb8aa3b, v9
    v_exp_f32 v10, v10
    v_exp_f32 v11, v11
    v_add_f32 v12, 1.0, v8
    v_add_f32 v13, 1.0, v9
    v_cmp_lt_f32 vcc, 0, v8
    s_nop 1
    v_cndmask_b32 v10, v10, v12, vcc
    v_cmp_lt_f32 vcc, 0, v9
    s_nop 1
    v_cndmask_b32 v11, v11, v13, vcc
    v_cvt_pk_bf16_f32 v10, v10, v11
    v_lshlrev_b32 v8, 16, v10
    v_and_b32 v9, 0xffff0000, v10
    v_add_f32 v8, 0x358637bd, v8
    v_add_f32 v9, 0x358637bd, v9
    v_cvt_pk_bf16_f32 v163, v8, v9
    v_lshlrev_b32 v8, 16, v163
    v_and_b32 v9, 0xffff0000, v163
    v_add_f32 v200, v200, v8
    v_add_f32 v200, v200, v9
    v_cvt_pk_bf16_f32 v10, v104, v105
    v_lshlrev_b32 v8, 16, v10
    v_and_b32 v9, 0xffff0000, v10
    v_mul_f32 v10, 0x3fb8aa3b, v8
    v_mul_f32 v11, 0x3fb8aa3b, v9
    v_exp_f32 v10, v10
    v_exp_f32 v11, v11
    v_add_f32 v12, 1.0, v8
    v_add_f32 v13, 1.0, v9
    v_cmp_lt_f32 vcc, 0, v8
    s_nop 1
    v_cndmask_b32 v10, v10, v12, vcc
    v_cmp_lt_f32 vcc, 0, v9
    s_nop 1
    v_cndmask_b32 v11, v11, v13, vcc
    v_cvt_pk_bf16_f32 v10, v10, v11
    v_lshlrev_b32 v8, 16, v10
    v_and_b32 v9, 0xffff0000, v10
    v_add_f32 v8, 0x358637bd, v8
    v_add_f32 v9, 0x358637bd, v9
    v_cvt_pk_bf16_f32 v164, v8, v9
    v_lshlrev_b32 v8, 16, v164
    v_and_b32 v9, 0xffff0000, v164
    v_add_f32 v200, v200, v8
    v_add_f32 v200, v200, v9
    v_cvt_pk_bf16_f32 v10, v106, v107
    v_lshlrev_b32 v8, 16, v10
    v_and_b32 v9, 0xffff0000, v10
    v_mul_f32 v10, 0x3fb8aa3b, v8
    v_mul_f32 v11, 0x3fb8aa3b, v9
    v_exp_f32 v10, v10
    v_exp_f32 v11, v11
    v_add_f32 v12, 1.0, v8
    v_add_f32 v13, 1.0, v9
    v_cmp_lt_f32 vcc, 0, v8
    s_nop 1
    v_cndmask_b32 v10, v10, v12, vcc
    v_cmp_lt_f32 vcc, 0, v9
    s_nop 1
    v_cndmask_b32 v11, v11, v13, vcc
    v_cvt_pk_bf16_f32 v10, v10, v11
    v_lshlrev_b32 v8, 16, v10
    v_and_b32 v9, 0xffff0000, v10
    v_add_f32 v8, 0x358637bd, v8
    v_add_f32 v9, 0x358637bd, v9
    v_cvt_pk_bf16_f32 v165, v8, v9
    v_lshlrev_b32 v8, 16, v165
    v_and_b32 v9, 0xffff0000, v165
    v_add_f32 v200, v200, v8
    v_add_f32 v200, v200, v9
    v_cvt_pk_bf16_f32 v10, v108, v109
    v_lshlrev_b32 v8, 16, v10
    v_and_b32 v9, 0xffff0000, v10
    v_mul_f32 v10, 0x3fb8aa3b, v8
    v_mul_f32 v11, 0x3fb8aa3b, v9
    v_exp_f32 v10, v10
    v_exp_f32 v11, v11
    v_add_f32 v12, 1.0, v8
    v_add_f32 v13, 1.0, v9
    v_cmp_lt_f32 vcc, 0, v8
    s_nop 1
    v_cndmask_b32 v10, v10, v12, vcc
    v_cmp_lt_f32 vcc, 0, v9
    s_nop 1
    v_cndmask_b32 v11, v11, v13, vcc
    v_cvt_pk_bf16_f32 v10, v10, v11
    v_lshlrev_b32 v8, 16, v10
    v_and_b32 v9, 0xffff0000, v10
    v_add_f32 v8, 0x358637bd, v8
    v_add_f32 v9, 0x358637bd, v9
    v_cvt_pk_bf16_f32 v166, v8, v9
    v_lshlrev_b32 v8, 16, v166
    v_and_b32 v9, 0xffff0000, v166
    v_add_f32 v200, v200, v8
    v_add_f32 v200, v200, v9
    v_cvt_pk_bf16_f32 v10, v110, v111
    v_lshlrev_b32 v8, 16, v10
    v_and_b32 v9, 0xffff0000, v10
    v_mul_f32 v10, 0x3fb8aa3b, v8
    v_mul_f32 v11, 0x3fb8aa3b, v9
    v_exp_f32 v10, v10
    v_exp_f32 v11, v11
    v_add_f32 v12, 1.0, v8
    v_add_f32 v13, 1.0, v9
    v_cmp_lt_f32 vcc, 0, v8
    s_nop 1
    v_cndmask_b32 v10, v10, v12, vcc
    v_cmp_lt_f32 vcc, 0, v9
    s_nop 1
    v_cndmask_b32 v11, v11, v13, vcc
    v_cvt_pk_bf16_f32 v10, v10, v11
    v_lshlrev_b32 v8, 16, v10
    v_and_b32 v9, 0xffff0000, v10
    v_add_f32 v8, 0x358637bd, v8
    v_add_f32 v9, 0x358637bd, v9
    v_cvt_pk_bf16_f32 v167, v8, v9
    v_lshlrev_b32 v8, 16, v167
    v_and_b32 v9, 0xffff0000, v167
    v_add_f32 v200, v200, v8
    v_add_f32 v200, v200, v9
    v_cvt_pk_bf16_f32 v10, v112, v113
    v_lshlrev_b32 v8, 16, v10
    v_and_b32 v9, 0xffff0000, v10
    v_mul_f32 v10, 0x3fb8aa3b, v8
    v_mul_f32 v11, 0x3fb8aa3b, v9
    v_exp_f32 v10, v10
    v_exp_f32 v11, v11
    v_add_f32 v12, 1.0, v8
    v_add_f32 v13, 1.0, v9
    v_cmp_lt_f32 vcc, 0, v8
    s_nop 1
    v_cndmask_b32 v10, v10, v12, vcc
    v_cmp_lt_f32 vcc, 0, v9
    s_nop 1
    v_cndmask_b32 v11, v11, v13, vcc
    v_cvt_pk_bf16_f32 v10, v10, v11
    v_lshlrev_b32 v8, 16, v10
    v_and_b32 v9, 0xffff0000, v10
    v_add_f32 v8, 0x358637bd, v8
    v_add_f32 v9, 0x358637bd, v9
    v_cvt_pk_bf16_f32 v168, v8, v9
    v_lshlrev_b32 v8, 16, v168
    v_and_b32 v9, 0xffff0000, v168
    v_add_f32 v200, v200, v8
    v_add_f32 v200, v200, v9
    v_cvt_pk_bf16_f32 v10, v114, v115
    v_lshlrev_b32 v8, 16, v10
    v_and_b32 v9, 0xffff0000, v10
    v_mul_f32 v10, 0x3fb8aa3b, v8
    v_mul_f32 v11, 0x3fb8aa3b, v9
    v_exp_f32 v10, v10
    v_exp_f32 v11, v11
    v_add_f32 v12, 1.0, v8
    v_add_f32 v13, 1.0, v9
    v_cmp_lt_f32 vcc, 0, v8
    s_nop 1
    v_cndmask_b32 v10, v10, v12, vcc
    v_cmp_lt_f32 vcc, 0, v9
    s_nop 1
    v_cndmask_b32 v11, v11, v13, vcc
    v_cvt_pk_bf16_f32 v10, v10, v11
    v_lshlrev_b32 v8, 16, v10
    v_and_b32 v9, 0xffff0000, v10
    v_add_f32 v8, 0x358637bd, v8
    v_add_f32 v9, 0x358637bd, v9
    v_cvt_pk_bf16_f32 v169, v8, v9
    v_lshlrev_b32 v8, 16, v169
    v_and_b32 v9, 0xffff0000, v169
    v_add_f32 v200, v200, v8
    v_add_f32 v200, v200, v9
    v_cvt_pk_bf16_f32 v10, v116, v117
    v_lshlrev_b32 v8, 16, v10
    v_and_b32 v9, 0xffff0000, v10
    v_mul_f32 v10, 0x3fb8aa3b, v8
    v_mul_f32 v11, 0x3fb8aa3b, v9
    v_exp_f32 v10, v10
    v_exp_f32 v11, v11
    v_add_f32 v12, 1.0, v8
    v_add_f32 v13, 1.0, v9
    v_cmp_lt_f32 vcc, 0, v8
    s_nop 1
    v_cndmask_b32 v10, v10, v12, vcc
    v_cmp_lt_f32 vcc, 0, v9
    s_nop 1
    v_cndmask_b32 v11, v11, v13, vcc
    v_cvt_pk_bf16_f32 v10, v10, v11
    v_lshlrev_b32 v8, 16, v10
    v_and_b32 v9, 0xffff0000, v10
    v_add_f32 v8, 0x358637bd, v8
    v_add_f32 v9, 0x358637bd, v9
    v_cvt_pk_bf16_f32 v170, v8, v9
    v_lshlrev_b32 v8, 16, v170
    v_and_b32 v9, 0xffff0000, v170
    v_add_f32 v200, v200, v8
    v_add_f32 v200, v200, v9
    v_cvt_pk_bf16_f32 v10, v118, v119
    v_lshlrev_b32 v8, 16, v10
    v_and_b32 v9, 0xffff0000, v10
    v_mul_f32 v10, 0x3fb8aa3b, v8
    v_mul_f32 v11, 0x3fb8aa3b, v9
    v_exp_f32 v10, v10
    v_exp_f32 v11, v11
    v_add_f32 v12, 1.0, v8
    v_add_f32 v13, 1.0, v9
    v_cmp_lt_f32 vcc, 0, v8
    s_nop 1
    v_cndmask_b32 v10, v10, v12, vcc
    v_cmp_lt_f32 vcc, 0, v9
    s_nop 1
    v_cndmask_b32 v11, v11, v13, vcc
    v_cvt_pk_bf16_f32 v10, v10, v11
    v_lshlrev_b32 v8, 16, v10
    v_and_b32 v9, 0xffff0000, v10
    v_add_f32 v8, 0x358637bd, v8
    v_add_f32 v9, 0x358637bd, v9
    v_cvt_pk_bf16_f32 v171, v8, v9
    v_lshlrev_b32 v8, 16, v171
    v_and_b32 v9, 0xffff0000, v171
    v_add_f32 v200, v200, v8
    v_add_f32 v200, v200, v9
    v_cvt_pk_bf16_f32 v10, v120, v121
    v_lshlrev_b32 v8, 16, v10
    v_and_b32 v9, 0xffff0000, v10
    v_mul_f32 v10, 0x3fb8aa3b, v8
    v_mul_f32 v11, 0x3fb8aa3b, v9
    v_exp_f32 v10, v10
    v_exp_f32 v11, v11
    v_add_f32 v12, 1.0, v8
    v_add_f32 v13, 1.0, v9
    v_cmp_lt_f32 vcc, 0, v8
    s_nop 1
    v_cndmask_b32 v10, v10, v12, vcc
    v_cmp_lt_f32 vcc, 0, v9
    s_nop 1
    v_cndmask_b32 v11, v11, v13, vcc
    v_cvt_pk_bf16_f32 v10, v10, v11
    v_lshlrev_b32 v8, 16, v10
    v_and_b32 v9, 0xffff0000, v10
    v_add_f32 v8, 0x358637bd, v8
    v_add_f32 v9, 0x358637bd, v9
    v_cvt_pk_bf16_f32 v172, v8, v9
    v_lshlrev_b32 v8, 16, v172
    v_and_b32 v9, 0xffff0000, v172
    v_add_f32 v200, v200, v8
    v_add_f32 v200, v200, v9
    v_cvt_pk_bf16_f32 v10, v122, v123
    v_lshlrev_b32 v8, 16, v10
    v_and_b32 v9, 0xffff0000, v10
    v_mul_f32 v10, 0x3fb8aa3b, v8
    v_mul_f32 v11, 0x3fb8aa3b, v9
    v_exp_f32 v10, v10
    v_exp_f32 v11, v11
    v_add_f32 v12, 1.0, v8
    v_add_f32 v13, 1.0, v9
    v_cmp_lt_f32 vcc, 0, v8
    s_nop 1
    v_cndmask_b32 v10, v10, v12, vcc
    v_cmp_lt_f32 vcc, 0, v9
    s_nop 1
    v_cndmask_b32 v11, v11, v13, vcc
    v_cvt_pk_bf16_f32 v10, v10, v11
    v_lshlrev_b32 v8, 16, v10
    v_and_b32 v9, 0xffff0000, v10
    v_add_f32 v8, 0x358637bd, v8
    v_add_f32 v9, 0x358637bd, v9
    v_cvt_pk_bf16_f32 v173, v8, v9
    v_lshlrev_b32 v8, 16, v173
    v_and_b32 v9, 0xffff0000, v173
    v_add_f32 v200, v200, v8
    v_add_f32 v200, v200, v9
    v_cvt_pk_bf16_f32 v10, v124, v125
    v_lshlrev_b32 v8, 16, v10
    v_and_b32 v9, 0xffff0000, v10
    v_mul_f32 v10, 0x3fb8aa3b, v8
    v_mul_f32 v11, 0x3fb8aa3b, v9
    v_exp_f32 v10, v10
    v_exp_f32 v11, v11
    v_add_f32 v12, 1.0, v8
    v_add_f32 v13, 1.0, v9
    v_cmp_lt_f32 vcc, 0, v8
    s_nop 1
    v_cndmask_b32 v10, v10, v12, vcc
    v_cmp_lt_f32 vcc, 0, v9
    s_nop 1
    v_cndmask_b32 v11, v11, v13, vcc
    v_cvt_pk_bf16_f32 v10, v10, v11
    v_lshlrev_b32 v8, 16, v10
    v_and_b32 v9, 0xffff0000, v10
    v_add_f32 v8, 0x358637bd, v8
    v_add_f32 v9, 0x358637bd, v9
    v_cvt_pk_bf16_f32 v174, v8, v9
    v_lshlrev_b32 v8, 16, v174
    v_and_b32 v9, 0xffff0000, v174
    v_add_f32 v200, v200, v8
    v_add_f32 v200, v200, v9
    v_cvt_pk_bf16_f32 v10, v126, v127
    v_lshlrev_b32 v8, 16, v10
    v_and_b32 v9, 0xffff0000, v10
    v_mul_f32 v10, 0x3fb8aa3b, v8
    v_mul_f32 v11, 0x3fb8aa3b, v9
    v_exp_f32 v10, v10
    v_exp_f32 v11, v11
    v_add_f32 v12, 1.0, v8
    v_add_f32 v13, 1.0, v9
    v_cmp_lt_f32 vcc, 0, v8
    s_nop 1
    v_cndmask_b32 v10, v10, v12, vcc
    v_cmp_lt_f32 vcc, 0, v9
    s_nop 1
    v_cndmask_b32 v11, v11, v13, vcc
    v_cvt_pk_bf16_f32 v10, v10, v11
    v_lshlrev_b32 v8, 16, v10
    v_and_b32 v9, 0xffff0000, v10
    v_add_f32 v8, 0x358637bd, v8
    v_add_f32 v9, 0x358637bd, v9
    v_cvt_pk_bf16_f32 v175, v8, v9
    v_lshlrev_b32 v8, 16, v175
    v_and_b32 v9, 0xffff0000, v175
    v_add_f32 v200, v200, v8
    v_add_f32 v200, v200, v9
    v_cvt_pk_bf16_f32 v176, v128, v129
    v_cvt_pk_bf16_f32 v177, v130, v131
    v_cvt_pk_bf16_f32 v178, v132, v133
    v_cvt_pk_bf16_f32 v179, v134, v135
    v_cvt_pk_bf16_f32 v180, v136, v137
    v_cvt_pk_bf16_f32 v181, v138, v139
    v_cvt_pk_bf16_f32 v182, v140, v141
    v_cvt_pk_bf16_f32 v183, v142, v143
    v_cvt_pk_bf16_f32 v184, v144, v145
    v_cvt_pk_bf16_f32 v185, v146, v147
    v_cvt_pk_bf16_f32 v186, v148, v149
    v_cvt_pk_bf16_f32 v187, v150, v151
    v_cvt_pk_bf16_f32 v188, v152, v153
    v_cvt_pk_bf16_f32 v189, v154, v155
    v_cvt_pk_bf16_f32 v190, v156, v157
    v_cvt_pk_bf16_f32 v191, v158, v159
    s_nop 1
    v_mfma_f32_32x32x16_bf16 v[208:223], v[160:163], v[176:179], 0
    v_mfma_f32_32x32x16_bf16 v[208:223], v[164:167], v[180:183], v[208:223]
    v_mfma_f32_32x32x16_bf16 v[208:223], v[168:171], v[184:187], v[208:223]
    v_mfma_f32_32x32x16_bf16 v[208:223], v[172:175], v[188:191], v[208:223]
    v_mov_b32 v201, v200
    s_nop 1
    v_permlane32_swap_b32 v200, v201
    v_add_f32 v200, v200, v201
    s_nop 15
    s_barrier
    s_lshl_b32 s27, s26, 13
    v_lshlrev_b32 v7, 2, v0
    v_add_u32 v7, s27, v7
    v_add_u32 v6, s27, v6
    s_cmp_eq_u32 s25, 0
    s_cbranch_scc1 qkv_kernel_rd4
    ds_write_b128 v6, v[208:211] offset:0
    ds_write_b128 v6, v[212:215] offset:1024
    ds_write_b128 v6, v[216:219] offset:2048
    ds_write_b128 v6, v[220:223] offset:3072
    ds_write_b32 v7, v200 offset:4096
    s_waitcnt lgkmcnt(0)
    s_barrier
    s_branch qkv_kernel_exit1
qkv_kernel_rd4:
    s_barrier
    ds_read_b128 v[160:163], v6 offset:0
    ds_read_b128 v[164:167], v6 offset:1024
    ds_read_b128 v[168:171], v6 offset:2048
    ds_read_b128 v[172:175], v6 offset:3072
    ds_read_b32 v201, v7 offset:4096
    s_add_u32 s16, s10, 0x2000000
    s_addc_u32 s17, s11, 0
    s_and_b32 s17, s17, 0xffff
    s_mov_b32 s18, 0x200000
    s_mov_b32 s19, 0x20000
    s_add_u32 s36, s10, 0x2200000
    s_addc_u32 s37, s11, 0
    s_and_b32 s37, s37, 0xffff
    s_mov_b32 s38, 0x10000
    s_mov_b32 s39, 0x20000
    s_lshl_b32 s27, s23, 5
    s_add_u32 s27, s27, s29
    s_lshl_b32 s30, s27, 7
    s_lshl_b32 s27, s27, 12
    v_lshlrev_b32 v6, 4, v0
    v_lshlrev_b32 v7, 2, v0
    s_waitcnt lgkmcnt(0)
    v_add_f32 v208, v208, v160
    v_add_f32 v209, v209, v161
    v_add_f32 v210, v210, v162
    v_add_f32 v211, v211, v163
    v_add_f32 v212, v212, v164
    v_add_f32 v213, v213, v165
    v_add_f32 v214, v214, v166
    v_add_f32 v215, v215, v167
    v_add_f32 v216, v216, v168
    v_add_f32 v217, v217, v169
    v_add_f32 v218, v218, v170
    v_add_f32 v219, v219, v171
    v_add_f32 v220, v220, v172
    v_add_f32 v221, v221, v173
    v_add_f32 v222, v222, v174
    v_add_f32 v223, v223, v175
    v_add_f32 v200, v200, v201
    buffer_store_dwordx4 v[208:211], v6, s[16:19], s27 offen offset:0
    buffer_store_dwordx4 v[212:215], v6, s[16:19], s27 offen offset:1024
    buffer_store_dwordx4 v[216:219], v6, s[16:19], s27 offen offset:2048
    buffer_store_dwordx4 v[220:223], v6, s[16:19], s27 offen offset:3072
    v_cmp_gt_u32 vcc, 32, v0
    s_and_saveexec_b64 s[34:35], vcc
    buffer_store_dword v200, v7, s[36:39], s30 offen
qkv_kernel_exit1:
    s_endpgm
.section .rodata,"a"
.p2align 6
.amdhsa_kernel qkv_kernel
  .amdhsa_next_free_vgpr 224
  .amdhsa_next_free_sgpr 96
  .amdhsa_accum_offset 224
  .amdhsa_group_segment_fixed_size 0
  .amdhsa_kernarg_size 88
  .amdhsa_user_sgpr_count 2
  .amdhsa_user_sgpr_kernarg_segment_ptr 1
  .amdhsa_system_sgpr_workgroup_id_x 1
.end_amdhsa_kernel

.text
.globl ko_kernel
.p2align 8
.type ko_kernel,@function
ko_kernel:
    s_cmp_ge_u32 s2, 256
    s_cbranch_scc1 ko_kernel_exit1
    s_load_dwordx2 s[10:11], s[0:1], 80
    v_lshrrev_b32 v1, 6, v0
    v_and_b32 v0, 63, v0
    s_nop 0
    v_readfirstlane_b32 s20, v1
    s_and_b32 s21, s2, 31
    s_lshr_b32 s22, s2, 5
    v_lshlrev_b32 v2, 4, v0
    v_and_b32 v3, 31, v0
    v_lshlrev_b32 v3, 2, v3
    s_waitcnt lgkmcnt(0)
    s_add_u32 s12, s10, 0x2000000
    s_addc_u32 s13, s11, 0
    s_and_b32 s13, s13, 0xffff
    s_mov_b32 s14, 0x200000
    s_mov_b32 s15, 0x20000
    s_add_u32 s16, s10, 0x2200000
    s_addc_u32 s17, s11, 0
    s_and_b32 s17, s17, 0xffff
    s_mov_b32 s18, 0x10000
    s_mov_b32 s19, 0x20000
    s_add_u32 s24, s10, 0xc00000
    s_addc_u32 s25, s11, 0
    s_and_b32 s25, s25, 0xffff
    s_mov_b32 s26, 0x400000
    s_mov_b32 s27, 0x20000
    s_add_u32 s28, s10, 0x1000000
    s_addc_u32 s29, s11, 0
    s_and_b32 s29, s29, 0xffff
    s_mov_b32 s30, 0x400000
    s_mov_b32 s31, 0x20000
    s_lshl_b32 s23, s20, 2
    s_lshl_b32 s23, s23, 5
    s_add_u32 s23, s23, s21
    s_lshl_b32 s32, s23, 7
    s_lshl_b32 s23, s23, 12
    buffer_load_dwordx4 v[16:19], v2, s[12:15], s23 offen offset:0
    buffer_load_dwordx4 v[20:23], v2, s[12:15], s23 offen offset:1024
    buffer_load_dwordx4 v[24:27], v2, s[12:15], s23 offen offset:2048
    buffer_load_dwordx4 v[28:31], v2, s[12:15], s23 offen offset:3072
    buffer_load_dword v96, v3, s[16:19], s32 offen
    s_add_u32 s23, s23, 131072
    s_add_u32 s32, s32, 4096
    buffer_load_dwordx4 v[32:35], v2, s[12:15], s23 offen offset:0
    buffer_load_dwordx4 v[36:39], v2, s[12:15], s23 offen offset:1024
    buffer_load_dwordx4 v[40:43], v2, s[12:15], s23 offen offset:2048
    buffer_load_dwordx4 v[44:47], v2, s[12:15], s23 offen offset:3072
    buffer_load_dword v97, v3, s[16:19], s32 offen
    s_add_u32 s23, s23, 131072
    s_add_u32 s32, s32, 4096
    buffer_load_dwordx4 v[48:51], v2, s[12:15], s23 offen offset:0
    buffer_load_dwordx4 v[52:55], v2, s[12:15], s23 offen offset:1024
    buffer_load_dwordx4 v[56:59], v2, s[12:15], s23 offen offset:2048
    buffer_load_dwordx4 v[60:63], v2, s[12:15], s23 offen offset:3072
    buffer_load_dword v98, v3, s[16:19], s32 offen
    s_add_u32 s23, s23, 131072
    s_add_u32 s32, s32, 4096
    buffer_load_dwordx4 v[64:67], v2, s[12:15], s23 offen offset:0
    buffer_load_dwordx4 v[68:71], v2, s[12:15], s23 offen offset:1024
    buffer_load_dwordx4 v[72:75], v2, s[12:15], s23 offen offset:2048
    buffer_load_dwordx4 v[76:79], v2, s[12:15], s23 offen offset:3072
    buffer_load_dword v99, v3, s[16:19], s32 offen
    s_add_u32 s23, s23, 131072
    s_add_u32 s32, s32, 4096
    s_lshl_b32 s33, s22, 3
    s_lshl_b32 s34, s20, 1
    s_add_u32 s33, s33, s34
    s_lshl_b32 s33, s33, 16
    s_lshl_b32 s34, s21, 11
    s_add_u32 s33, s33, s34
    s_add_u32 s34, s33, 65536
    buffer_load_dwordx4 v[104:107], v2, s[24:27], s33 offen offset:0
    buffer_load_dwordx4 v[108:111], v2, s[24:27], s33 offen offset:1024
    buffer_load_dwordx4 v[112:115], v2, s[24:27], s34 offen offset:0
    buffer_load_dwordx4 v[116:119], v2, s[24:27], s34 offen offset:1024
    s_waitcnt vmcnt(4)
    v_add_f32 v16, v16, v32
    v_add_f32 v48, v48, v64
    v_add_f32 v16, v16, v48
    v_add_f32 v17, v17, v33
    v_add_f32 v49, v49, v65
    v_add_f32 v17, v17, v49
    v_add_f32 v18, v18, v34
    v_add_f32 v50, v50, v66
    v_add_f32 v18, v18, v50
    v_add_f32 v19, v19, v35
    v_add_f32 v51, v51, v67
    v_add_f32 v19, v19, v51
    v_add_f32 v20, v20, v36
    v_add_f32 v52, v52, v68
    v_add_f32 v20, v20, v52
    v_add_f32 v21, v21, v37
    v_add_f32 v53, v53, v69
    v_add_f32 v21, v21, v53
    v_add_f32 v22, v22, v38
    v_add_f32 v54, v54, v70
    v_add_f32 v22, v22, v54
    v_add_f32 v23, v23, v39
    v_add_f32 v55, v55, v71
    v_add_f32 v23, v23, v55
    v_add_f32 v24, v24, v40
    v_add_f32 v56, v56, v72
    v_add_f32 v24, v24, v56
    v_add_f32 v25, v25, v41
    v_add_f32 v57, v57, v73
    v_add_f32 v25, v25, v57
    v_add_f32 v26, v26, v42
    v_add_f32 v58, v58, v74
    v_add_f32 v26, v26, v58
    v_add_f32 v27, v27, v43
    v_add_f32 v59, v59, v75
    v_add_f32 v27, v27, v59
    v_add_f32 v28, v28, v44
    v_add_f32 v60, v60, v76
    v_add_f32 v28, v28, v60
    v_add_f32 v29, v29, v45
    v_add_f32 v61, v61, v77
    v_add_f32 v29, v29, v61
    v_add_f32 v30, v30, v46
    v_add_f32 v62, v62, v78
    v_add_f32 v30, v30, v62
    v_add_f32 v31, v31, v47
    v_add_f32 v63, v63, v79
    v_add_f32 v31, v31, v63
    v_add_f32 v96, v96, v97
    v_add_f32 v98, v98, v99
    v_add_f32 v96, v96, v98
    s_lshl_b32 s35, s20, 12
    v_add_u32 v4, s35, v2
    s_lshl_b32 s35, s20, 7
    v_add_u32 v5, s35, v3
    ds_write_b128 v4, v[16:19] offset:0
    ds_write_b128 v4, v[20:23] offset:1024
    ds_write_b128 v4, v[24:27] offset:2048
    ds_write_b128 v4, v[28:31] offset:3072
    ds_write_b32 v5, v96 offset:16384
    s_waitcnt lgkmcnt(0)
    s_barrier
    ds_read_b128 v[16:19], v2 offset:0
    ds_read_b128 v[20:23], v2 offset:1024
    ds_read_b128 v[24:27], v2 offset:2048
    ds_read_b128 v[28:31], v2 offset:3072
    ds_read_b32 v96, v3 offset:16384
    ds_read_b128 v[32:35], v2 offset:4096
    ds_read_b128 v[36:39], v2 offset:5120
    ds_read_b128 v[40:43], v2 offset:6144
    ds_read_b128 v[44:47], v2 offset:7168
    ds_read_b32 v97, v3 offset:16512
    ds_read_b128 v[48:51], v2 offset:8192
    ds_read_b128 v[52:55], v2 offset:9216
    ds_read_b128 v[56:59], v2 offset:10240
    ds_read_b128 v[60:63], v2 offset:11264
    ds_read_b32 v98, v3 offset:16640
    ds_read_b128 v[64:67], v2 offset:12288
    ds_read_b128 v[68:71], v2 offset:13312
    ds_read_b128 v[72:75], v2 offset:14336
    ds_read_b128 v[76:79], v2 offset:15360
    ds_read_b32 v99, v3 offset:16768
    s_waitcnt lgkmcnt(0)
    v_add_f32 v16, v16, v32
    v_add_f32 v48, v48, v64
    v_add_f32 v16, v16, v48
    v_add_f32 v17, v17, v33
    v_add_f32 v49, v49, v65
    v_add_f32 v17, v17, v49
    v_add_f32 v18, v18, v34
    v_add_f32 v50, v50, v66
    v_add_f32 v18, v18, v50
    v_add_f32 v19, v19, v35
    v_add_f32 v51, v51, v67
    v_add_f32 v19, v19, v51
    v_add_f32 v20, v20, v36
    v_add_f32 v52, v52, v68
    v_add_f32 v20, v20, v52
    v_add_f32 v21, v21, v37
    v_add_f32 v53, v53, v69
    v_add_f32 v21, v21, v53
    v_add_f32 v22, v22, v38
    v_add_f32 v54, v54, v70
    v_add_f32 v22, v22, v54
    v_add_f32 v23, v23, v39
    v_add_f32 v55, v55, v71
    v_add_f32 v23, v23, v55
    v_add_f32 v24, v24, v40
    v_add_f32 v56, v56, v72
    v_add_f32 v24, v24, v56
    v_add_f32 v25, v25, v41
    v_add_f32 v57, v57, v73
    v_add_f32 v25, v25, v57
    v_add_f32 v26, v26, v42
    v_add_f32 v58, v58, v74
    v_add_f32 v26, v26, v58
    v_add_f32 v27, v27, v43
    v_add_f32 v59, v59, v75
    v_add_f32 v27, v27, v59
    v_add_f32 v28, v28, v44
    v_add_f32 v60, v60, v76
    v_add_f32 v28, v28, v60
    v_add_f32 v29, v29, v45
    v_add_f32 v61, v61, v77
    v_add_f32 v29, v29, v61
    v_add_f32 v30, v30, v46
    v_add_f32 v62, v62, v78
    v_add_f32 v30, v30, v62
    v_add_f32 v31, v31, v47
    v_add_f32 v63, v63, v79
    v_add_f32 v31, v31, v63
    v_cvt_pk_bf16_f32 v80, v16, v17
    v_cvt_pk_bf16_f32 v81, v18, v19
    v_cvt_pk_bf16_f32 v82, v20, v21
    v_cvt_pk_bf16_f32 v83, v22, v23
    v_cvt_pk_bf16_f32 v84, v24, v25
    v_cvt_pk_bf16_f32 v85, v26, v27
    v_cvt_pk_bf16_f32 v86, v28, v29
    v_cvt_pk_bf16_f32 v87, v30, v31
    v_add_f32 v96, v96, v97
    v_add_f32 v98, v98, v99
    v_add_f32 v96, v96, v98
    v_cvt_pk_bf16_f32 v96, v96, v96
    v_lshlrev_b32 v96, 16, v96
    ds_write_b32 v5, v96 offset:17408
    v_lshrrev_b32 v6, 5, v0
    v_lshlrev_b32 v6, 4, v6
    s_lshl_b32 s35, s20, 7
    v_add_u32 v6, s35, v6
    s_waitcnt lgkmcnt(0)
    ds_read_b128 v[16:19], v6 offset:17408
    ds_read_b128 v[20:23], v6 offset:17440
    ds_read_b128 v[24:27], v6 offset:17472
    ds_read_b128 v[28:31], v6 offset:17504
    s_waitcnt lgkmcnt(0)
    v_cvt_pk_bf16_f32 v88, v16, v17
    v_cvt_pk_bf16_f32 v89, v18, v19
    v_cvt_pk_bf16_f32 v90, v20, v21
    v_cvt_pk_bf16_f32 v91, v22, v23
    v_cvt_pk_bf16_f32 v92, v24, v25
    v_cvt_pk_bf16_f32 v93, v26, v27
    v_cvt_pk_bf16_f32 v94, v28, v29
    v_cvt_pk_bf16_f32 v95, v30, v31
    s_waitcnt vmcnt(0)
    s_nop 1
    v_mfma_f32_32x32x16_bf16 v[16:31], v[80:83], v[104:107], 0
    v_mfma_f32_32x32x16_bf16 v[48:63], v[88:91], v[104:107], 0
    v_mfma_f32_32x32x16_bf16 v[16:31], v[84:87], v[108:111], v[16:31]
    v_mfma_f32_32x32x16_bf16 v[48:63], v[92:95], v[108:111], v[48:63]
    v_mfma_f32_32x32x16_bf16 v[32:47], v[80:83], v[112:115], 0
    v_mfma_f32_32x32x16_bf16 v[64:79], v[88:91], v[112:115], 0
    v_mfma_f32_32x32x16_bf16 v[32:47], v[84:87], v[116:119], v[32:47]
    v_mfma_f32_32x32x16_bf16 v[64:79], v[92:95], v[116:119], v[64:79]
    s_nop 15
    v_cvt_pk_bf16_f32 v8, v48, v48
    v_lshlrev_b32 v8, 16, v8
    v_add_f32 v8, 0x358637bd, v8
    v_cvt_pk_bf16_f32 v8, v8, v8
    v_lshlrev_b32 v8, 16, v8
    v_rcp_f32 v9, v8
    s_nop 0
    v_cvt_pk_bf16_f32 v10, v16, v17
    v_and_b32 v11, 0xffff0000, v10
    v_lshlrev_b32 v10, 16, v10
    v_mul_f32 v12, v10, v9
    v_mul_f32 v13, v11, v9
    v_fma_f32 v14, -v12, v8, v10
    v_fma_f32 v15, -v13, v8, v11
    v_fma_f32 v12, v14, v9, v12
    v_fma_f32 v13, v15, v9, v13
    v_cvt_pk_bf16_f32 v120, v12, v13
    v_cvt_pk_bf16_f32 v10, v18, v19
    v_and_b32 v11, 0xffff0000, v10
    v_lshlrev_b32 v10, 16, v10
    v_mul_f32 v12, v10, v9
    v_mul_f32 v13, v11, v9
    v_fma_f32 v14, -v12, v8, v10
    v_fma_f32 v15, -v13, v8, v11
    v_fma_f32 v12, v14, v9, v12
    v_fma_f32 v13, v15, v9, v13
    v_cvt_pk_bf16_f32 v121, v12, v13
    v_cvt_pk_bf16_f32 v10, v20, v21
    v_and_b32 v11, 0xffff0000, v10
    v_lshlrev_b32 v10, 16, v10
    v_mul_f32 v12, v10, v9
    v_mul_f32 v13, v11, v9
    v_fma_f32 v14, -v12, v8, v10
    v_fma_f32 v15, -v13, v8, v11
    v_fma_f32 v12, v14, v9, v12
    v_fma_f32 v13, v15, v9, v13
    v_cvt_pk_bf16_f32 v122, v12, v13
    v_cvt_pk_bf16_f32 v10, v22, v23
    v_and_b32 v11, 0xffff0000, v10
    v_lshlrev_b32 v10, 16, v10
    v_mul_f32 v12, v10, v9
    v_mul_f32 v13, v11, v9
    v_fma_f32 v14, -v12, v8, v10
    v_fma_f32 v15, -v13, v8, v11
    v_fma_f32 v12, v14, v9, v12
    v_fma_f32 v13, v15, v9, v13
    v_cvt_pk_bf16_f32 v123, v12, v13
    v_cvt_pk_bf16_f32 v10, v24, v25
    v_and_b32 v11, 0xffff0000, v10
    v_lshlrev_b32 v10, 16, v10
    v_mul_f32 v12, v10, v9
    v_mul_f32 v13, v11, v9
    v_fma_f32 v14, -v12, v8, v10
    v_fma_f32 v15, -v13, v8, v11
    v_fma_f32 v12, v14, v9, v12
    v_fma_f32 v13, v15, v9, v13
    v_cvt_pk_bf16_f32 v124, v12, v13
    v_cvt_pk_bf16_f32 v10, v26, v27
    v_and_b32 v11, 0xffff0000, v10
    v_lshlrev_b32 v10, 16, v10
    v_mul_f32 v12, v10, v9
    v_mul_f32 v13, v11, v9
    v_fma_f32 v14, -v12, v8, v10
    v_fma_f32 v15, -v13, v8, v11
    v_fma_f32 v12, v14, v9, v12
    v_fma_f32 v13, v15, v9, v13
    v_cvt_pk_bf16_f32 v125, v12, v13
    v_cvt_pk_bf16_f32 v10, v28, v29
    v_and_b32 v11, 0xffff0000, v10
    v_lshlrev_b32 v10, 16, v10
    v_mul_f32 v12, v10, v9
    v_mul_f32 v13, v11, v9
    v_fma_f32 v14, -v12, v8, v10
    v_fma_f32 v15, -v13, v8, v11
    v_fma_f32 v12, v14, v9, v12
    v_fma_f32 v13, v15, v9, v13
    v_cvt_pk_bf16_f32 v126, v12, v13
    v_cvt_pk_bf16_f32 v10, v30, v31
    v_and_b32 v11, 0xffff0000, v10
    v_lshlrev_b32 v10, 16, v10
    v_mul_f32 v12, v10, v9
    v_mul_f32 v13, v11, v9
    v_fma_f32 v14, -v12, v8, v10
    v_fma_f32 v15, -v13, v8, v11
    v_fma_f32 v12, v14, v9, v12
    v_fma_f32 v13, v15, v9, v13
    v_cvt_pk_bf16_f32 v127, v12, v13
    buffer_store_dwordx4 v[120:123], v2, s[28:31], s33 offen offset:0
    buffer_store_dwordx4 v[124:127], v2, s[28:31], s33 offen offset:1024
    v_cvt_pk_bf16_f32 v8, v64, v64
    v_lshlrev_b32 v8, 16, v8
    v_add_f32 v8, 0x358637bd, v8
    v_cvt_pk_bf16_f32 v8, v8, v8
    v_lshlrev_b32 v8, 16, v8
    v_rcp_f32 v9, v8
    s_nop 0
    v_cvt_pk_bf16_f32 v10, v32, v33
    v_and_b32 v11, 0xffff0000, v10
    v_lshlrev_b32 v10, 16, v10
    v_mul_f32 v12, v10, v9
    v_mul_f32 v13, v11, v9
    v_fma_f32 v14, -v12, v8, v10
    v_fma_f32 v15, -v13, v8, v11
    v_fma_f32 v12, v14, v9, v12
    v_fma_f32 v13, v15, v9, v13
    v_cvt_pk_bf16_f32 v128, v12, v13
    v_cvt_pk_bf16_f32 v10, v34, v35
    v_and_b32 v11, 0xffff0000, v10
    v_lshlrev_b32 v10, 16, v10
    v_mul_f32 v12, v10, v9
    v_mul_f32 v13, v11, v9
    v_fma_f32 v14, -v12, v8, v10
    v_fma_f32 v15, -v13, v8, v11
    v_fma_f32 v12, v14, v9, v12
    v_fma_f32 v13, v15, v9, v13
    v_cvt_pk_bf16_f32 v129, v12, v13
    v_cvt_pk_bf16_f32 v10, v36, v37
    v_and_b32 v11, 0xffff0000, v10
    v_lshlrev_b32 v10, 16, v10
    v_mul_f32 v12, v10, v9
    v_mul_f32 v13, v11, v9
    v_fma_f32 v14, -v12, v8, v10
    v_fma_f32 v15, -v13, v8, v11
    v_fma_f32 v12, v14, v9, v12
    v_fma_f32 v13, v15, v9, v13
    v_cvt_pk_bf16_f32 v130, v12, v13
    v_cvt_pk_bf16_f32 v10, v38, v39
    v_and_b32 v11, 0xffff0000, v10
    v_lshlrev_b32 v10, 16, v10
    v_mul_f32 v12, v10, v9
    v_mul_f32 v13, v11, v9
    v_fma_f32 v14, -v12, v8, v10
    v_fma_f32 v15, -v13, v8, v11
    v_fma_f32 v12, v14, v9, v12
    v_fma_f32 v13, v15, v9, v13
    v_cvt_pk_bf16_f32 v131, v12, v13
    v_cvt_pk_bf16_f32 v10, v40, v41
    v_and_b32 v11, 0xffff0000, v10
    v_lshlrev_b32 v10, 16, v10
    v_mul_f32 v12, v10, v9
    v_mul_f32 v13, v11, v9
    v_fma_f32 v14, -v12, v8, v10
    v_fma_f32 v15, -v13, v8, v11
    v_fma_f32 v12, v14, v9, v12
    v_fma_f32 v13, v15, v9, v13
    v_cvt_pk_bf16_f32 v132, v12, v13
    v_cvt_pk_bf16_f32 v10, v42, v43
    v_and_b32 v11, 0xffff0000, v10
    v_lshlrev_b32 v10, 16, v10
    v_mul_f32 v12, v10, v9
    v_mul_f32 v13, v11, v9
    v_fma_f32 v14, -v12, v8, v10
    v_fma_f32 v15, -v13, v8, v11
    v_fma_f32 v12, v14, v9, v12
    v_fma_f32 v13, v15, v9, v13
    v_cvt_pk_bf16_f32 v133, v12, v13
    v_cvt_pk_bf16_f32 v10, v44, v45
    v_and_b32 v11, 0xffff0000, v10
    v_lshlrev_b32 v10, 16, v10
    v_mul_f32 v12, v10, v9
    v_mul_f32 v13, v11, v9
    v_fma_f32 v14, -v12, v8, v10
    v_fma_f32 v15, -v13, v8, v11
    v_fma_f32 v12, v14, v9, v12
    v_fma_f32 v13, v15, v9, v13
    v_cvt_pk_bf16_f32 v134, v12, v13
    v_cvt_pk_bf16_f32 v10, v46, v47
    v_and_b32 v11, 0xffff0000, v10
    v_lshlrev_b32 v10, 16, v10
    v_mul_f32 v12, v10, v9
    v_mul_f32 v13, v11, v9
    v_fma_f32 v14, -v12, v8, v10
    v_fma_f32 v15, -v13, v8, v11
    v_fma_f32 v12, v14, v9, v12
    v_fma_f32 v13, v15, v9, v13
    v_cvt_pk_bf16_f32 v135, v12, v13
    buffer_store_dwordx4 v[128:131], v2, s[28:31], s34 offen offset:0
    buffer_store_dwordx4 v[132:135], v2, s[28:31], s34 offen offset:1024
ko_kernel_exit1:
    s_endpgm
.section .rodata,"a"
.p2align 6
.amdhsa_kernel ko_kernel
  .amdhsa_next_free_vgpr 136
  .amdhsa_next_free_sgpr 40
  .amdhsa_accum_offset 136
  .amdhsa_group_segment_fixed_size 0
  .amdhsa_kernarg_size 88
  .amdhsa_user_sgpr_count 2
  .amdhsa_user_sgpr_kernarg_segment_ptr 1
  .amdhsa_system_sgpr_workgroup_id_x 1
.end_amdhsa_kernel

.text
.globl ffn1_kernel
.p2align 8
.type ffn1_kernel,@function
ffn1_kernel:
    s_cmp_ge_u32 s2, 224
    s_cbranch_scc1 ffn1_kernel_exit1
    s_load_dwordx2 s[10:11], s[0:1], 80
    s_load_dwordx2 s[4:5], s[0:1], 40
    s_load_dwordx2 s[6:7], s[0:1], 48
    v_lshrrev_b32 v1, 6, v0
    v_mov_b32 v3, v0
    v_and_b32 v0, 63, v0
    s_nop 0
    v_readfirstlane_b32 s20, v1
    s_mul_i32 s22, s2, 9363
    s_lshr_b32 s22, s22, 18
    s_mul_i32 s21, s22, 28
    s_sub_u32 s21, s2, s21
    s_waitcnt lgkmcnt(0)
    s_mov_b32 s12, s4
    s_and_b32 s13, s5, 0xffff
    s_mov_b32 s14, 0x700000
    s_mov_b32 s15, 0x20000
    s_mov_b32 s16, s6
    s_and_b32 s17, s7, 0xffff
    s_mov_b32 s18, 0x700000
    s_mov_b32 s19, 0x20000
    s_add_u32 s24, s10, 0x2210000
    s_addc_u32 s25, s11, 0
    s_and_b32 s25, s25, 0xffff
    s_mov_b32 s26, 0x2000
    s_mov_b32 s27, 0x20000
    s_add_u32 s28, s10, 0x1c00000
    s_addc_u32 s29, s11, 0
    s_and_b32 s29, s29, 0xffff
    s_mov_b32 s30, 0x400000
    s_mov_b32 s31, 0x20000
    s_add_u32 s32, s10, 0x2300000
    s_addc_u32 s33, s11, 0
    s_and_b32 s33, s33, 0xffff
    s_mov_b32 s34, 0x200000
    s_mov_b32 s35, 0x20000
    s_add_u32 s36, s10, 0x2214000
    s_addc_u32 s37, s11, 0
    s_and_b32 s37, s37, 0xffff
    s_mov_b32 s38, 0x20
    s_mov_b32 s39, 0x20000
    s_lshl_b32 s23, s22, 7
    s_lshl_b32 s40, s20, 5
    s_add_u32 s23, s23, s40
    s_mul_i32 s23, s23, 7168
    s_lshl_b32 s40, s21, 8
    s_add_u32 s23, s23, s40
    v_lshlrev_b32 v2, 2, v0
    s_lshl_b32 s60, s20, 11
    v_lshlrev_b32 v6, 5, v0
    buffer_load_dwordx4 v[8:11], v6, s[24:27], s60 offen
    buffer_load_dwordx4 v[12:15], v6, s[24:27], s60 offen offset:16
    buffer_load_dword v64, v2, s[12:15], s23 offen
    buffer_load_dword v96, v2, s[16:19], s23 offen
    s_add_u32 s23, s23, 7168
    buffer_load_dword v65, v2, s[12:15], s23 offen
    buffer_load_dword v97, v2, s[16:19], s23 offen
    s_add_u32 s23, s23, 7168
    buffer_load_dword v66, v2, s[12:15], s23 offen
    buffer_load_dword v98, v2, s[16:19], s23 offen
    s_add_u32 s23, s23, 7168
    buffer_load_dword v67, v2, s[12:15], s23 offen
    buffer_load_dword v99, v2, s[16:19], s23 offen
    s_add_u32 s23, s23, 7168
    buffer_load_dword v68, v2, s[12:15], s23 offen
    buffer_load_dword v100, v2, s[16:19], s23 offen
    s_add_u32 s23, s23, 7168
    buffer_load_dword v69, v2, s[12:15], s23 offen
    buffer_load_dword v101, v2, s[16:19], s23 offen
    s_add_u32 s23, s23, 7168
    buffer_load_dword v70, v2, s[12:15], s23 offen
    buffer_load_dword v102, v2, s[16:19], s23 offen
    s_add_u32 s23, s23, 7168
    buffer_load_dword v71, v2, s[12:15], s23 offen
    buffer_load_dword v103, v2, s[16:19], s23 offen
    s_add_u32 s23, s23, 7168
    buffer_load_dword v72, v2, s[12:15], s23 offen
    buffer_load_dword v104, v2, s[16:19], s23 offen
    s_add_u32 s23, s23, 7168
    buffer_load_dword v73, v2, s[12:15], s23 offen
    buffer_load_dword v105, v2, s[16:19], s23 offen
    s_add_u32 s23, s23, 7168
    buffer_load_dword v74, v2, s[12:15], s23 offen
    buffer_load_dword v106, v2, s[16:19], s23 offen
    s_add_u32 s23, s23, 7168
    buffer_load_dword v75, v2, s[12:15], s23 offen
    buffer_load_dword v107, v2, s[16:19], s23 offen
    s_add_u32 s23, s23, 7168
    buffer_load_dword v76, v2, s[12:15], s23 offen
    buffer_load_dword v108, v2, s[16:19], s23 offen
    s_add_u32 s23, s23, 7168
    buffer_load_dword v77, v2, s[12:15], s23 offen
    buffer_load_dword v109, v2, s[16:19], s23 offen
    s_add_u32 s23, s23, 7168
    buffer_load_dword v78, v2, s[12:15], s23 offen
    buffer_load_dword v110, v2, s[16:19], s23 offen
    s_add_u32 s23, s23, 7168
    buffer_load_dword v79, v2, s[12:15], s23 offen
    buffer_load_dword v111, v2, s[16:19], s23 offen
    s_add_u32 s23, s23, 7168
    buffer_load_dword v80, v2, s[12:15], s23 offen
    buffer_load_dword v112, v2, s[16:19], s23 offen
    s_add_u32 s23, s23, 7168
    buffer_load_dword v81, v2, s[12:15], s23 offen
    buffer_load_dword v113, v2, s[16:19], s23 offen
    s_add_u32 s23, s23, 7168
    buffer_load_dword v82, v2, s[12:15], s23 offen
    buffer_load_dword v114, v2, s[16:19], s23 offen
    s_add_u32 s23, s23, 7168
    buffer_load_dword v83, v2, s[12:15], s23 offen
    buffer_load_dword v115, v2, s[16:19], s23 offen
    s_add_u32 s23, s23, 7168
    buffer_load_dword v84, v2, s[12:15], s23 offen
    buffer_load_dword v116, v2, s[16:19], s23 offen
    s_add_u32 s23, s23, 7168
    buffer_load_dword v85, v2, s[12:15], s23 offen
    buffer_load_dword v117, v2, s[16:19], s23 offen
    s_add_u32 s23, s23, 7168
    buffer_load_dword v86, v2, s[12:15], s23 offen
    buffer_load_dword v118, v2, s[16:19], s23 offen
    s_add_u32 s23, s23, 7168
    buffer_load_dword v87, v2, s[12:15], s23 offen
    buffer_load_dword v119, v2, s[16:19], s23 offen
    s_add_u32 s23, s23, 7168
    buffer_load_dword v88, v2, s[12:15], s23 offen
    buffer_load_dword v120, v2, s[16:19], s23 offen
    s_add_u32 s23, s23, 7168
    buffer_load_dword v89, v2, s[12:15], s23 offen
    buffer_load_dword v121, v2, s[16:19], s23 offen
    s_add_u32 s23, s23, 7168
    buffer_load_dword v90, v2, s[12:15], s23 offen
    buffer_load_dword v122, v2, s[16:19], s23 offen
    s_add_u32 s23, s23, 7168
    buffer_load_dword v91, v2, s[12:15], s23 offen
    buffer_load_dword v123, v2, s[16:19], s23 offen
    s_add_u32 s23, s23, 7168
    buffer_load_dword v92, v2, s[12:15], s23 offen
    buffer_load_dword v124, v2, s[16:19], s23 offen
    s_add_u32 s23, s23, 7168
    buffer_load_dword v93, v2, s[12:15], s23 offen
    buffer_load_dword v125, v2, s[16:19], s23 offen
    s_add_u32 s23, s23, 7168
    buffer_load_dword v94, v2, s[12:15], s23 offen
    buffer_load_dword v126, v2, s[16:19], s23 offen
    s_add_u32 s23, s23, 7168
    buffer_load_dword v95, v2, s[12:15], s23 offen
    buffer_load_dword v127, v2, s[16:19], s23 offen
    s_add_u32 s23, s23, 7168
    v_mov_b32 v5, 0
    s_waitcnt vmcnt(63)
    v_max_u32 v4, v8, v9
    v_max_u32 v4, v4, v10
    v_max_u32 v4, v4, v11
    v_max_u32 v4, v4, v12
    v_max_u32 v4, v4, v13
    v_max_u32 v4, v4, v14
    v_max_u32 v4, v4, v15
    s_nop 1
    v_max_u32_dpp v4, v4, v4 quad_perm:[1,0,3,2] row_mask:0xf bank_mask:0xf
    s_nop 1
    v_max_u32_dpp v4, v4, v4 quad_perm:[2,3,0,1] row_mask:0xf bank_mask:0xf
    s_nop 1
    v_max_u32_dpp v4, v4, v4 row_half_mirror row_mask:0xf bank_mask:0xf
    s_nop 1
    v_max_u32_dpp v4, v4, v4 row_mirror row_mask:0xf bank_mask:0xf
    s_nop 1
    v_readlane_b32 s60, v4, 0
    v_readlane_b32 s61, v4, 16
    v_readlane_b32 s62, v4, 32
    v_readlane_b32 s63, v4, 48
    s_max_u32 s60, s60, s61
    s_max_u32 s62, s62, s63
    s_max_u32 s60, s60, s62
    v_writelane_b32 v5, s60, 0
    v_cmp_ne_u32 vcc, s60, v8
    s_nop 1
    v_cndmask_b32 v8, 0, v8, vcc
    v_cmp_ne_u32 vcc, s60, v9
    s_nop 1
    v_cndmask_b32 v9, 0, v9, vcc
    v_cmp_ne_u32 vcc, s60, v10
    s_nop 1
    v_cndmask_b32 v10, 0, v10, vcc
    v_cmp_ne_u32 vcc, s60, v11
    s_nop 1
    v_cndmask_b32 v11, 0, v11, vcc
    v_cmp_ne_u32 vcc, s60, v12
    s_nop 1
    v_cndmask_b32 v12, 0, v12, vcc
    v_cmp_ne_u32 vcc, s60, v13
    s_nop 1
    v_cndmask_b32 v13, 0, v13, vcc
    v_cmp_ne_u32 vcc, s60, v14
    s_nop 1
    v_cndmask_b32 v14, 0, v14, vcc
    v_cmp_ne_u32 vcc, s60, v15
    s_nop 1
    v_cndmask_b32 v15, 0, v15, vcc
    v_max_u32 v4, v8, v9
    v_max_u32 v4, v4, v10
    v_max_u32 v4, v4, v11
    v_max_u32 v4, v4, v12
    v_max_u32 v4, v4, v13
    v_max_u32 v4, v4, v14
    v_max_u32 v4, v4, v15
    s_nop 1
    v_max_u32_dpp v4, v4, v4 quad_perm:[1,0,3,2] row_mask:0xf bank_mask:0xf
    s_nop 1
    v_max_u32_dpp v4, v4, v4 quad_perm:[2,3,0,1] row_mask:0xf bank_mask:0xf
    s_nop 1
    v_max_u32_dpp v4, v4, v4 row_half_mirror row_mask:0xf bank_mask:0xf
    s_nop 1
    v_max_u32_dpp v4, v4, v4 row_mirror row_mask:0xf bank_mask:0xf
    s_nop 1
    v_readlane_b32 s60, v4, 0
    v_readlane_b32 s61, v4, 16
    v_readlane_b32 s62, v4, 32
    v_readlane_b32 s63, v4, 48
    s_max_u32 s60, s60, s61
    s_max_u32 s62, s62, s63
    s_max_u32 s60, s60, s62
    v_writelane_b32 v5, s60, 1
    v_cmp_ne_u32 vcc, s60, v8
    s_nop 1
    v_cndmask_b32 v8, 0, v8, vcc
    v_cmp_ne_u32 vcc, s60, v9
    s_nop 1
    v_cndmask_b32 v9, 0, v9, vcc
    v_cmp_ne_u32 vcc, s60, v10
    s_nop 1
    v_cndmask_b32 v10, 0, v10, vcc
    v_cmp_ne_u32 vcc, s60, v11
    s_nop 1
    v_cndmask_b32 v11, 0, v11, vcc
    v_cmp_ne_u32 vcc, s60, v12
    s_nop 1
    v_cndmask_b32 v12, 0, v12, vcc
    v_cmp_ne_u32 vcc, s60, v13
    s_nop 1
    v_cndmask_b32 v13, 0, v13, vcc
    v_cmp_ne_u32 vcc, s60, v14
    s_nop 1
    v_cndmask_b32 v14, 0, v14, vcc
    v_cmp_ne_u32 vcc, s60, v15
    s_nop 1
    v_cndmask_b32 v15, 0, v15, vcc
    v_max_u32 v4, v8, v9
    v_max_u32 v4, v4, v10
    v_max_u32 v4, v4, v11
    v_max_u32 v4, v4, v12
    v_max_u32 v4, v4, v13
    v_max_u32 v4, v4, v14
    v_max_u32 v4, v4, v15
    s_nop 1
    v_max_u32_dpp v4, v4, v4 quad_perm:[1,0,3,2] row_mask:0xf bank_mask:0xf
    s_nop 1
    v_max_u32_dpp v4, v4, v4 quad_perm:[2,3,0,1] row_mask:0xf bank_mask:0xf
    s_nop 1
    v_max_u32_dpp v4, v4, v4 row_half_mirror row_mask:0xf bank_mask:0xf
    s_nop 1
    v_max_u32_dpp v4, v4, v4 row_mirror row_mask:0xf bank_mask:0xf
    s_nop 1
    v_readlane_b32 s60, v4, 0
    v_readlane_b32 s61, v4, 16
    v_readlane_b32 s62, v4, 32
    v_readlane_b32 s63, v4, 48
    s_max_u32 s60, s60, s61
    s_max_u32 s62, s62, s63
    s_max_u32 s60, s60, s62
    v_writelane_b32 v5, s60, 2
    v_cmp_ne_u32 vcc, s60, v8
    s_nop 1
    v_cndmask_b32 v8, 0, v8, vcc
    v_cmp_ne_u32 vcc, s60, v9
    s_nop 1
    v_cndmask_b32 v9, 0, v9, vcc
    v_cmp_ne_u32 vcc, s60, v10
    s_nop 1
    v_cndmask_b32 v10, 0, v10, vcc
    v_cmp_ne_u32 vcc, s60, v11
    s_nop 1
    v_cndmask_b32 v11, 0, v11, vcc
    v_cmp_ne_u32 vcc, s60, v12
    s_nop 1
    v_cndmask_b32 v12, 0, v12, vcc
    v_cmp_ne_u32 vcc, s60, v13
    s_nop 1
    v_cndmask_b32 v13, 0, v13, vcc
    v_cmp_ne_u32 vcc, s60, v14
    s_nop 1
    v_cndmask_b32 v14, 0, v14, vcc
    v_cmp_ne_u32 vcc, s60, v15
    s_nop 1
    v_cndmask_b32 v15, 0, v15, vcc
    v_max_u32 v4, v8, v9
    v_max_u32 v4, v4, v10
    v_max_u32 v4, v4, v11
    v_max_u32 v4, v4, v12
    v_max_u32 v4, v4, v13
    v_max_u32 v4, v4, v14
    v_max_u32 v4, v4, v15
    s_nop 1
    v_max_u32_dpp v4, v4, v4 quad_perm:[1,0,3,2] row_mask:0xf bank_mask:0xf
    s_nop 1
    v_max_u32_dpp v4, v4, v4 quad_perm:[2,3,0,1] row_mask:0xf bank_mask:0xf
    s_nop 1
    v_max_u32_dpp v4, v4, v4 row_half_mirror row_mask:0xf bank_mask:0xf
    s_nop 1
    v_max_u32_dpp v4, v4, v4 row_mirror row_mask:0xf bank_mask:0xf
    s_nop 1
    v_readlane_b32 s60, v4, 0
    v_readlane_b32 s61, v4, 16
    v_readlane_b32 s62, v4, 32
    v_readlane_b32 s63, v4, 48
    s_max_u32 s60, s60, s61
    s_max_u32 s62, s62, s63
    s_max_u32 s60, s60, s62
    v_writelane_b32 v5, s60, 3
    v_cmp_ne_u32 vcc, s60, v8
    s_nop 1
    v_cndmask_b32 v8, 0, v8, vcc
    v_cmp_ne_u32 vcc, s60, v9
    s_nop 1
    v_cndmask_b32 v9, 0, v9, vcc
    v_cmp_ne_u32 vcc, s60, v10
    s_nop 1
    v_cndmask_b32 v10, 0, v10, vcc
    v_cmp_ne_u32 vcc, s60, v11
    s_nop 1
    v_cndmask_b32 v11, 0, v11, vcc
    v_cmp_ne_u32 vcc, s60, v12
    s_nop 1
    v_cndmask_b32 v12, 0, v12, vcc
    v_cmp_ne_u32 vcc, s60, v13
    s_nop 1
    v_cndmask_b32 v13, 0, v13, vcc
    v_cmp_ne_u32 vcc, s60, v14
    s_nop 1
    v_cndmask_b32 v14, 0, v14, vcc
    v_cmp_ne_u32 vcc, s60, v15
    s_nop 1
    v_cndmask_b32 v15, 0, v15, vcc
    v_max_u32 v4, v8, v9
    v_max_u32 v4, v4, v10
    v_max_u32 v4, v4, v11
    v_max_u32 v4, v4, v12
    v_max_u32 v4, v4, v13
    v_max_u32 v4, v4, v14
    v_max_u32 v4, v4, v15
    s_nop 1
    v_max_u32_dpp v4, v4, v4 quad_perm:[1,0,3,2] row_mask:0xf bank_mask:0xf
    s_nop 1
    v_max_u32_dpp v4, v4, v4 quad_perm:[2,3,0,1] row_mask:0xf bank_mask:0xf
    s_nop 1
    v_max_u32_dpp v4, v4, v4 row_half_mirror row_mask:0xf bank_mask:0xf
    s_nop 1
    v_max_u32_dpp v4, v4, v4 row_mirror row_mask:0xf bank_mask:0xf
    s_nop 1
    v_readlane_b32 s60, v4, 0
    v_readlane_b32 s61, v4, 16
    v_readlane_b32 s62, v4, 32
    v_readlane_b32 s63, v4, 48
    s_max_u32 s60, s60, s61
    s_max_u32 s62, s62, s63
    s_max_u32 s60, s60, s62
    v_writelane_b32 v5, s60, 4
    v_cmp_ne_u32 vcc, s60, v8
    s_nop 1
    v_cndmask_b32 v8, 0, v8, vcc
    v_cmp_ne_u32 vcc, s60, v9
    s_nop 1
    v_cndmask_b32 v9, 0, v9, vcc
    v_cmp_ne_u32 vcc, s60, v10
    s_nop 1
    v_cndmask_b32 v10, 0, v10, vcc
    v_cmp_ne_u32 vcc, s60, v11
    s_nop 1
    v_cndmask_b32 v11, 0, v11, vcc
    v_cmp_ne_u32 vcc, s60, v12
    s_nop 1
    v_cndmask_b32 v12, 0, v12, vcc
    v_cmp_ne_u32 vcc, s60, v13
    s_nop 1
    v_cndmask_b32 v13, 0, v13, vcc
    v_cmp_ne_u32 vcc, s60, v14
    s_nop 1
    v_cndmask_b32 v14, 0, v14, vcc
    v_cmp_ne_u32 vcc, s60, v15
    s_nop 1
    v_cndmask_b32 v15, 0, v15, vcc
    v_max_u32 v4, v8, v9
    v_max_u32 v4, v4, v10
    v_max_u32 v4, v4, v11
    v_max_u32 v4, v4, v12
    v_max_u32 v4, v4, v13
    v_max_u32 v4, v4, v14
    v_max_u32 v4, v4, v15
    s_nop 1
    v_max_u32_dpp v4, v4, v4 quad_perm:[1,0,3,2] row_mask:0xf bank_mask:0xf
    s_nop 1
    v_max_u32_dpp v4, v4, v4 quad_perm:[2,3,0,1] row_mask:0xf bank_mask:0xf
    s_nop 1
    v_max_u32_dpp v4, v4, v4 row_half_mirror row_mask:0xf bank_mask:0xf
    s_nop 1
    v_max_u32_dpp v4, v4, v4 row_mirror row_mask:0xf bank_mask:0xf
    s_nop 1
    v_readlane_b32 s60, v4, 0
    v_readlane_b32 s61, v4, 16
    v_readlane_b32 s62, v4, 32
    v_readlane_b32 s63, v4, 48
    s_max_u32 s60, s60, s61
    s_max_u32 s62, s62, s63
    s_max_u32 s60, s60, s62
    v_writelane_b32 v5, s60, 5
    v_cmp_ne_u32 vcc, s60, v8
    s_nop 1
    v_cndmask_b32 v8, 0, v8, vcc
    v_cmp_ne_u32 vcc, s60, v9
    s_nop 1
    v_cndmask_b32 v9, 0, v9, vcc
    v_cmp_ne_u32 vcc, s60, v10
    s_nop 1
    v_cndmask_b32 v10, 0, v10, vcc
    v_cmp_ne_u32 vcc, s60, v11
    s_nop 1
    v_cndmask_b32 v11, 0, v11, vcc
    v_cmp_ne_u32 vcc, s60, v12
    s_nop 1
    v_cndmask_b32 v12, 0, v12, vcc
    v_cmp_ne_u32 vcc, s60, v13
    s_nop 1
    v_cndmask_b32 v13, 0, v13, vcc
    v_cmp_ne_u32 vcc, s60, v14
    s_nop 1
    v_cndmask_b32 v14, 0, v14, vcc
    v_cmp_ne_u32 vcc, s60, v15
    s_nop 1
    v_cndmask_b32 v15, 0, v15, vcc
    v_max_u32 v4, v8, v9
    v_max_u32 v4, v4, v10
    v_max_u32 v4, v4, v11
    v_max_u32 v4, v4, v12
    v_max_u32 v4, v4, v13
    v_max_u32 v4, v4, v14
    v_max_u32 v4, v4, v15
    s_nop 1
    v_max_u32_dpp v4, v4, v4 quad_perm:[1,0,3,2] row_mask:0xf bank_mask:0xf
    s_nop 1
    v_max_u32_dpp v4, v4, v4 quad_perm:[2,3,0,1] row_mask:0xf bank_mask:0xf
    s_nop 1
    v_max_u32_dpp v4, v4, v4 row_half_mirror row_mask:0xf bank_mask:0xf
    s_nop 1
    v_max_u32_dpp v4, v4, v4 row_mirror row_mask:0xf bank_mask:0xf
    s_nop 1
    v_readlane_b32 s60, v4, 0
    v_readlane_b32 s61, v4, 16
    v_readlane_b32 s62, v4, 32
    v_readlane_b32 s63, v4, 48
    s_max_u32 s60, s60, s61
    s_max_u32 s62, s62, s63
    s_max_u32 s60, s60, s62
    v_writelane_b32 v5, s60, 6
    v_cmp_ne_u32 vcc, s60, v8
    s_nop 1
    v_cndmask_b32 v8, 0, v8, vcc
    v_cmp_ne_u32 vcc, s60, v9
    s_nop 1
    v_cndmask_b32 v9, 0, v9, vcc
    v_cmp_ne_u32 vcc, s60, v10
    s_nop 1
    v_cndmask_b32 v10, 0, v10, vcc
    v_cmp_ne_u32 vcc, s60, v11
    s_nop 1
    v_cndmask_b32 v11, 0, v11, vcc
    v_cmp_ne_u32 vcc, s60, v12
    s_nop 1
    v_cndmask_b32 v12, 0, v12, vcc
    v_cmp_ne_u32 vcc, s60, v13
    s_nop 1
    v_cndmask_b32 v13, 0, v13, vcc
    v_cmp_ne_u32 vcc, s60, v14
    s_nop 1
    v_cndmask_b32 v14, 0, v14, vcc
    v_cmp_ne_u32 vcc, s60, v15
    s_nop 1
    v_cndmask_b32 v15, 0, v15, vcc
    v_max_u32 v4, v8, v9
    v_max_u32 v4, v4, v10
    v_max_u32 v4, v4, v11
    v_max_u32 v4, v4, v12
    v_max_u32 v4, v4, v13
    v_max_u32 v4, v4, v14
    v_max_u32 v4, v4, v15
    s_nop 1
    v_max_u32_dpp v4, v4, v4 quad_perm:[1,0,3,2] row_mask:0xf bank_mask:0xf
    s_nop 1
    v_max_u32_dpp v4, v4, v4 quad_perm:[2,3,0,1] row_mask:0xf bank_mask:0xf
    s_nop 1
    v_max_u32_dpp v4, v4, v4 row_half_mirror row_mask:0xf bank_mask:0xf
    s_nop 1
    v_max_u32_dpp v4, v4, v4 row_mirror row_mask:0xf bank_mask:0xf
    s_nop 1
    v_readlane_b32 s60, v4, 0
    v_readlane_b32 s61, v4, 16
    v_readlane_b32 s62, v4, 32
    v_readlane_b32 s63, v4, 48
    s_max_u32 s60, s60, s61
    s_max_u32 s62, s62, s63
    s_max_u32 s60, s60, s62
    v_writelane_b32 v5, s60, 7
    v_cmp_ne_u32 vcc, s60, v8
    s_nop 1
    v_cndmask_b32 v8, 0, v8, vcc
    v_cmp_ne_u32 vcc, s60, v9
    s_nop 1
    v_cndmask_b32 v9, 0, v9, vcc
    v_cmp_ne_u32 vcc, s60, v10
    s_nop 1
    v_cndmask_b32 v10, 0, v10, vcc
    v_cmp_ne_u32 vcc, s60, v11
    s_nop 1
    v_cndmask_b32 v11, 0, v11, vcc
    v_cmp_ne_u32 vcc, s60, v12
    s_nop 1
    v_cndmask_b32 v12, 0, v12, vcc
    v_cmp_ne_u32 vcc, s60, v13
    s_nop 1
    v_cndmask_b32 v13, 0, v13, vcc
    v_cmp_ne_u32 vcc, s60, v14
    s_nop 1
    v_cndmask_b32 v14, 0, v14, vcc
    v_cmp_ne_u32 vcc, s60, v15
    s_nop 1
    v_cndmask_b32 v15, 0, v15, vcc
    s_lshl_b32 s60, s20, 5
    v_lshlrev_b32 v6, 2, v0
    v_add_u32 v6, s60, v6
    v_cmp_gt_u32 vcc, 8, v0
    s_and_saveexec_b64 s[62:63], vcc
    ds_write_b32 v6, v5 offset:0
    s_mov_b64 exec, s[62:63]
    s_waitcnt lgkmcnt(0)
    s_barrier
    v_and_b32 v6, 31, v0
    v_lshlrev_b32 v6, 2, v6
    ds_read_b32 v5, v6 offset:0
    s_waitcnt lgkmcnt(0)
    v_mov_b32 v4, v5
    s_nop 1
    v_max_u32_dpp v4, v4, v4 quad_perm:[1,0,3,2] row_mask:0xf bank_mask:0xf
    s_nop 1
    v_max_u32_dpp v4, v4, v4 quad_perm:[2,3,0,1] row_mask:0xf bank_mask:0xf
    s_nop 1
    v_max_u32_dpp v4, v4, v4 row_half_mirror row_mask:0xf bank_mask:0xf
    s_nop 1
    v_max_u32_dpp v4, v4, v4 row_mirror row_mask:0xf bank_mask:0xf
    s_nop 1
    v_readlane_b32 s60, v4, 0
    v_readlane_b32 s61, v4, 16
    s_max_u32 s64, s60, s61
    v_cmp_ne_u32 vcc, s64, v5
    s_nop 1
    v_cndmask_b32 v5, 0, v5, vcc
    v_mov_b32 v4, v5
    s_nop 1
    v_max_u32_dpp v4, v4, v4 quad_perm:[1,0,3,2] row_mask:0xf bank_mask:0xf
    s_nop 1
    v_max_u32_dpp v4, v4, v4 quad_perm:[2,3,0,1] row_mask:0xf bank_mask:0xf
    s_nop 1
    v_max_u32_dpp v4, v4, v4 row_half_mirror row_mask:0xf bank_mask:0xf
    s_nop 1
    v_max_u32_dpp v4, v4, v4 row_mirror row_mask:0xf bank_mask:0xf
    s_nop 1
    v_readlane_b32 s60, v4, 0
    v_readlane_b32 s61, v4, 16
    s_max_u32 s65, s60, s61
    v_cmp_ne_u32 vcc, s65, v5
    s_nop 1
    v_cndmask_b32 v5, 0, v5, vcc
    v_mov_b32 v4, v5
    s_nop 1
    v_max_u32_dpp v4, v4, v4 quad_perm:[1,0,3,2] row_mask:0xf bank_mask:0xf
    s_nop 1
    v_max_u32_dpp v4, v4, v4 quad_perm:[2,3,0,1] row_mask:0xf bank_mask:0xf
    s_nop 1
    v_max_u32_dpp v4, v4, v4 row_half_mirror row_mask:0xf bank_mask:0xf
    s_nop 1
    v_max_u32_dpp v4, v4, v4 row_mirror row_mask:0xf bank_mask:0xf
    s_nop 1
    v_readlane_b32 s60, v4, 0
    v_readlane_b32 s61, v4, 16
    s_max_u32 s66, s60, s61
    v_cmp_ne_u32 vcc, s66, v5
    s_nop 1
    v_cndmask_b32 v5, 0, v5, vcc
    v_mov_b32 v4, v5
    s_nop 1
    v_max_u32_dpp v4, v4, v4 quad_perm:[1,0,3,2] row_mask:0xf bank_mask:0xf
    s_nop 1
    v_max_u32_dpp v4, v4, v4 quad_perm:[2,3,0,1] row_mask:0xf bank_mask:0xf
    s_nop 1
    v_max_u32_dpp v4, v4, v4 row_half_mirror row_mask:0xf bank_mask:0xf
    s_nop 1
    v_max_u32_dpp v4, v4, v4 row_mirror row_mask:0xf bank_mask:0xf
    s_nop 1
    v_readlane_b32 s60, v4, 0
    v_readlane_b32 s61, v4, 16
    s_max_u32 s67, s60, s61
    v_cmp_ne_u32 vcc, s67, v5
    s_nop 1
    v_cndmask_b32 v5, 0, v5, vcc
    v_mov_b32 v4, v5
    s_nop 1
    v_max_u32_dpp v4, v4, v4 quad_perm:[1,0,3,2] row_mask:0xf bank_mask:0xf
    s_nop 1
    v_max_u32_dpp v4, v4, v4 quad_perm:[2,3,0,1] row_mask:0xf bank_mask:0xf
    s_nop 1
    v_max_u32_dpp v4, v4, v4 row_half_mirror row_mask:0xf bank_mask:0xf
    s_nop 1
    v_max_u32_dpp v4, v4, v4 row_mirror row_mask:0xf bank_mask:0xf
    s_nop 1
    v_readlane_b32 s60, v4, 0
    v_readlane_b32 s61, v4, 16
    s_max_u32 s68, s60, s61
    v_cmp_ne_u32 vcc, s68, v5
    s_nop 1
    v_cndmask_b32 v5, 0, v5, vcc
    v_mov_b32 v4, v5
    s_nop 1
    v_max_u32_dpp v4, v4, v4 quad_perm:[1,0,3,2] row_mask:0xf bank_mask:0xf
    s_nop 1
    v_max_u32_dpp v4, v4, v4 quad_perm:[2,3,0,1] row_mask:0xf bank_mask:0xf
    s_nop 1
    v_max_u32_dpp v4, v4, v4 row_half_mirror row_mask:0xf bank_mask:0xf
    s_nop 1
    v_max_u32_dpp v4, v4, v4 row_mirror row_mask:0xf bank_mask:0xf
    s_nop 1
    v_readlane_b32 s60, v4, 0
    v_readlane_b32 s61, v4, 16
    s_max_u32 s69, s60, s61
    v_cmp_ne_u32 vcc, s69, v5
    s_nop 1
    v_cndmask_b32 v5, 0, v5, vcc
    v_mov_b32 v4, v5
    s_nop 1
    v_max_u32_dpp v4, v4, v4 quad_perm:[1,0,3,2] row_mask:0xf bank_mask:0xf
    s_nop 1
    v_max_u32_dpp v4, v4, v4 quad_perm:[2,3,0,1] row_mask:0xf bank_mask:0xf
    s_nop 1
    v_max_u32_dpp v4, v4, v4 row_half_mirror row_mask:0xf bank_mask:0xf
    s_nop 1
    v_max_u32_dpp v4, v4, v4 row_mirror row_mask:0xf bank_mask:0xf
    s_nop 1
    v_readlane_b32 s60, v4, 0
    v_readlane_b32 s61, v4, 16
    s_max_u32 s70, s60, s61
    v_cmp_ne_u32 vcc, s70, v5
    s_nop 1
    v_cndmask_b32 v5, 0, v5, vcc
    v_mov_b32 v4, v5
    s_nop 1
    v_max_u32_dpp v4, v4, v4 quad_perm:[1,0,3,2] row_mask:0xf bank_mask:0xf
    s_nop 1
    v_max_u32_dpp v4, v4, v4 quad_perm:[2,3,0,1] row_mask:0xf bank_mask:0xf
    s_nop 1
    v_max_u32_dpp v4, v4, v4 row_half_mirror row_mask:0xf bank_mask:0xf
    s_nop 1
    v_max_u32_dpp v4, v4, v4 row_mirror row_mask:0xf bank_mask:0xf
    s_nop 1
    v_readlane_b32 s60, v4, 0
    v_readlane_b32 s61, v4, 16
    s_max_u32 s71, s60, s61
    v_cmp_ne_u32 vcc, s71, v5
    s_nop 1
    v_cndmask_b32 v5, 0, v5, vcc
    v_mov_b32 v4, 0
    v_writelane_b32 v4, s64, 0
    v_writelane_b32 v4, s65, 1
    v_writelane_b32 v4, s66, 2
    v_writelane_b32 v4, s67, 3
    v_writelane_b32 v4, s68, 4
    v_writelane_b32 v4, s69, 5
    v_writelane_b32 v4, s70, 6
    v_writelane_b32 v4, s71, 7
    v_lshlrev_b32 v5, 2, v0
    s_lshl_b32 s40, s20, 5
    v_add_u32 v6, s40, v5
    v_cmp_gt_u32 vcc, 8, v0
    s_and_saveexec_b64 s[62:63], vcc
    ds_write_b32 v6, v4 offset:128
    s_or_b32 s41, s2, s20
    s_cmp_eq_u32 s41, 0
    s_cbranch_scc0 ffn1_kernel_nosel
    buffer_store_dword v4, v5, s[36:39], 0 offen
ffn1_kernel_nosel:
    s_mov_b64 exec, s[62:63]
    s_waitcnt lgkmcnt(0)
    v_lshrrev_b32 v5, 5, v3
    v_lshlrev_b32 v5, 2, v5
    v_add_u32 v6, s40, v5
    ds_read_b32 v4, v6 offset:128
    s_waitcnt lgkmcnt(0)
    v_and_b32 v4, 0xffff, v4
    v_sub_u32 v4, 0xffff, v4
    v_lshlrev_b32 v4, 11, v4
    v_and_b32 v6, 31, v3
    v_lshl_add_u32 v4, v6, 3, v4
    s_lshl_b32 s40, s22, 8
    buffer_load_dwordx2 v[8:9], v4, s[28:31], s40 offen
    v_lshl_add_u32 v5, v6, 7, v5
    s_waitcnt vmcnt(0)
    v_lshlrev_b32 v4, 16, v8
    v_and_b32 v6, 0xffff0000, v8
    ds_write_b32 v5, v4 offset:512
    ds_write_b32 v5, v6 offset:544
    v_lshlrev_b32 v4, 16, v9
    v_and_b32 v6, 0xffff0000, v9
    ds_write_b32 v5, v4 offset:576
    ds_write_b32 v5, v6 offset:608
    s_waitcnt lgkmcnt(0)
    s_barrier
    s_lshl_b32 s40, s20, 10
    v_mov_b32 v4, s40
    v_mov_b32 v128, 0
    v_mov_b32 v129, 0
    v_mov_b32 v130, 0
    v_mov_b32 v131, 0
    v_mov_b32 v132, 0
    v_mov_b32 v133, 0
    v_mov_b32 v134, 0
    v_mov_b32 v135, 0
    v_mov_b32 v136, 0
    v_mov_b32 v137, 0
    v_mov_b32 v138, 0
    v_mov_b32 v139, 0
    v_mov_b32 v140, 0
    v_mov_b32 v141, 0
    v_mov_b32 v142, 0
    v_mov_b32 v143, 0
    v_mov_b32 v144, 0
    v_mov_b32 v145, 0
    v_mov_b32 v146, 0
    v_mov_b32 v147, 0
    v_mov_b32 v148, 0
    v_mov_b32 v149, 0
    v_mov_b32 v150, 0
    v_mov_b32 v151, 0
    v_mov_b32 v152, 0
    v_mov_b32 v153, 0
    v_mov_b32 v154, 0
    v_mov_b32 v155, 0
    v_mov_b32 v156, 0
    v_mov_b32 v157, 0
    v_mov_b32 v158, 0
    v_mov_b32 v159, 0
    ds_read_b128 v[160:163], v4 offset:512
    ds_read_b128 v[164:167], v4 offset:528
    s_waitcnt lgkmcnt(0)
    ds_read_b128 v[168:171], v4 offset:544
    ds_read_b128 v[172:175], v4 offset:560
    v_lshlrev_b32 v5, 16, v64
    v_and_b32 v6, 0xffff0000, v64
    v_lshlrev_b32 v7, 16, v96
    v_and_b32 v8, 0xffff0000, v96
    v_fmac_f32 v128, v160, v5
    v_fmac_f32 v129, v160, v6
    v_fmac_f32 v144, v160, v7
    v_fmac_f32 v145, v160, v8
    v_fmac_f32 v130, v161, v5
    v_fmac_f32 v131, v161, v6
    v_fmac_f32 v146, v161, v7
    v_fmac_f32 v147, v161, v8
    v_fmac_f32 v132, v162, v5
    v_fmac_f32 v133, v162, v6
    v_fmac_f32 v148, v162, v7
    v_fmac_f32 v149, v162, v8
    v_fmac_f32 v134, v163, v5
    v_fmac_f32 v135, v163, v6
    v_fmac_f32 v150, v163, v7
    v_fmac_f32 v151, v163, v8
    v_fmac_f32 v136, v164, v5
    v_fmac_f32 v137, v164, v6
    v_fmac_f32 v152, v164, v7
    v_fmac_f32 v153, v164, v8
    v_fmac_f32 v138, v165, v5
    v_fmac_f32 v139, v165, v6
    v_fmac_f32 v154, v165, v7
    v_fmac_f32 v155, v165, v8
    v_fmac_f32 v140, v166, v5
    v_fmac_f32 v141, v166, v6
    v_fmac_f32 v156, v166, v7
    v_fmac_f32 v157, v166, v8
    v_fmac_f32 v142, v167, v5
    v_fmac_f32 v143, v167, v6
    v_fmac_f32 v158, v167, v7
    v_fmac_f32 v159, v167, v8
    s_waitcnt lgkmcnt(0)
    ds_read_b128 v[160:163], v4 offset:576
    ds_read_b128 v[164:167], v4 offset:592
    v_lshlrev_b32 v5, 16, v65
    v_and_b32 v6, 0xffff0000, v65
    v_lshlrev_b32 v7, 16, v97
    v_and_b32 v8, 0xffff0000, v97
    v_fmac_f32 v128, v168, v5
    v_fmac_f32 v129, v168, v6
    v_fmac_f32 v144, v168, v7
    v_fmac_f32 v145, v168, v8
    v_fmac_f32 v130, v169, v5
    v_fmac_f32 v131, v169, v6
    v_fmac_f32 v146, v169, v7
    v_fmac_f32 v147, v169, v8
    v_fmac_f32 v132, v170, v5
    v_fmac_f32 v133, v170, v6
    v_fmac_f32 v148, v170, v7
    v_fmac_f32 v149, v170, v8
    v_fmac_f32 v134, v171, v5
    v_fmac_f32 v135, v171, v6
    v_fmac_f32 v150, v171, v7
    v_fmac_f32 v151, v171, v8
    v_fmac_f32 v136, v172, v5
    v_fmac_f32 v137, v172, v6
    v_fmac_f32 v152, v172, v7
    v_fmac_f32 v153, v172, v8
    v_fmac_f32 v138, v173, v5
    v_fmac_f32 v139, v173, v6
    v_fmac_f32 v154, v173, v7
    v_fmac_f32 v155, v173, v8
    v_fmac_f32 v140, v174, v5
    v_fmac_f32 v141, v174, v6
    v_fmac_f32 v156, v174, v7
    v_fmac_f32 v157, v174, v8
    v_fmac_f32 v142, v175, v5
    v_fmac_f32 v143, v175, v6
    v_fmac_f32 v158, v175, v7
    v_fmac_f32 v159, v175, v8
    s_waitcnt lgkmcnt(0)
    ds_read_b128 v[168:171], v4 offset:608
    ds_read_b128 v[172:175], v4 offset:624
    v_lshlrev_b32 v5, 16, v66
    v_and_b32 v6, 0xffff0000, v66
    v_lshlrev_b32 v7, 16, v98
    v_and_b32 v8, 0xffff0000, v98
    v_fmac_f32 v128, v160, v5
    v_fmac_f32 v129, v160, v6
    v_fmac_f32 v144, v160, v7
    v_fmac_f32 v145, v160, v8
    v_fmac_f32 v130, v161, v5
    v_fmac_f32 v131, v161, v6
    v_fmac_f32 v146, v161, v7
    v_fmac_f32 v147, v161, v8
    v_fmac_f32 v132, v162, v5
    v_fmac_f32 v133, v162, v6
    v_fmac_f32 v148, v162, v7
    v_fmac_f32 v149, v162, v8
    v_fmac_f32 v134, v163, v5
    v_fmac_f32 v135, v163, v6
    v_fmac_f32 v150, v163, v7
    v_fmac_f32 v151, v163, v8
    v_fmac_f32 v136, v164, v5
    v_fmac_f32 v137, v164, v6
    v_fmac_f32 v152, v164, v7
    v_fmac_f32 v153, v164, v8
    v_fmac_f32 v138, v165, v5
    v_fmac_f32 v139, v165, v6
    v_fmac_f32 v154, v165, v7
    v_fmac_f32 v155, v165, v8
    v_fmac_f32 v140, v166, v5
    v_fmac_f32 v141, v166, v6
    v_fmac_f32 v156, v166, v7
    v_fmac_f32 v157, v166, v8
    v_fmac_f32 v142, v167, v5
    v_fmac_f32 v143, v167, v6
    v_fmac_f32 v158, v167, v7
    v_fmac_f32 v159, v167, v8
    s_waitcnt lgkmcnt(0)
    ds_read_b128 v[160:163], v4 offset:640
    ds_read_b128 v[164:167], v4 offset:656
    v_lshlrev_b32 v5, 16, v67
    v_and_b32 v6, 0xffff0000, v67
    v_lshlrev_b32 v7, 16, v99
    v_and_b32 v8, 0xffff0000, v99
    v_fmac_f32 v128, v168, v5
    v_fmac_f32 v129, v168, v6
    v_fmac_f32 v144, v168, v7
    v_fmac_f32 v145, v168, v8
    v_fmac_f32 v130, v169, v5
    v_fmac_f32 v131, v169, v6
    v_fmac_f32 v146, v169, v7
    v_fmac_f32 v147, v169, v8
    v_fmac_f32 v132, v170, v5
    v_fmac_f32 v133, v170, v6
    v_fmac_f32 v148, v170, v7
    v_fmac_f32 v149, v170, v8
    v_fmac_f32 v134, v171, v5
    v_fmac_f32 v135, v171, v6
    v_fmac_f32 v150, v171, v7
    v_fmac_f32 v151, v171, v8
    v_fmac_f32 v136, v172, v5
    v_fmac_f32 v137, v172, v6
    v_fmac_f32 v152, v172, v7
    v_fmac_f32 v153, v172, v8
    v_fmac_f32 v138, v173, v5
    v_fmac_f32 v139, v173, v6
    v_fmac_f32 v154, v173, v7
    v_fmac_f32 v155, v173, v8
    v_fmac_f32 v140, v174, v5
    v_fmac_f32 v141, v174, v6
    v_fmac_f32 v156, v174, v7
    v_fmac_f32 v157, v174, v8
    v_fmac_f32 v142, v175, v5
    v_fmac_f32 v143, v175, v6
    v_fmac_f32 v158, v175, v7
    v_fmac_f32 v159, v175, v8
    s_waitcnt lgkmcnt(0)
    ds_read_b128 v[168:171], v4 offset:672
    ds_read_b128 v[172:175], v4 offset:688
    v_lshlrev_b32 v5, 16, v68
    v_and_b32 v6, 0xffff0000, v68
    v_lshlrev_b32 v7, 16, v100
    v_and_b32 v8, 0xffff0000, v100
    v_fmac_f32 v128, v160, v5
    v_fmac_f32 v129, v160, v6
    v_fmac_f32 v144, v160, v7
    v_fmac_f32 v145, v160, v8
    v_fmac_f32 v130, v161, v5
    v_fmac_f32 v131, v161, v6
    v_fmac_f32 v146, v161, v7
    v_fmac_f32 v147, v161, v8
    v_fmac_f32 v132, v162, v5
    v_fmac_f32 v133, v162, v6
    v_fmac_f32 v148, v162, v7
    v_fmac_f32 v149, v162, v8
    v_fmac_f32 v134, v163, v5
    v_fmac_f32 v135, v163, v6
    v_fmac_f32 v150, v163, v7
    v_fmac_f32 v151, v163, v8
    v_fmac_f32 v136, v164, v5
    v_fmac_f32 v137, v164, v6
    v_fmac_f32 v152, v164, v7
    v_fmac_f32 v153, v164, v8
    v_fmac_f32 v138, v165, v5
    v_fmac_f32 v139, v165, v6
    v_fmac_f32 v154, v165, v7
    v_fmac_f32 v155, v165, v8
    v_fmac_f32 v140, v166, v5
    v_fmac_f32 v141, v166, v6
    v_fmac_f32 v156, v166, v7
    v_fmac_f32 v157, v166, v8
    v_fmac_f32 v142, v167, v5
    v_fmac_f32 v143, v167, v6
    v_fmac_f32 v158, v167, v7
    v_fmac_f32 v159, v167, v8
    s_waitcnt lgkmcnt(0)
    ds_read_b128 v[160:163], v4 offset:704
    ds_read_b128 v[164:167], v4 offset:720
    v_lshlrev_b32 v5, 16, v69
    v_and_b32 v6, 0xffff0000, v69
    v_lshlrev_b32 v7, 16, v101
    v_and_b32 v8, 0xffff0000, v101
    v_fmac_f32 v128, v168, v5
    v_fmac_f32 v129, v168, v6
    v_fmac_f32 v144, v168, v7
    v_fmac_f32 v145, v168, v8
    v_fmac_f32 v130, v169, v5
    v_fmac_f32 v131, v169, v6
    v_fmac_f32 v146, v169, v7
    v_fmac_f32 v147, v169, v8
    v_fmac_f32 v132, v170, v5
    v_fmac_f32 v133, v170, v6
    v_fmac_f32 v148, v170, v7
    v_fmac_f32 v149, v170, v8
    v_fmac_f32 v134, v171, v5
    v_fmac_f32 v135, v171, v6
    v_fmac_f32 v150, v171, v7
    v_fmac_f32 v151, v171, v8
    v_fmac_f32 v136, v172, v5
    v_fmac_f32 v137, v172, v6
    v_fmac_f32 v152, v172, v7
    v_fmac_f32 v153, v172, v8
    v_fmac_f32 v138, v173, v5
    v_fmac_f32 v139, v173, v6
    v_fmac_f32 v154, v173, v7
    v_fmac_f32 v155, v173, v8
    v_fmac_f32 v140, v174, v5
    v_fmac_f32 v141, v174, v6
    v_fmac_f32 v156, v174, v7
    v_fmac_f32 v157, v174, v8
    v_fmac_f32 v142, v175, v5
    v_fmac_f32 v143, v175, v6
    v_fmac_f32 v158, v175, v7
    v_fmac_f32 v159, v175, v8
    s_waitcnt lgkmcnt(0)
    ds_read_b128 v[168:171], v4 offset:736
    ds_read_b128 v[172:175], v4 offset:752
    v_lshlrev_b32 v5, 16, v70
    v_and_b32 v6, 0xffff0000, v70
    v_lshlrev_b32 v7, 16, v102
    v_and_b32 v8, 0xffff0000, v102
    v_fmac_f32 v128, v160, v5
    v_fmac_f32 v129, v160, v6
    v_fmac_f32 v144, v160, v7
    v_fmac_f32 v145, v160, v8
    v_fmac_f32 v130, v161, v5
    v_fmac_f32 v131, v161, v6
    v_fmac_f32 v146, v161, v7
    v_fmac_f32 v147, v161, v8
    v_fmac_f32 v132, v162, v5
    v_fmac_f32 v133, v162, v6
    v_fmac_f32 v148, v162, v7
    v_fmac_f32 v149, v162, v8
    v_fmac_f32 v134, v163, v5
    v_fmac_f32 v135, v163, v6
    v_fmac_f32 v150, v163, v7
    v_fmac_f32 v151, v163, v8
    v_fmac_f32 v136, v164, v5
    v_fmac_f32 v137, v164, v6
    v_fmac_f32 v152, v164, v7
    v_fmac_f32 v153, v164, v8
    v_fmac_f32 v138, v165, v5
    v_fmac_f32 v139, v165, v6
    v_fmac_f32 v154, v165, v7
    v_fmac_f32 v155, v165, v8
    v_fmac_f32 v140, v166, v5
    v_fmac_f32 v141, v166, v6
    v_fmac_f32 v156, v166, v7
    v_fmac_f32 v157, v166, v8
    v_fmac_f32 v142, v167, v5
    v_fmac_f32 v143, v167, v6
    v_fmac_f32 v158, v167, v7
    v_fmac_f32 v159, v167, v8
    s_waitcnt lgkmcnt(0)
    ds_read_b128 v[160:163], v4 offset:768
    ds_read_b128 v[164:167], v4 offset:784
    v_lshlrev_b32 v5, 16, v71
    v_and_b32 v6, 0xffff0000, v71
    v_lshlrev_b32 v7, 16, v103
    v_and_b32 v8, 0xffff0000, v103
    v_fmac_f32 v128, v168, v5
    v_fmac_f32 v129, v168, v6
    v_fmac_f32 v144, v168, v7
    v_fmac_f32 v145, v168, v8
    v_fmac_f32 v130, v169, v5
    v_fmac_f32 v131, v169, v6
    v_fmac_f32 v146, v169, v7
    v_fmac_f32 v147, v169, v8
    v_fmac_f32 v132, v170, v5
    v_fmac_f32 v133, v170, v6
    v_fmac_f32 v148, v170, v7
    v_fmac_f32 v149, v170, v8
    v_fmac_f32 v134, v171, v5
    v_fmac_f32 v135, v171, v6
    v_fmac_f32 v150, v171, v7
    v_fmac_f32 v151, v171, v8
    v_fmac_f32 v136, v172, v5
    v_fmac_f32 v137, v172, v6
    v_fmac_f32 v152, v172, v7
    v_fmac_f32 v153, v172, v8
    v_fmac_f32 v138, v173, v5
    v_fmac_f32 v139, v173, v6
    v_fmac_f32 v154, v173, v7
    v_fmac_f32 v155, v173, v8
    v_fmac_f32 v140, v174, v5
    v_fmac_f32 v141, v174, v6
    v_fmac_f32 v156, v174, v7
    v_fmac_f32 v157, v174, v8
    v_fmac_f32 v142, v175, v5
    v_fmac_f32 v143, v175, v6
    v_fmac_f32 v158, v175, v7
    v_fmac_f32 v159, v175, v8
    s_waitcnt lgkmcnt(0)
    ds_read_b128 v[168:171], v4 offset:800
    ds_read_b128 v[172:175], v4 offset:816
    v_lshlrev_b32 v5, 16, v72
    v_and_b32 v6, 0xffff0000, v72
    v_lshlrev_b32 v7, 16, v104
    v_and_b32 v8, 0xffff0000, v104
    v_fmac_f32 v128, v160, v5
    v_fmac_f32 v129, v160, v6
    v_fmac_f32 v144, v160, v7
    v_fmac_f32 v145, v160, v8
    v_fmac_f32 v130, v161, v5
    v_fmac_f32 v131, v161, v6
    v_fmac_f32 v146, v161, v7
    v_fmac_f32 v147, v161, v8
    v_fmac_f32 v132, v162, v5
    v_fmac_f32 v133, v162, v6
    v_fmac_f32 v148, v162, v7
    v_fmac_f32 v149, v162, v8
    v_fmac_f32 v134, v163, v5
    v_fmac_f32 v135, v163, v6
    v_fmac_f32 v150, v163, v7
    v_fmac_f32 v151, v163, v8
    v_fmac_f32 v136, v164, v5
    v_fmac_f32 v137, v164, v6
    v_fmac_f32 v152, v164, v7
    v_fmac_f32 v153, v164, v8
    v_fmac_f32 v138, v165, v5
    v_fmac_f32 v139, v165, v6
    v_fmac_f32 v154, v165, v7
    v_fmac_f32 v155, v165, v8
    v_fmac_f32 v140, v166, v5
    v_fmac_f32 v141, v166, v6
    v_fmac_f32 v156, v166, v7
    v_fmac_f32 v157, v166, v8
    v_fmac_f32 v142, v167, v5
    v_fmac_f32 v143, v167, v6
    v_fmac_f32 v158, v167, v7
    v_fmac_f32 v159, v167, v8
    s_waitcnt lgkmcnt(0)
    ds_read_b128 v[160:163], v4 offset:832
    ds_read_b128 v[164:167], v4 offset:848
    v_lshlrev_b32 v5, 16, v73
    v_and_b32 v6, 0xffff0000, v73
    v_lshlrev_b32 v7, 16, v105
    v_and_b32 v8, 0xffff0000, v105
    v_fmac_f32 v128, v168, v5
    v_fmac_f32 v129, v168, v6
    v_fmac_f32 v144, v168, v7
    v_fmac_f32 v145, v168, v8
    v_fmac_f32 v130, v169, v5
    v_fmac_f32 v131, v169, v6
    v_fmac_f32 v146, v169, v7
    v_fmac_f32 v147, v169, v8
    v_fmac_f32 v132, v170, v5
    v_fmac_f32 v133, v170, v6
    v_fmac_f32 v148, v170, v7
    v_fmac_f32 v149, v170, v8
    v_fmac_f32 v134, v171, v5
    v_fmac_f32 v135, v171, v6
    v_fmac_f32 v150, v171, v7
    v_fmac_f32 v151, v171, v8
    v_fmac_f32 v136, v172, v5
    v_fmac_f32 v137, v172, v6
    v_fmac_f32 v152, v172, v7
    v_fmac_f32 v153, v172, v8
    v_fmac_f32 v138, v173, v5
    v_fmac_f32 v139, v173, v6
    v_fmac_f32 v154, v173, v7
    v_fmac_f32 v155, v173, v8
    v_fmac_f32 v140, v174, v5
    v_fmac_f32 v141, v174, v6
    v_fmac_f32 v156, v174, v7
    v_fmac_f32 v157, v174, v8
    v_fmac_f32 v142, v175, v5
    v_fmac_f32 v143, v175, v6
    v_fmac_f32 v158, v175, v7
    v_fmac_f32 v159, v175, v8
    s_waitcnt lgkmcnt(0)
    ds_read_b128 v[168:171], v4 offset:864
    ds_read_b128 v[172:175], v4 offset:880
    v_lshlrev_b32 v5, 16, v74
    v_and_b32 v6, 0xffff0000, v74
    v_lshlrev_b32 v7, 16, v106
    v_and_b32 v8, 0xffff0000, v106
    v_fmac_f32 v128, v160, v5
    v_fmac_f32 v129, v160, v6
    v_fmac_f32 v144, v160, v7
    v_fmac_f32 v145, v160, v8
    v_fmac_f32 v130, v161, v5
    v_fmac_f32 v131, v161, v6
    v_fmac_f32 v146, v161, v7
    v_fmac_f32 v147, v161, v8
    v_fmac_f32 v132, v162, v5
    v_fmac_f32 v133, v162, v6
    v_fmac_f32 v148, v162, v7
    v_fmac_f32 v149, v162, v8
    v_fmac_f32 v134, v163, v5
    v_fmac_f32 v135, v163, v6
    v_fmac_f32 v150, v163, v7
    v_fmac_f32 v151, v163, v8
    v_fmac_f32 v136, v164, v5
    v_fmac_f32 v137, v164, v6
    v_fmac_f32 v152, v164, v7
    v_fmac_f32 v153, v164, v8
    v_fmac_f32 v138, v165, v5
    v_fmac_f32 v139, v165, v6
    v_fmac_f32 v154, v165, v7
    v_fmac_f32 v155, v165, v8
    v_fmac_f32 v140, v166, v5
    v_fmac_f32 v141, v166, v6
    v_fmac_f32 v156, v166, v7
    v_fmac_f32 v157, v166, v8
    v_fmac_f32 v142, v167, v5
    v_fmac_f32 v143, v167, v6
    v_fmac_f32 v158, v167, v7
    v_fmac_f32 v159, v167, v8
    s_waitcnt lgkmcnt(0)
    ds_read_b128 v[160:163], v4 offset:896
    ds_read_b128 v[164:167], v4 offset:912
    v_lshlrev_b32 v5, 16, v75
    v_and_b32 v6, 0xffff0000, v75
    v_lshlrev_b32 v7, 16, v107
    v_and_b32 v8, 0xffff0000, v107
    v_fmac_f32 v128, v168, v5
    v_fmac_f32 v129, v168, v6
    v_fmac_f32 v144, v168, v7
    v_fmac_f32 v145, v168, v8
    v_fmac_f32 v130, v169, v5
    v_fmac_f32 v131, v169, v6
    v_fmac_f32 v146, v169, v7
    v_fmac_f32 v147, v169, v8
    v_fmac_f32 v132, v170, v5
    v_fmac_f32 v133, v170, v6
    v_fmac_f32 v148, v170, v7
    v_fmac_f32 v149, v170, v8
    v_fmac_f32 v134, v171, v5
    v_fmac_f32 v135, v171, v6
    v_fmac_f32 v150, v171, v7
    v_fmac_f32 v151, v171, v8
    v_fmac_f32 v136, v172, v5
    v_fmac_f32 v137, v172, v6
    v_fmac_f32 v152, v172, v7
    v_fmac_f32 v153, v172, v8
    v_fmac_f32 v138, v173, v5
    v_fmac_f32 v139, v173, v6
    v_fmac_f32 v154, v173, v7
    v_fmac_f32 v155, v173, v8
    v_fmac_f32 v140, v174, v5
    v_fmac_f32 v141, v174, v6
    v_fmac_f32 v156, v174, v7
    v_fmac_f32 v157, v174, v8
    v_fmac_f32 v142, v175, v5
    v_fmac_f32 v143, v175, v6
    v_fmac_f32 v158, v175, v7
    v_fmac_f32 v159, v175, v8
    s_waitcnt lgkmcnt(0)
    ds_read_b128 v[168:171], v4 offset:928
    ds_read_b128 v[172:175], v4 offset:944
    v_lshlrev_b32 v5, 16, v76
    v_and_b32 v6, 0xffff0000, v76
    v_lshlrev_b32 v7, 16, v108
    v_and_b32 v8, 0xffff0000, v108
    v_fmac_f32 v128, v160, v5
    v_fmac_f32 v129, v160, v6
    v_fmac_f32 v144, v160, v7
    v_fmac_f32 v145, v160, v8
    v_fmac_f32 v130, v161, v5
    v_fmac_f32 v131, v161, v6
    v_fmac_f32 v146, v161, v7
    v_fmac_f32 v147, v161, v8
    v_fmac_f32 v132, v162, v5
    v_fmac_f32 v133, v162, v6
    v_fmac_f32 v148, v162, v7
    v_fmac_f32 v149, v162, v8
    v_fmac_f32 v134, v163, v5
    v_fmac_f32 v135, v163, v6
    v_fmac_f32 v150, v163, v7
    v_fmac_f32 v151, v163, v8
    v_fmac_f32 v136, v164, v5
    v_fmac_f32 v137, v164, v6
    v_fmac_f32 v152, v164, v7
    v_fmac_f32 v153, v164, v8
    v_fmac_f32 v138, v165, v5
    v_fmac_f32 v139, v165, v6
    v_fmac_f32 v154, v165, v7
    v_fmac_f32 v155, v165, v8
    v_fmac_f32 v140, v166, v5
    v_fmac_f32 v141, v166, v6
    v_fmac_f32 v156, v166, v7
    v_fmac_f32 v157, v166, v8
    v_fmac_f32 v142, v167, v5
    v_fmac_f32 v143, v167, v6
    v_fmac_f32 v158, v167, v7
    v_fmac_f32 v159, v167, v8
    s_waitcnt lgkmcnt(0)
    ds_read_b128 v[160:163], v4 offset:960
    ds_read_b128 v[164:167], v4 offset:976
    v_lshlrev_b32 v5, 16, v77
    v_and_b32 v6, 0xffff0000, v77
    v_lshlrev_b32 v7, 16, v109
    v_and_b32 v8, 0xffff0000, v109
    v_fmac_f32 v128, v168, v5
    v_fmac_f32 v129, v168, v6
    v_fmac_f32 v144, v168, v7
    v_fmac_f32 v145, v168, v8
    v_fmac_f32 v130, v169, v5
    v_fmac_f32 v131, v169, v6
    v_fmac_f32 v146, v169, v7
    v_fmac_f32 v147, v169, v8
    v_fmac_f32 v132, v170, v5
    v_fmac_f32 v133, v170, v6
    v_fmac_f32 v148, v170, v7
    v_fmac_f32 v149, v170, v8
    v_fmac_f32 v134, v171, v5
    v_fmac_f32 v135, v171, v6
    v_fmac_f32 v150, v171, v7
    v_fmac_f32 v151, v171, v8
    v_fmac_f32 v136, v172, v5
    v_fmac_f32 v137, v172, v6
    v_fmac_f32 v152, v172, v7
    v_fmac_f32 v153, v172, v8
    v_fmac_f32 v138, v173, v5
    v_fmac_f32 v139, v173, v6
    v_fmac_f32 v154, v173, v7
    v_fmac_f32 v155, v173, v8
    v_fmac_f32 v140, v174, v5
    v_fmac_f32 v141, v174, v6
    v_fmac_f32 v156, v174, v7
    v_fmac_f32 v157, v174, v8
    v_fmac_f32 v142, v175, v5
    v_fmac_f32 v143, v175, v6
    v_fmac_f32 v158, v175, v7
    v_fmac_f32 v159, v175, v8
    s_waitcnt lgkmcnt(0)
    ds_read_b128 v[168:171], v4 offset:992
    ds_read_b128 v[172:175], v4 offset:1008
    v_lshlrev_b32 v5, 16, v78
    v_and_b32 v6, 0xffff0000, v78
    v_lshlrev_b32 v7, 16, v110
    v_and_b32 v8, 0xffff0000, v110
    v_fmac_f32 v128, v160, v5
    v_fmac_f32 v129, v160, v6
    v_fmac_f32 v144, v160, v7
    v_fmac_f32 v145, v160, v8
    v_fmac_f32 v130, v161, v5
    v_fmac_f32 v131, v161, v6
    v_fmac_f32 v146, v161, v7
    v_fmac_f32 v147, v161, v8
    v_fmac_f32 v132, v162, v5
    v_fmac_f32 v133, v162, v6
    v_fmac_f32 v148, v162, v7
    v_fmac_f32 v149, v162, v8
    v_fmac_f32 v134, v163, v5
    v_fmac_f32 v135, v163, v6
    v_fmac_f32 v150, v163, v7
    v_fmac_f32 v151, v163, v8
    v_fmac_f32 v136, v164, v5
    v_fmac_f32 v137, v164, v6
    v_fmac_f32 v152, v164, v7
    v_fmac_f32 v153, v164, v8
    v_fmac_f32 v138, v165, v5
    v_fmac_f32 v139, v165, v6
    v_fmac_f32 v154, v165, v7
    v_fmac_f32 v155, v165, v8
    v_fmac_f32 v140, v166, v5
    v_fmac_f32 v141, v166, v6
    v_fmac_f32 v156, v166, v7
    v_fmac_f32 v157, v166, v8
    v_fmac_f32 v142, v167, v5
    v_fmac_f32 v143, v167, v6
    v_fmac_f32 v158, v167, v7
    v_fmac_f32 v159, v167, v8
    s_waitcnt lgkmcnt(0)
    ds_read_b128 v[160:163], v4 offset:1024
    ds_read_b128 v[164:167], v4 offset:1040
    v_lshlrev_b32 v5, 16, v79
    v_and_b32 v6, 0xffff0000, v79
    v_lshlrev_b32 v7, 16, v111
    v_and_b32 v8, 0xffff0000, v111
    v_fmac_f32 v128, v168, v5
    v_fmac_f32 v129, v168, v6
    v_fmac_f32 v144, v168, v7
    v_fmac_f32 v145, v168, v8
    v_fmac_f32 v130, v169, v5
    v_fmac_f32 v131, v169, v6
    v_fmac_f32 v146, v169, v7
    v_fmac_f32 v147, v169, v8
    v_fmac_f32 v132, v170, v5
    v_fmac_f32 v133, v170, v6
    v_fmac_f32 v148, v170, v7
    v_fmac_f32 v149, v170, v8
    v_fmac_f32 v134, v171, v5
    v_fmac_f32 v135, v171, v6
    v_fmac_f32 v150, v171, v7
    v_fmac_f32 v151, v171, v8
    v_fmac_f32 v136, v172, v5
    v_fmac_f32 v137, v172, v6
    v_fmac_f32 v152, v172, v7
    v_fmac_f32 v153, v172, v8
    v_fmac_f32 v138, v173, v5
    v_fmac_f32 v139, v173, v6
    v_fmac_f32 v154, v173, v7
    v_fmac_f32 v155, v173, v8
    v_fmac_f32 v140, v174, v5
    v_fmac_f32 v141, v174, v6
    v_fmac_f32 v156, v174, v7
    v_fmac_f32 v157, v174, v8
    v_fmac_f32 v142, v175, v5
    v_fmac_f32 v143, v175, v6
    v_fmac_f32 v158, v175, v7
    v_fmac_f32 v159, v175, v8
    s_waitcnt lgkmcnt(0)
    ds_read_b128 v[168:171], v4 offset:1056
    ds_read_b128 v[172:175], v4 offset:1072
    v_lshlrev_b32 v5, 16, v80
    v_and_b32 v6, 0xffff0000, v80
    v_lshlrev_b32 v7, 16, v112
    v_and_b32 v8, 0xffff0000, v112
    v_fmac_f32 v128, v160, v5
    v_fmac_f32 v129, v160, v6
    v_fmac_f32 v144, v160, v7
    v_fmac_f32 v145, v160, v8
    v_fmac_f32 v130, v161, v5
    v_fmac_f32 v131, v161, v6
    v_fmac_f32 v146, v161, v7
    v_fmac_f32 v147, v161, v8
    v_fmac_f32 v132, v162, v5
    v_fmac_f32 v133, v162, v6
    v_fmac_f32 v148, v162, v7
    v_fmac_f32 v149, v162, v8
    v_fmac_f32 v134, v163, v5
    v_fmac_f32 v135, v163, v6
    v_fmac_f32 v150, v163, v7
    v_fmac_f32 v151, v163, v8
    v_fmac_f32 v136, v164, v5
    v_fmac_f32 v137, v164, v6
    v_fmac_f32 v152, v164, v7
    v_fmac_f32 v153, v164, v8
    v_fmac_f32 v138, v165, v5
    v_fmac_f32 v139, v165, v6
    v_fmac_f32 v154, v165, v7
    v_fmac_f32 v155, v165, v8
    v_fmac_f32 v140, v166, v5
    v_fmac_f32 v141, v166, v6
    v_fmac_f32 v156, v166, v7
    v_fmac_f32 v157, v166, v8
    v_fmac_f32 v142, v167, v5
    v_fmac_f32 v143, v167, v6
    v_fmac_f32 v158, v167, v7
    v_fmac_f32 v159, v167, v8
    s_waitcnt lgkmcnt(0)
    ds_read_b128 v[160:163], v4 offset:1088
    ds_read_b128 v[164:167], v4 offset:1104
    v_lshlrev_b32 v5, 16, v81
    v_and_b32 v6, 0xffff0000, v81
    v_lshlrev_b32 v7, 16, v113
    v_and_b32 v8, 0xffff0000, v113
    v_fmac_f32 v128, v168, v5
    v_fmac_f32 v129, v168, v6
    v_fmac_f32 v144, v168, v7
    v_fmac_f32 v145, v168, v8
    v_fmac_f32 v130, v169, v5
    v_fmac_f32 v131, v169, v6
    v_fmac_f32 v146, v169, v7
    v_fmac_f32 v147, v169, v8
    v_fmac_f32 v132, v170, v5
    v_fmac_f32 v133, v170, v6
    v_fmac_f32 v148, v170, v7
    v_fmac_f32 v149, v170, v8
    v_fmac_f32 v134, v171, v5
    v_fmac_f32 v135, v171, v6
    v_fmac_f32 v150, v171, v7
    v_fmac_f32 v151, v171, v8
    v_fmac_f32 v136, v172, v5
    v_fmac_f32 v137, v172, v6
    v_fmac_f32 v152, v172, v7
    v_fmac_f32 v153, v172, v8
    v_fmac_f32 v138, v173, v5
    v_fmac_f32 v139, v173, v6
    v_fmac_f32 v154, v173, v7
    v_fmac_f32 v155, v173, v8
    v_fmac_f32 v140, v174, v5
    v_fmac_f32 v141, v174, v6
    v_fmac_f32 v156, v174, v7
    v_fmac_f32 v157, v174, v8
    v_fmac_f32 v142, v175, v5
    v_fmac_f32 v143, v175, v6
    v_fmac_f32 v158, v175, v7
    v_fmac_f32 v159, v175, v8
    s_waitcnt lgkmcnt(0)
    ds_read_b128 v[168:171], v4 offset:1120
    ds_read_b128 v[172:175], v4 offset:1136
    v_lshlrev_b32 v5, 16, v82
    v_and_b32 v6, 0xffff0000, v82
    v_lshlrev_b32 v7, 16, v114
    v_and_b32 v8, 0xffff0000, v114
    v_fmac_f32 v128, v160, v5
    v_fmac_f32 v129, v160, v6
    v_fmac_f32 v144, v160, v7
    v_fmac_f32 v145, v160, v8
    v_fmac_f32 v130, v161, v5
    v_fmac_f32 v131, v161, v6
    v_fmac_f32 v146, v161, v7
    v_fmac_f32 v147, v161, v8
    v_fmac_f32 v132, v162, v5
    v_fmac_f32 v133, v162, v6
    v_fmac_f32 v148, v162, v7
    v_fmac_f32 v149, v162, v8
    v_fmac_f32 v134, v163, v5
    v_fmac_f32 v135, v163, v6
    v_fmac_f32 v150, v163, v7
    v_fmac_f32 v151, v163, v8
    v_fmac_f32 v136, v164, v5
    v_fmac_f32 v137, v164, v6
    v_fmac_f32 v152, v164, v7
    v_fmac_f32 v153, v164, v8
    v_fmac_f32 v138, v165, v5
    v_fmac_f32 v139, v165, v6
    v_fmac_f32 v154, v165, v7
    v_fmac_f32 v155, v165, v8
    v_fmac_f32 v140, v166, v5
    v_fmac_f32 v141, v166, v6
    v_fmac_f32 v156, v166, v7
    v_fmac_f32 v157, v166, v8
    v_fmac_f32 v142, v167, v5
    v_fmac_f32 v143, v167, v6
    v_fmac_f32 v158, v167, v7
    v_fmac_f32 v159, v167, v8
    s_waitcnt lgkmcnt(0)
    ds_read_b128 v[160:163], v4 offset:1152
    ds_read_b128 v[164:167], v4 offset:1168
    v_lshlrev_b32 v5, 16, v83
    v_and_b32 v6, 0xffff0000, v83
    v_lshlrev_b32 v7, 16, v115
    v_and_b32 v8, 0xffff0000, v115
    v_fmac_f32 v128, v168, v5
    v_fmac_f32 v129, v168, v6
    v_fmac_f32 v144, v168, v7
    v_fmac_f32 v145, v168, v8
    v_fmac_f32 v130, v169, v5
    v_fmac_f32 v131, v169, v6
    v_fmac_f32 v146, v169, v7
    v_fmac_f32 v147, v169, v8
    v_fmac_f32 v132, v170, v5
    v_fmac_f32 v133, v170, v6
    v_fmac_f32 v148, v170, v7
    v_fmac_f32 v149, v170, v8
    v_fmac_f32 v134, v171, v5
    v_fmac_f32 v135, v171, v6
    v_fmac_f32 v150, v171, v7
    v_fmac_f32 v151, v171, v8
    v_fmac_f32 v136, v172, v5
    v_fmac_f32 v137, v172, v6
    v_fmac_f32 v152, v172, v7
    v_fmac_f32 v153, v172, v8
    v_fmac_f32 v138, v173, v5
    v_fmac_f32 v139, v173, v6
    v_fmac_f32 v154, v173, v7
    v_fmac_f32 v155, v173, v8
    v_fmac_f32 v140, v174, v5
    v_fmac_f32 v141, v174, v6
    v_fmac_f32 v156, v174, v7
    v_fmac_f32 v157, v174, v8
    v_fmac_f32 v142, v175, v5
    v_fmac_f32 v143, v175, v6
    v_fmac_f32 v158, v175, v7
    v_fmac_f32 v159, v175, v8
    s_waitcnt lgkmcnt(0)
    ds_read_b128 v[168:171], v4 offset:1184
    ds_read_b128 v[172:175], v4 offset:1200
    v_lshlrev_b32 v5, 16, v84
    v_and_b32 v6, 0xffff0000, v84
    v_lshlrev_b32 v7, 16, v116
    v_and_b32 v8, 0xffff0000, v116
    v_fmac_f32 v128, v160, v5
    v_fmac_f32 v129, v160, v6
    v_fmac_f32 v144, v160, v7
    v_fmac_f32 v145, v160, v8
    v_fmac_f32 v130, v161, v5
    v_fmac_f32 v131, v161, v6
    v_fmac_f32 v146, v161, v7
    v_fmac_f32 v147, v161, v8
    v_fmac_f32 v132, v162, v5
    v_fmac_f32 v133, v162, v6
    v_fmac_f32 v148, v162, v7
    v_fmac_f32 v149, v162, v8
    v_fmac_f32 v134, v163, v5
    v_fmac_f32 v135, v163, v6
    v_fmac_f32 v150, v163, v7
    v_fmac_f32 v151, v163, v8
    v_fmac_f32 v136, v164, v5
    v_fmac_f32 v137, v164, v6
    v_fmac_f32 v152, v164, v7
    v_fmac_f32 v153, v164, v8
    v_fmac_f32 v138, v165, v5
    v_fmac_f32 v139, v165, v6
    v_fmac_f32 v154, v165, v7
    v_fmac_f32 v155, v165, v8
    v_fmac_f32 v140, v166, v5
    v_fmac_f32 v141, v166, v6
    v_fmac_f32 v156, v166, v7
    v_fmac_f32 v157, v166, v8
    v_fmac_f32 v142, v167, v5
    v_fmac_f32 v143, v167, v6
    v_fmac_f32 v158, v167, v7
    v_fmac_f32 v159, v167, v8
    s_waitcnt lgkmcnt(0)
    ds_read_b128 v[160:163], v4 offset:1216
    ds_read_b128 v[164:167], v4 offset:1232
    v_lshlrev_b32 v5, 16, v85
    v_and_b32 v6, 0xffff0000, v85
    v_lshlrev_b32 v7, 16, v117
    v_and_b32 v8, 0xffff0000, v117
    v_fmac_f32 v128, v168, v5
    v_fmac_f32 v129, v168, v6
    v_fmac_f32 v144, v168, v7
    v_fmac_f32 v145, v168, v8
    v_fmac_f32 v130, v169, v5
    v_fmac_f32 v131, v169, v6
    v_fmac_f32 v146, v169, v7
    v_fmac_f32 v147, v169, v8
    v_fmac_f32 v132, v170, v5
    v_fmac_f32 v133, v170, v6
    v_fmac_f32 v148, v170, v7
    v_fmac_f32 v149, v170, v8
    v_fmac_f32 v134, v171, v5
    v_fmac_f32 v135, v171, v6
    v_fmac_f32 v150, v171, v7
    v_fmac_f32 v151, v171, v8
    v_fmac_f32 v136, v172, v5
    v_fmac_f32 v137, v172, v6
    v_fmac_f32 v152, v172, v7
    v_fmac_f32 v153, v172, v8
    v_fmac_f32 v138, v173, v5
    v_fmac_f32 v139, v173, v6
    v_fmac_f32 v154, v173, v7
    v_fmac_f32 v155, v173, v8
    v_fmac_f32 v140, v174, v5
    v_fmac_f32 v141, v174, v6
    v_fmac_f32 v156, v174, v7
    v_fmac_f32 v157, v174, v8
    v_fmac_f32 v142, v175, v5
    v_fmac_f32 v143, v175, v6
    v_fmac_f32 v158, v175, v7
    v_fmac_f32 v159, v175, v8
    s_waitcnt lgkmcnt(0)
    ds_read_b128 v[168:171], v4 offset:1248
    ds_read_b128 v[172:175], v4 offset:1264
    v_lshlrev_b32 v5, 16, v86
    v_and_b32 v6, 0xffff0000, v86
    v_lshlrev_b32 v7, 16, v118
    v_and_b32 v8, 0xffff0000, v118
    v_fmac_f32 v128, v160, v5
    v_fmac_f32 v129, v160, v6
    v_fmac_f32 v144, v160, v7
    v_fmac_f32 v145, v160, v8
    v_fmac_f32 v130, v161, v5
    v_fmac_f32 v131, v161, v6
    v_fmac_f32 v146, v161, v7
    v_fmac_f32 v147, v161, v8
    v_fmac_f32 v132, v162, v5
    v_fmac_f32 v133, v162, v6
    v_fmac_f32 v148, v162, v7
    v_fmac_f32 v149, v162, v8
    v_fmac_f32 v134, v163, v5
    v_fmac_f32 v135, v163, v6
    v_fmac_f32 v150, v163, v7
    v_fmac_f32 v151, v163, v8
    v_fmac_f32 v136, v164, v5
    v_fmac_f32 v137, v164, v6
    v_fmac_f32 v152, v164, v7
    v_fmac_f32 v153, v164, v8
    v_fmac_f32 v138, v165, v5
    v_fmac_f32 v139, v165, v6
    v_fmac_f32 v154, v165, v7
    v_fmac_f32 v155, v165, v8
    v_fmac_f32 v140, v166, v5
    v_fmac_f32 v141, v166, v6
    v_fmac_f32 v156, v166, v7
    v_fmac_f32 v157, v166, v8
    v_fmac_f32 v142, v167, v5
    v_fmac_f32 v143, v167, v6
    v_fmac_f32 v158, v167, v7
    v_fmac_f32 v159, v167, v8
    s_waitcnt lgkmcnt(0)
    ds_read_b128 v[160:163], v4 offset:1280
    ds_read_b128 v[164:167], v4 offset:1296
    v_lshlrev_b32 v5, 16, v87
    v_and_b32 v6, 0xffff0000, v87
    v_lshlrev_b32 v7, 16, v119
    v_and_b32 v8, 0xffff0000, v119
    v_fmac_f32 v128, v168, v5
    v_fmac_f32 v129, v168, v6
    v_fmac_f32 v144, v168, v7
    v_fmac_f32 v145, v168, v8
    v_fmac_f32 v130, v169, v5
    v_fmac_f32 v131, v169, v6
    v_fmac_f32 v146, v169, v7
    v_fmac_f32 v147, v169, v8
    v_fmac_f32 v132, v170, v5
    v_fmac_f32 v133, v170, v6
    v_fmac_f32 v148, v170, v7
    v_fmac_f32 v149, v170, v8
    v_fmac_f32 v134, v171, v5
    v_fmac_f32 v135, v171, v6
    v_fmac_f32 v150, v171, v7
    v_fmac_f32 v151, v171, v8
    v_fmac_f32 v136, v172, v5
    v_fmac_f32 v137, v172, v6
    v_fmac_f32 v152, v172, v7
    v_fmac_f32 v153, v172, v8
    v_fmac_f32 v138, v173, v5
    v_fmac_f32 v139, v173, v6
    v_fmac_f32 v154, v173, v7
    v_fmac_f32 v155, v173, v8
    v_fmac_f32 v140, v174, v5
    v_fmac_f32 v141, v174, v6
    v_fmac_f32 v156, v174, v7
    v_fmac_f32 v157, v174, v8
    v_fmac_f32 v142, v175, v5
    v_fmac_f32 v143, v175, v6
    v_fmac_f32 v158, v175, v7
    v_fmac_f32 v159, v175, v8
    s_waitcnt lgkmcnt(0)
    ds_read_b128 v[168:171], v4 offset:1312
    ds_read_b128 v[172:175], v4 offset:1328
    v_lshlrev_b32 v5, 16, v88
    v_and_b32 v6, 0xffff0000, v88
    v_lshlrev_b32 v7, 16, v120
    v_and_b32 v8, 0xffff0000, v120
    v_fmac_f32 v128, v160, v5
    v_fmac_f32 v129, v160, v6
    v_fmac_f32 v144, v160, v7
    v_fmac_f32 v145, v160, v8
    v_fmac_f32 v130, v161, v5
    v_fmac_f32 v131, v161, v6
    v_fmac_f32 v146, v161, v7
    v_fmac_f32 v147, v161, v8
    v_fmac_f32 v132, v162, v5
    v_fmac_f32 v133, v162, v6
    v_fmac_f32 v148, v162, v7
    v_fmac_f32 v149, v162, v8
    v_fmac_f32 v134, v163, v5
    v_fmac_f32 v135, v163, v6
    v_fmac_f32 v150, v163, v7
    v_fmac_f32 v151, v163, v8
    v_fmac_f32 v136, v164, v5
    v_fmac_f32 v137, v164, v6
    v_fmac_f32 v152, v164, v7
    v_fmac_f32 v153, v164, v8
    v_fmac_f32 v138, v165, v5
    v_fmac_f32 v139, v165, v6
    v_fmac_f32 v154, v165, v7
    v_fmac_f32 v155, v165, v8
    v_fmac_f32 v140, v166, v5
    v_fmac_f32 v141, v166, v6
    v_fmac_f32 v156, v166, v7
    v_fmac_f32 v157, v166, v8
    v_fmac_f32 v142, v167, v5
    v_fmac_f32 v143, v167, v6
    v_fmac_f32 v158, v167, v7
    v_fmac_f32 v159, v167, v8
    s_waitcnt lgkmcnt(0)
    ds_read_b128 v[160:163], v4 offset:1344
    ds_read_b128 v[164:167], v4 offset:1360
    v_lshlrev_b32 v5, 16, v89
    v_and_b32 v6, 0xffff0000, v89
    v_lshlrev_b32 v7, 16, v121
    v_and_b32 v8, 0xffff0000, v121
    v_fmac_f32 v128, v168, v5
    v_fmac_f32 v129, v168, v6
    v_fmac_f32 v144, v168, v7
    v_fmac_f32 v145, v168, v8
    v_fmac_f32 v130, v169, v5
    v_fmac_f32 v131, v169, v6
    v_fmac_f32 v146, v169, v7
    v_fmac_f32 v147, v169, v8
    v_fmac_f32 v132, v170, v5
    v_fmac_f32 v133, v170, v6
    v_fmac_f32 v148, v170, v7
    v_fmac_f32 v149, v170, v8
    v_fmac_f32 v134, v171, v5
    v_fmac_f32 v135, v171, v6
    v_fmac_f32 v150, v171, v7
    v_fmac_f32 v151, v171, v8
    v_fmac_f32 v136, v172, v5
    v_fmac_f32 v137, v172, v6
    v_fmac_f32 v152, v172, v7
    v_fmac_f32 v153, v172, v8
    v_fmac_f32 v138, v173, v5
    v_fmac_f32 v139, v173, v6
    v_fmac_f32 v154, v173, v7
    v_fmac_f32 v155, v173, v8
    v_fmac_f32 v140, v174, v5
    v_fmac_f32 v141, v174, v6
    v_fmac_f32 v156, v174, v7
    v_fmac_f32 v157, v174, v8
    v_fmac_f32 v142, v175, v5
    v_fmac_f32 v143, v175, v6
    v_fmac_f32 v158, v175, v7
    v_fmac_f32 v159, v175, v8
    s_waitcnt lgkmcnt(0)
    ds_read_b128 v[168:171], v4 offset:1376
    ds_read_b128 v[172:175], v4 offset:1392
    v_lshlrev_b32 v5, 16, v90
    v_and_b32 v6, 0xffff0000, v90
    v_lshlrev_b32 v7, 16, v122
    v_and_b32 v8, 0xffff0000, v122
    v_fmac_f32 v128, v160, v5
    v_fmac_f32 v129, v160, v6
    v_fmac_f32 v144, v160, v7
    v_fmac_f32 v145, v160, v8
    v_fmac_f32 v130, v161, v5
    v_fmac_f32 v131, v161, v6
    v_fmac_f32 v146, v161, v7
    v_fmac_f32 v147, v161, v8
    v_fmac_f32 v132, v162, v5
    v_fmac_f32 v133, v162, v6
    v_fmac_f32 v148, v162, v7
    v_fmac_f32 v149, v162, v8
    v_fmac_f32 v134, v163, v5
    v_fmac_f32 v135, v163, v6
    v_fmac_f32 v150, v163, v7
    v_fmac_f32 v151, v163, v8
    v_fmac_f32 v136, v164, v5
    v_fmac_f32 v137, v164, v6
    v_fmac_f32 v152, v164, v7
    v_fmac_f32 v153, v164, v8
    v_fmac_f32 v138, v165, v5
    v_fmac_f32 v139, v165, v6
    v_fmac_f32 v154, v165, v7
    v_fmac_f32 v155, v165, v8
    v_fmac_f32 v140, v166, v5
    v_fmac_f32 v141, v166, v6
    v_fmac_f32 v156, v166, v7
    v_fmac_f32 v157, v166, v8
    v_fmac_f32 v142, v167, v5
    v_fmac_f32 v143, v167, v6
    v_fmac_f32 v158, v167, v7
    v_fmac_f32 v159, v167, v8
    s_waitcnt lgkmcnt(0)
    ds_read_b128 v[160:163], v4 offset:1408
    ds_read_b128 v[164:167], v4 offset:1424
    v_lshlrev_b32 v5, 16, v91
    v_and_b32 v6, 0xffff0000, v91
    v_lshlrev_b32 v7, 16, v123
    v_and_b32 v8, 0xffff0000, v123
    v_fmac_f32 v128, v168, v5
    v_fmac_f32 v129, v168, v6
    v_fmac_f32 v144, v168, v7
    v_fmac_f32 v145, v168, v8
    v_fmac_f32 v130, v169, v5
    v_fmac_f32 v131, v169, v6
    v_fmac_f32 v146, v169, v7
    v_fmac_f32 v147, v169, v8
    v_fmac_f32 v132, v170, v5
    v_fmac_f32 v133, v170, v6
    v_fmac_f32 v148, v170, v7
    v_fmac_f32 v149, v170, v8
    v_fmac_f32 v134, v171, v5
    v_fmac_f32 v135, v171, v6
    v_fmac_f32 v150, v171, v7
    v_fmac_f32 v151, v171, v8
    v_fmac_f32 v136, v172, v5
    v_fmac_f32 v137, v172, v6
    v_fmac_f32 v152, v172, v7
    v_fmac_f32 v153, v172, v8
    v_fmac_f32 v138, v173, v5
    v_fmac_f32 v139, v173, v6
    v_fmac_f32 v154, v173, v7
    v_fmac_f32 v155, v173, v8
    v_fmac_f32 v140, v174, v5
    v_fmac_f32 v141, v174, v6
    v_fmac_f32 v156, v174, v7
    v_fmac_f32 v157, v174, v8
    v_fmac_f32 v142, v175, v5
    v_fmac_f32 v143, v175, v6
    v_fmac_f32 v158, v175, v7
    v_fmac_f32 v159, v175, v8
    s_waitcnt lgkmcnt(0)
    ds_read_b128 v[168:171], v4 offset:1440
    ds_read_b128 v[172:175], v4 offset:1456
    v_lshlrev_b32 v5, 16, v92
    v_and_b32 v6, 0xffff0000, v92
    v_lshlrev_b32 v7, 16, v124
    v_and_b32 v8, 0xffff0000, v124
    v_fmac_f32 v128, v160, v5
    v_fmac_f32 v129, v160, v6
    v_fmac_f32 v144, v160, v7
    v_fmac_f32 v145, v160, v8
    v_fmac_f32 v130, v161, v5
    v_fmac_f32 v131, v161, v6
    v_fmac_f32 v146, v161, v7
    v_fmac_f32 v147, v161, v8
    v_fmac_f32 v132, v162, v5
    v_fmac_f32 v133, v162, v6
    v_fmac_f32 v148, v162, v7
    v_fmac_f32 v149, v162, v8
    v_fmac_f32 v134, v163, v5
    v_fmac_f32 v135, v163, v6
    v_fmac_f32 v150, v163, v7
    v_fmac_f32 v151, v163, v8
    v_fmac_f32 v136, v164, v5
    v_fmac_f32 v137, v164, v6
    v_fmac_f32 v152, v164, v7
    v_fmac_f32 v153, v164, v8
    v_fmac_f32 v138, v165, v5
    v_fmac_f32 v139, v165, v6
    v_fmac_f32 v154, v165, v7
    v_fmac_f32 v155, v165, v8
    v_fmac_f32 v140, v166, v5
    v_fmac_f32 v141, v166, v6
    v_fmac_f32 v156, v166, v7
    v_fmac_f32 v157, v166, v8
    v_fmac_f32 v142, v167, v5
    v_fmac_f32 v143, v167, v6
    v_fmac_f32 v158, v167, v7
    v_fmac_f32 v159, v167, v8
    s_waitcnt lgkmcnt(0)
    ds_read_b128 v[160:163], v4 offset:1472
    ds_read_b128 v[164:167], v4 offset:1488
    v_lshlrev_b32 v5, 16, v93
    v_and_b32 v6, 0xffff0000, v93
    v_lshlrev_b32 v7, 16, v125
    v_and_b32 v8, 0xffff0000, v125
    v_fmac_f32 v128, v168, v5
    v_fmac_f32 v129, v168, v6
    v_fmac_f32 v144, v168, v7
    v_fmac_f32 v145, v168, v8
    v_fmac_f32 v130, v169, v5
    v_fmac_f32 v131, v169, v6
    v_fmac_f32 v146, v169, v7
    v_fmac_f32 v147, v169, v8
    v_fmac_f32 v132, v170, v5
    v_fmac_f32 v133, v170, v6
    v_fmac_f32 v148, v170, v7
    v_fmac_f32 v149, v170, v8
    v_fmac_f32 v134, v171, v5
    v_fmac_f32 v135, v171, v6
    v_fmac_f32 v150, v171, v7
    v_fmac_f32 v151, v171, v8
    v_fmac_f32 v136, v172, v5
    v_fmac_f32 v137, v172, v6
    v_fmac_f32 v152, v172, v7
    v_fmac_f32 v153, v172, v8
    v_fmac_f32 v138, v173, v5
    v_fmac_f32 v139, v173, v6
    v_fmac_f32 v154, v173, v7
    v_fmac_f32 v155, v173, v8
    v_fmac_f32 v140, v174, v5
    v_fmac_f32 v141, v174, v6
    v_fmac_f32 v156, v174, v7
    v_fmac_f32 v157, v174, v8
    v_fmac_f32 v142, v175, v5
    v_fmac_f32 v143, v175, v6
    v_fmac_f32 v158, v175, v7
    v_fmac_f32 v159, v175, v8
    s_waitcnt lgkmcnt(0)
    ds_read_b128 v[168:171], v4 offset:1504
    ds_read_b128 v[172:175], v4 offset:1520
    v_lshlrev_b32 v5, 16, v94
    v_and_b32 v6, 0xffff0000, v94
    v_lshlrev_b32 v7, 16, v126
    v_and_b32 v8, 0xffff0000, v126
    v_fmac_f32 v128, v160, v5
    v_fmac_f32 v129, v160, v6
    v_fmac_f32 v144, v160, v7
    v_fmac_f32 v145, v160, v8
    v_fmac_f32 v130, v161, v5
    v_fmac_f32 v131, v161, v6
    v_fmac_f32 v146, v161, v7
    v_fmac_f32 v147, v161, v8
    v_fmac_f32 v132, v162, v5
    v_fmac_f32 v133, v162, v6
    v_fmac_f32 v148, v162, v7
    v_fmac_f32 v149, v162, v8
    v_fmac_f32 v134, v163, v5
    v_fmac_f32 v135, v163, v6
    v_fmac_f32 v150, v163, v7
    v_fmac_f32 v151, v163, v8
    v_fmac_f32 v136, v164, v5
    v_fmac_f32 v137, v164, v6
    v_fmac_f32 v152, v164, v7
    v_fmac_f32 v153, v164, v8
    v_fmac_f32 v138, v165, v5
    v_fmac_f32 v139, v165, v6
    v_fmac_f32 v154, v165, v7
    v_fmac_f32 v155, v165, v8
    v_fmac_f32 v140, v166, v5
    v_fmac_f32 v141, v166, v6
    v_fmac_f32 v156, v166, v7
    v_fmac_f32 v157, v166, v8
    v_fmac_f32 v142, v167, v5
    v_fmac_f32 v143, v167, v6
    v_fmac_f32 v158, v167, v7
    v_fmac_f32 v159, v167, v8
    s_waitcnt lgkmcnt(0)
    v_lshlrev_b32 v5, 16, v95
    v_and_b32 v6, 0xffff0000, v95
    v_lshlrev_b32 v7, 16, v127
    v_and_b32 v8, 0xffff0000, v127
    v_fmac_f32 v128, v168, v5
    v_fmac_f32 v129, v168, v6
    v_fmac_f32 v144, v168, v7
    v_fmac_f32 v145, v168, v8
    v_fmac_f32 v130, v169, v5
    v_fmac_f32 v131, v169, v6
    v_fmac_f32 v146, v169, v7
    v_fmac_f32 v147, v169, v8
    v_fmac_f32 v132, v170, v5
    v_fmac_f32 v133, v170, v6
    v_fmac_f32 v148, v170, v7
    v_fmac_f32 v149, v170, v8
    v_fmac_f32 v134, v171, v5
    v_fmac_f32 v135, v171, v6
    v_fmac_f32 v150, v171, v7
    v_fmac_f32 v151, v171, v8
    v_fmac_f32 v136, v172, v5
    v_fmac_f32 v137, v172, v6
    v_fmac_f32 v152, v172, v7
    v_fmac_f32 v153, v172, v8
    v_fmac_f32 v138, v173, v5
    v_fmac_f32 v139, v173, v6
    v_fmac_f32 v154, v173, v7
    v_fmac_f32 v155, v173, v8
    v_fmac_f32 v140, v174, v5
    v_fmac_f32 v141, v174, v6
    v_fmac_f32 v156, v174, v7
    v_fmac_f32 v157, v174, v8
    v_fmac_f32 v142, v175, v5
    v_fmac_f32 v143, v175, v6
    v_fmac_f32 v158, v175, v7
    v_fmac_f32 v159, v175, v8
    s_lshl_b32 s40, s20, 13
    v_lshlrev_b32 v4, 2, v0
    v_add_u32 v5, s40, v4
    ds_write_b32 v5, v128 offset:8192
    ds_write_b32 v5, v129 offset:8448
    ds_write_b32 v5, v130 offset:8704
    ds_write_b32 v5, v131 offset:8960
    ds_write_b32 v5, v132 offset:9216
    ds_write_b32 v5, v133 offset:9472
    ds_write_b32 v5, v134 offset:9728
    ds_write_b32 v5, v135 offset:9984
    ds_write_b32 v5, v136 offset:10240
    ds_write_b32 v5, v137 offset:10496
    ds_write_b32 v5, v138 offset:10752
    ds_write_b32 v5, v139 offset:11008
    ds_write_b32 v5, v140 offset:11264
    ds_write_b32 v5, v141 offset:11520
    ds_write_b32 v5, v142 offset:11776
    ds_write_b32 v5, v143 offset:12032
    ds_write_b32 v5, v144 offset:12288
    ds_write_b32 v5, v145 offset:12544
    ds_write_b32 v5, v146 offset:12800
    ds_write_b32 v5, v147 offset:13056
    ds_write_b32 v5, v148 offset:13312
    ds_write_b32 v5, v149 offset:13568
    ds_write_b32 v5, v150 offset:13824
    ds_write_b32 v5, v151 offset:14080
    ds_write_b32 v5, v152 offset:14336
    ds_write_b32 v5, v153 offset:14592
    ds_write_b32 v5, v154 offset:14848
    ds_write_b32 v5, v155 offset:15104
    ds_write_b32 v5, v156 offset:15360
    ds_write_b32 v5, v157 offset:15616
    ds_write_b32 v5, v158 offset:15872
    ds_write_b32 v5, v159 offset:16128
    s_waitcnt lgkmcnt(0)
    s_barrier
    s_lshl_b32 s40, s20, 11
    v_add_u32 v5, s40, v4
    ds_read_b32 v64, v5 offset:8192
    ds_read_b32 v65, v5 offset:16384
    ds_read_b32 v66, v5 offset:24576
    ds_read_b32 v67, v5 offset:32768
    ds_read_b32 v68, v5 offset:8448
    ds_read_b32 v69, v5 offset:16640
    ds_read_b32 v70, v5 offset:24832
    ds_read_b32 v71, v5 offset:33024
    ds_read_b32 v72, v5 offset:8704
    ds_read_b32 v73, v5 offset:16896
    ds_read_b32 v74, v5 offset:25088
    ds_read_b32 v75, v5 offset:33280
    ds_read_b32 v76, v5 offset:8960
    ds_read_b32 v77, v5 offset:17152
    ds_read_b32 v78, v5 offset:25344
    ds_read_b32 v79, v5 offset:33536
    ds_read_b32 v80, v5 offset:9216
    ds_read_b32 v81, v5 offset:17408
    ds_read_b32 v82, v5 offset:25600
    ds_read_b32 v83, v5 offset:33792
    ds_read_b32 v84, v5 offset:9472
    ds_read_b32 v85, v5 offset:17664
    ds_read_b32 v86, v5 offset:25856
    ds_read_b32 v87, v5 offset:34048
    ds_read_b32 v88, v5 offset:9728
    ds_read_b32 v89, v5 offset:17920
    ds_read_b32 v90, v5 offset:26112
    ds_read_b32 v91, v5 offset:34304
    ds_read_b32 v92, v5 offset:9984
    ds_read_b32 v93, v5 offset:18176
    ds_read_b32 v94, v5 offset:26368
    ds_read_b32 v95, v5 offset:34560
    s_waitcnt lgkmcnt(0)
    v_add_f32 v128, v64, v65
    v_add_f32 v66, v66, v67
    v_add_f32 v128, v128, v66
    v_add_f32 v129, v68, v69
    v_add_f32 v70, v70, v71
    v_add_f32 v129, v129, v70
    v_add_f32 v130, v72, v73
    v_add_f32 v74, v74, v75
    v_add_f32 v130, v130, v74
    v_add_f32 v131, v76, v77
    v_add_f32 v78, v78, v79
    v_add_f32 v131, v131, v78
    v_add_f32 v132, v80, v81
    v_add_f32 v82, v82, v83
    v_add_f32 v132, v132, v82
    v_add_f32 v133, v84, v85
    v_add_f32 v86, v86, v87
    v_add_f32 v133, v133, v86
    v_add_f32 v134, v88, v89
    v_add_f32 v90, v90, v91
    v_add_f32 v134, v134, v90
    v_add_f32 v135, v92, v93
    v_add_f32 v94, v94, v95
    v_add_f32 v135, v135, v94
    s_lshl_b32 s40, s22, 4
    s_lshl_b32 s41, s20, 2
    s_add_u32 s40, s40, s41
    s_mul_i32 s40, s40, 14336
    s_lshl_b32 s41, s21, 9
    s_add_u32 s40, s40, s41
    v_lshlrev_b32 v4, 3, v0
    buffer_store_dwordx2 v[128:129], v4, s[32:35], s40 offen
    s_add_u32 s40, s40, 14336
    buffer_store_dwordx2 v[130:131], v4, s[32:35], s40 offen
    s_add_u32 s40, s40, 14336
    buffer_store_dwordx2 v[132:133], v4, s[32:35], s40 offen
    s_add_u32 s40, s40, 14336
    buffer_store_dwordx2 v[134:135], v4, s[32:35], s40 offen
    s_add_u32 s40, s40, 14336
ffn1_kernel_exit1:
    s_endpgm
.section .rodata,"a"
.p2align 6
.amdhsa_kernel ffn1_kernel
  .amdhsa_next_free_vgpr 176
  .amdhsa_next_free_sgpr 80
  .amdhsa_accum_offset 176
  .amdhsa_group_segment_fixed_size 0
  .amdhsa_kernarg_size 88
  .amdhsa_user_sgpr_count 2
  .amdhsa_user_sgpr_kernarg_segment_ptr 1
  .amdhsa_system_sgpr_workgroup_id_x 1
.end_amdhsa_kernel

.text
.globl ffn2_kernel
.p2align 8
.type ffn2_kernel,@function
ffn2_kernel:
    s_cmp_ge_u32 s2, 224
    s_cbranch_scc1 ffn2_kernel_exit1
    s_load_dwordx2 s[10:11], s[0:1], 80
    s_load_dwordx2 s[4:5], s[0:1], 56
    v_lshrrev_b32 v1, 6, v0
    v_mov_b32 v3, v0
    v_and_b32 v0, 63, v0
    s_nop 0
    v_readfirstlane_b32 s20, v1
    s_and_b32 s21, s2, 7
    s_lshr_b32 s22, s2, 3
    s_waitcnt lgkmcnt(0)
    s_mov_b32 s12, s4
    s_and_b32 s13, s5, 0xffff
    s_mov_b32 s14, 0x700000
    s_mov_b32 s15, 0x20000
    s_add_u32 s32, s10, 0x2300000
    s_addc_u32 s33, s11, 0
    s_and_b32 s33, s33, 0xffff
    s_mov_b32 s34, 0x200000
    s_mov_b32 s35, 0x20000
    s_add_u32 s36, s10, 0x2500000
    s_addc_u32 s37, s11, 0
    s_and_b32 s37, s37, 0xffff
    s_mov_b32 s38, 0x100000
    s_mov_b32 s39, 0x20000
    s_lshl_b32 s23, s22, 7
    s_lshl_b32 s40, s20, 5
    s_add_u32 s23, s23, s40
    s_lshl_b32 s23, s23, 11
    s_lshl_b32 s40, s21, 8
    s_add_u32 s23, s23, s40
    v_lshlrev_b32 v2, 2, v0
    v_lshrrev_b32 v4, 5, v3
    v_mul_u32_u24 v5, 14336, v4
    v_and_b32 v6, 31, v3
    v_lshl_add_u32 v5, v6, 4, v5
    s_lshl_b32 s40, s22, 9
    buffer_load_dwordx4 v[96:99], v5, s[32:35], s40 offen
    s_add_u32 s40, s40, 114688
    buffer_load_dwordx4 v[100:103], v5, s[32:35], s40 offen
    s_add_u32 s40, s40, 114688
    buffer_load_dwordx4 v[104:107], v5, s[32:35], s40 offen
    s_add_u32 s40, s40, 114688
    buffer_load_dwordx4 v[108:111], v5, s[32:35], s40 offen
    s_add_u32 s40, s40, 114688
    buffer_load_dwordx4 v[112:115], v5, s[32:35], s40 offen
    s_add_u32 s40, s40, 114688
    buffer_load_dwordx4 v[116:119], v5, s[32:35], s40 offen
    s_add_u32 s40, s40, 114688
    buffer_load_dwordx4 v[120:123], v5, s[32:35], s40 offen
    s_add_u32 s40, s40, 114688
    buffer_load_dwordx4 v[124:127], v5, s[32:35], s40 offen
    s_add_u32 s40, s40, 114688
    buffer_load_dwordx4 v[128:131], v5, s[32:35], s40 offen
    s_add_u32 s40, s40, 114688
    buffer_load_dwordx4 v[132:135], v5, s[32:35], s40 offen
    s_add_u32 s40, s40, 114688
    buffer_load_dwordx4 v[136:139], v5, s[32:35], s40 offen
    s_add_u32 s40, s40, 114688
    buffer_load_dwordx4 v[140:143], v5, s[32:35], s40 offen
    s_add_u32 s40, s40, 114688
    buffer_load_dwordx4 v[144:147], v5, s[32:35], s40 offen
    s_add_u32 s40, s40, 114688
    buffer_load_dwordx4 v[148:151], v5, s[32:35], s40 offen
    s_add_u32 s40, s40, 114688
    buffer_load_dwordx4 v[152:155], v5, s[32:35], s40 offen
    s_add_u32 s40, s40, 114688
    buffer_load_dwordx4 v[156:159], v5, s[32:35], s40 offen
    s_add_u32 s40, s40, 114688
    buffer_load_dword v64, v2, s[12:15], s23 offen offset:0
    buffer_load_dword v65, v2, s[12:15], s23 offen offset:2048
    s_add_u32 s23, s23, 4096
    buffer_load_dword v66, v2, s[12:15], s23 offen offset:0
    buffer_load_dword v67, v2, s[12:15], s23 offen offset:2048
    s_add_u32 s23, s23, 4096
    buffer_load_dword v68, v2, s[12:15], s23 offen offset:0
    buffer_load_dword v69, v2, s[12:15], s23 offen offset:2048
    s_add_u32 s23, s23, 4096
    buffer_load_dword v70, v2, s[12:15], s23 offen offset:0
    buffer_load_dword v71, v2, s[12:15], s23 offen offset:2048
    s_add_u32 s23, s23, 4096
    buffer_load_dword v72, v2, s[12:15], s23 offen offset:0
    buffer_load_dword v73, v2, s[12:15], s23 offen offset:2048
    s_add_u32 s23, s23, 4096
    buffer_load_dword v74, v2, s[12:15], s23 offen offset:0
    buffer_load_dword v75, v2, s[12:15], s23 offen offset:2048
    s_add_u32 s23, s23, 4096
    buffer_load_dword v76, v2, s[12:15], s23 offen offset:0
    buffer_load_dword v77, v2, s[12:15], s23 offen offset:2048
    s_add_u32 s23, s23, 4096
    buffer_load_dword v78, v2, s[12:15], s23 offen offset:0
    buffer_load_dword v79, v2, s[12:15], s23 offen offset:2048
    s_add_u32 s23, s23, 4096
    buffer_load_dword v80, v2, s[12:15], s23 offen offset:0
    buffer_load_dword v81, v2, s[12:15], s23 offen offset:2048
    s_add_u32 s23, s23, 4096
    buffer_load_dword v82, v2, s[12:15], s23 offen offset:0
    buffer_load_dword v83, v2, s[12:15], s23 offen offset:2048
    s_add_u32 s23, s23, 4096
    buffer_load_dword v84, v2, s[12:15], s23 offen offset:0
    buffer_load_dword v85, v2, s[12:15], s23 offen offset:2048
    s_add_u32 s23, s23, 4096
    buffer_load_dword v86, v2, s[12:15], s23 offen offset:0
    buffer_load_dword v87, v2, s[12:15], s23 offen offset:2048
    s_add_u32 s23, s23, 4096
    buffer_load_dword v88, v2, s[12:15], s23 offen offset:0
    buffer_load_dword v89, v2, s[12:15], s23 offen offset:2048
    s_add_u32 s23, s23, 4096
    buffer_load_dword v90, v2, s[12:15], s23 offen offset:0
    buffer_load_dword v91, v2, s[12:15], s23 offen offset:2048
    s_add_u32 s23, s23, 4096
    buffer_load_dword v92, v2, s[12:15], s23 offen offset:0
    buffer_load_dword v93, v2, s[12:15], s23 offen offset:2048
    s_add_u32 s23, s23, 4096
    buffer_load_dword v94, v2, s[12:15], s23 offen offset:0
    buffer_load_dword v95, v2, s[12:15], s23 offen offset:2048
    s_add_u32 s23, s23, 4096
    s_waitcnt vmcnt(32)
    v_add_f32 v96, v96, v104
    v_add_f32 v96, v96, v112
    v_add_f32 v96, v96, v120
    v_add_f32 v96, v96, v128
    v_add_f32 v96, v96, v136
    v_add_f32 v96, v96, v144
    v_add_f32 v96, v96, v152
    v_add_f32 v97, v97, v105
    v_add_f32 v97, v97, v113
    v_add_f32 v97, v97, v121
    v_add_f32 v97, v97, v129
    v_add_f32 v97, v97, v137
    v_add_f32 v97, v97, v145
    v_add_f32 v97, v97, v153
    v_add_f32 v98, v98, v106
    v_add_f32 v98, v98, v114
    v_add_f32 v98, v98, v122
    v_add_f32 v98, v98, v130
    v_add_f32 v98, v98, v138
    v_add_f32 v98, v98, v146
    v_add_f32 v98, v98, v154
    v_add_f32 v99, v99, v107
    v_add_f32 v99, v99, v115
    v_add_f32 v99, v99, v123
    v_add_f32 v99, v99, v131
    v_add_f32 v99, v99, v139
    v_add_f32 v99, v99, v147
    v_add_f32 v99, v99, v155
    v_add_f32 v100, v100, v108
    v_add_f32 v100, v100, v116
    v_add_f32 v100, v100, v124
    v_add_f32 v100, v100, v132
    v_add_f32 v100, v100, v140
    v_add_f32 v100, v100, v148
    v_add_f32 v100, v100, v156
    v_add_f32 v101, v101, v109
    v_add_f32 v101, v101, v117
    v_add_f32 v101, v101, v125
    v_add_f32 v101, v101, v133
    v_add_f32 v101, v101, v141
    v_add_f32 v101, v101, v149
    v_add_f32 v101, v101, v157
    v_add_f32 v102, v102, v110
    v_add_f32 v102, v102, v118
    v_add_f32 v102, v102, v126
    v_add_f32 v102, v102, v134
    v_add_f32 v102, v102, v142
    v_add_f32 v102, v102, v150
    v_add_f32 v102, v102, v158
    v_add_f32 v103, v103, v111
    v_add_f32 v103, v103, v119
    v_add_f32 v103, v103, v127
    v_add_f32 v103, v103, v135
    v_add_f32 v103, v103, v143
    v_add_f32 v103, v103, v151
    v_add_f32 v103, v103, v159
    v_lshlrev_b32 v4, 2, v4
    v_lshl_add_u32 v4, v6, 7, v4
    v_cvt_pk_bf16_f32 v5, v96, v100
    v_lshlrev_b32 v96, 16, v5
    v_and_b32 v100, 0xffff0000, v5
    v_mul_f32 v5, 0x3fb8aa3b, v96
    v_exp_f32 v5, -v5
    s_nop 0
    v_add_f32 v5, 1.0, v5
    v_rcp_f32 v6, v5
    s_nop 0
    v_mul_f32 v7, v96, v6
    v_fma_f32 v160, -v7, v5, v96
    v_fma_f32 v7, v160, v6, v7
    v_cvt_pk_bf16_f32 v7, v7, v7
    v_lshlrev_b32 v7, 16, v7
    v_mul_f32 v7, v7, v100
    v_cvt_pk_bf16_f32 v7, v7, v7
    v_lshlrev_b32 v7, 16, v7
    ds_write_b32 v4, v7 offset:0
    v_cvt_pk_bf16_f32 v5, v97, v101
    v_lshlrev_b32 v97, 16, v5
    v_and_b32 v101, 0xffff0000, v5
    v_mul_f32 v5, 0x3fb8aa3b, v97
    v_exp_f32 v5, -v5
    s_nop 0
    v_add_f32 v5, 1.0, v5
    v_rcp_f32 v6, v5
    s_nop 0
    v_mul_f32 v7, v97, v6
    v_fma_f32 v160, -v7, v5, v97
    v_fma_f32 v7, v160, v6, v7
    v_cvt_pk_bf16_f32 v7, v7, v7
    v_lshlrev_b32 v7, 16, v7
    v_mul_f32 v7, v7, v101
    v_cvt_pk_bf16_f32 v7, v7, v7
    v_lshlrev_b32 v7, 16, v7
    ds_write_b32 v4, v7 offset:32
    v_cvt_pk_bf16_f32 v5, v98, v102
    v_lshlrev_b32 v98, 16, v5
    v_and_b32 v102, 0xffff0000, v5
    v_mul_f32 v5, 0x3fb8aa3b, v98
    v_exp_f32 v5, -v5
    s_nop 0
    v_add_f32 v5, 1.0, v5
    v_rcp_f32 v6, v5
    s_nop 0
    v_mul_f32 v7, v98, v6
    v_fma_f32 v160, -v7, v5, v98
    v_fma_f32 v7, v160, v6, v7
    v_cvt_pk_bf16_f32 v7, v7, v7
    v_lshlrev_b32 v7, 16, v7
    v_mul_f32 v7, v7, v102
    v_cvt_pk_bf16_f32 v7, v7, v7
    v_lshlrev_b32 v7, 16, v7
    ds_write_b32 v4, v7 offset:64
    v_cvt_pk_bf16_f32 v5, v99, v103
    v_lshlrev_b32 v99, 16, v5
    v_and_b32 v103, 0xffff0000, v5
    v_mul_f32 v5, 0x3fb8aa3b, v99
    v_exp_f32 v5, -v5
    s_nop 0
    v_add_f32 v5, 1.0, v5
    v_rcp_f32 v6, v5
    s_nop 0
    v_mul_f32 v7, v99, v6
    v_fma_f32 v160, -v7, v5, v99
    v_fma_f32 v7, v160, v6, v7
    v_cvt_pk_bf16_f32 v7, v7, v7
    v_lshlrev_b32 v7, 16, v7
    v_mul_f32 v7, v7, v103
    v_cvt_pk_bf16_f32 v7, v7, v7
    v_lshlrev_b32 v7, 16, v7
    ds_write_b32 v4, v7 offset:96
    s_waitcnt lgkmcnt(0)
    s_barrier
    s_lshl_b32 s40, s20, 10
    v_mov_b32 v4, s40
    v_mov_b32 v128, 0
    v_mov_b32 v129, 0
    v_mov_b32 v130, 0
    v_mov_b32 v131, 0
    v_mov_b32 v132, 0
    v_mov_b32 v133, 0
    v_mov_b32 v134, 0
    v_mov_b32 v135, 0
    v_mov_b32 v136, 0
    v_mov_b32 v137, 0
    v_mov_b32 v138, 0
    v_mov_b32 v139, 0
    v_mov_b32 v140, 0
    v_mov_b32 v141, 0
    v_mov_b32 v142, 0
    v_mov_b32 v143, 0
    s_waitcnt vmcnt(0)
    ds_read_b128 v[160:163], v4 offset:0
    ds_read_b128 v[164:167], v4 offset:16
    s_waitcnt lgkmcnt(0)
    ds_read_b128 v[168:171], v4 offset:32
    ds_read_b128 v[172:175], v4 offset:48
    v_lshlrev_b32 v5, 16, v64
    v_and_b32 v6, 0xffff0000, v64
    v_fmac_f32 v128, v160, v5
    v_fmac_f32 v129, v160, v6
    v_fmac_f32 v130, v161, v5
    v_fmac_f32 v131, v161, v6
    v_fmac_f32 v132, v162, v5
    v_fmac_f32 v133, v162, v6
    v_fmac_f32 v134, v163, v5
    v_fmac_f32 v135, v163, v6
    v_fmac_f32 v136, v164, v5
    v_fmac_f32 v137, v164, v6
    v_fmac_f32 v138, v165, v5
    v_fmac_f32 v139, v165, v6
    v_fmac_f32 v140, v166, v5
    v_fmac_f32 v141, v166, v6
    v_fmac_f32 v142, v167, v5
    v_fmac_f32 v143, v167, v6
    s_waitcnt lgkmcnt(0)
    ds_read_b128 v[160:163], v4 offset:64
    ds_read_b128 v[164:167], v4 offset:80
    v_lshlrev_b32 v5, 16, v65
    v_and_b32 v6, 0xffff0000, v65
    v_fmac_f32 v128, v168, v5
    v_fmac_f32 v129, v168, v6
    v_fmac_f32 v130, v169, v5
    v_fmac_f32 v131, v169, v6
    v_fmac_f32 v132, v170, v5
    v_fmac_f32 v133, v170, v6
    v_fmac_f32 v134, v171, v5
    v_fmac_f32 v135, v171, v6
    v_fmac_f32 v136, v172, v5
    v_fmac_f32 v137, v172, v6
    v_fmac_f32 v138, v173, v5
    v_fmac_f32 v139, v173, v6
    v_fmac_f32 v140, v174, v5
    v_fmac_f32 v141, v174, v6
    v_fmac_f32 v142, v175, v5
    v_fmac_f32 v143, v175, v6
    s_waitcnt lgkmcnt(0)
    ds_read_b128 v[168:171], v4 offset:96
    ds_read_b128 v[172:175], v4 offset:112
    v_lshlrev_b32 v5, 16, v66
    v_and_b32 v6, 0xffff0000, v66
    v_fmac_f32 v128, v160, v5
    v_fmac_f32 v129, v160, v6
    v_fmac_f32 v130, v161, v5
    v_fmac_f32 v131, v161, v6
    v_fmac_f32 v132, v162, v5
    v_fmac_f32 v133, v162, v6
    v_fmac_f32 v134, v163, v5
    v_fmac_f32 v135, v163, v6
    v_fmac_f32 v136, v164, v5
    v_fmac_f32 v137, v164, v6
    v_fmac_f32 v138, v165, v5
    v_fmac_f32 v139, v165, v6
    v_fmac_f32 v140, v166, v5
    v_fmac_f32 v141, v166, v6
    v_fmac_f32 v142, v167, v5
    v_fmac_f32 v143, v167, v6
    s_waitcnt lgkmcnt(0)
    ds_read_b128 v[160:163], v4 offset:128
    ds_read_b128 v[164:167], v4 offset:144
    v_lshlrev_b32 v5, 16, v67
    v_and_b32 v6, 0xffff0000, v67
    v_fmac_f32 v128, v168, v5
    v_fmac_f32 v129, v168, v6
    v_fmac_f32 v130, v169, v5
    v_fmac_f32 v131, v169, v6
    v_fmac_f32 v132, v170, v5
    v_fmac_f32 v133, v170, v6
    v_fmac_f32 v134, v171, v5
    v_fmac_f32 v135, v171, v6
    v_fmac_f32 v136, v172, v5
    v_fmac_f32 v137, v172, v6
    v_fmac_f32 v138, v173, v5
    v_fmac_f32 v139, v173, v6
    v_fmac_f32 v140, v174, v5
    v_fmac_f32 v141, v174, v6
    v_fmac_f32 v142, v175, v5
    v_fmac_f32 v143, v175, v6
    s_waitcnt lgkmcnt(0)
    ds_read_b128 v[168:171], v4 offset:160
    ds_read_b128 v[172:175], v4 offset:176
    v_lshlrev_b32 v5, 16, v68
    v_and_b32 v6, 0xffff0000, v68
    v_fmac_f32 v128, v160, v5
    v_fmac_f32 v129, v160, v6
    v_fmac_f32 v130, v161, v5
    v_fmac_f32 v131, v161, v6
    v_fmac_f32 v132, v162, v5
    v_fmac_f32 v133, v162, v6
    v_fmac_f32 v134, v163, v5
    v_fmac_f32 v135, v163, v6
    v_fmac_f32 v136, v164, v5
    v_fmac_f32 v137, v164, v6
    v_fmac_f32 v138, v165, v5
    v_fmac_f32 v139, v165, v6
    v_fmac_f32 v140, v166, v5
    v_fmac_f32 v141, v166, v6
    v_fmac_f32 v142, v167, v5
    v_fmac_f32 v143, v167, v6
    s_waitcnt lgkmcnt(0)
    ds_read_b128 v[160:163], v4 offset:192
    ds_read_b128 v[164:167], v4 offset:208
    v_lshlrev_b32 v5, 16, v69
    v_and_b32 v6, 0xffff0000, v69
    v_fmac_f32 v128, v168, v5
    v_fmac_f32 v129, v168, v6
    v_fmac_f32 v130, v169, v5
    v_fmac_f32 v131, v169, v6
    v_fmac_f32 v132, v170, v5
    v_fmac_f32 v133, v170, v6
    v_fmac_f32 v134, v171, v5
    v_fmac_f32 v135, v171, v6
    v_fmac_f32 v136, v172, v5
    v_fmac_f32 v137, v172, v6
    v_fmac_f32 v138, v173, v5
    v_fmac_f32 v139, v173, v6
    v_fmac_f32 v140, v174, v5
    v_fmac_f32 v141, v174, v6
    v_fmac_f32 v142, v175, v5
    v_fmac_f32 v143, v175, v6
    s_waitcnt lgkmcnt(0)
    ds_read_b128 v[168:171], v4 offset:224
    ds_read_b128 v[172:175], v4 offset:240
    v_lshlrev_b32 v5, 16, v70
    v_and_b32 v6, 0xffff0000, v70
    v_fmac_f32 v128, v160, v5
    v_fmac_f32 v129, v160, v6
    v_fmac_f32 v130, v161, v5
    v_fmac_f32 v131, v161, v6
    v_fmac_f32 v132, v162, v5
    v_fmac_f32 v133, v162, v6
    v_fmac_f32 v134, v163, v5
    v_fmac_f32 v135, v163, v6
    v_fmac_f32 v136, v164, v5
    v_fmac_f32 v137, v164, v6
    v_fmac_f32 v138, v165, v5
    v_fmac_f32 v139, v165, v6
    v_fmac_f32 v140, v166, v5
    v_fmac_f32 v141, v166, v6
    v_fmac_f32 v142, v167, v5
    v_fmac_f32 v143, v167, v6
    s_waitcnt lgkmcnt(0)
    ds_read_b128 v[160:163], v4 offset:256
    ds_read_b128 v[164:167], v4 offset:272
    v_lshlrev_b32 v5, 16, v71
    v_and_b32 v6, 0xffff0000, v71
    v_fmac_f32 v128, v168, v5
    v_fmac_f32 v129, v168, v6
    v_fmac_f32 v130, v169, v5
    v_fmac_f32 v131, v169, v6
    v_fmac_f32 v132, v170, v5
    v_fmac_f32 v133, v170, v6
    v_fmac_f32 v134, v171, v5
    v_fmac_f32 v135, v171, v6
    v_fmac_f32 v136, v172, v5
    v_fmac_f32 v137, v172, v6
    v_fmac_f32 v138, v173, v5
    v_fmac_f32 v139, v173, v6
    v_fmac_f32 v140, v174, v5
    v_fmac_f32 v141, v174, v6
    v_fmac_f32 v142, v175, v5
    v_fmac_f32 v143, v175, v6
    s_waitcnt lgkmcnt(0)
    ds_read_b128 v[168:171], v4 offset:288
    ds_read_b128 v[172:175], v4 offset:304
    v_lshlrev_b32 v5, 16, v72
    v_and_b32 v6, 0xffff0000, v72
    v_fmac_f32 v128, v160, v5
    v_fmac_f32 v129, v160, v6
    v_fmac_f32 v130, v161, v5
    v_fmac_f32 v131, v161, v6
    v_fmac_f32 v132, v162, v5
    v_fmac_f32 v133, v162, v6
    v_fmac_f32 v134, v163, v5
    v_fmac_f32 v135, v163, v6
    v_fmac_f32 v136, v164, v5
    v_fmac_f32 v137, v164, v6
    v_fmac_f32 v138, v165, v5
    v_fmac_f32 v139, v165, v6
    v_fmac_f32 v140, v166, v5
    v_fmac_f32 v141, v166, v6
    v_fmac_f32 v142, v167, v5
    v_fmac_f32 v143, v167, v6
    s_waitcnt lgkmcnt(0)
    ds_read_b128 v[160:163], v4 offset:320
    ds_read_b128 v[164:167], v4 offset:336
    v_lshlrev_b32 v5, 16, v73
    v_and_b32 v6, 0xffff0000, v73
    v_fmac_f32 v128, v168, v5
    v_fmac_f32 v129, v168, v6
    v_fmac_f32 v130, v169, v5
    v_fmac_f32 v131, v169, v6
    v_fmac_f32 v132, v170, v5
    v_fmac_f32 v133, v170, v6
    v_fmac_f32 v134, v171, v5
    v_fmac_f32 v135, v171, v6
    v_fmac_f32 v136, v172, v5
    v_fmac_f32 v137, v172, v6
    v_fmac_f32 v138, v173, v5
    v_fmac_f32 v139, v173, v6
    v_fmac_f32 v140, v174, v5
    v_fmac_f32 v141, v174, v6
    v_fmac_f32 v142, v175, v5
    v_fmac_f32 v143, v175, v6
    s_waitcnt lgkmcnt(0)
    ds_read_b128 v[168:171], v4 offset:352
    ds_read_b128 v[172:175], v4 offset:368
    v_lshlrev_b32 v5, 16, v74
    v_and_b32 v6, 0xffff0000, v74
    v_fmac_f32 v128, v160, v5
    v_fmac_f32 v129, v160, v6
    v_fmac_f32 v130, v161, v5
    v_fmac_f32 v131, v161, v6
    v_fmac_f32 v132, v162, v5
    v_fmac_f32 v133, v162, v6
    v_fmac_f32 v134, v163, v5
    v_fmac_f32 v135, v163, v6
    v_fmac_f32 v136, v164, v5
    v_fmac_f32 v137, v164, v6
    v_fmac_f32 v138, v165, v5
    v_fmac_f32 v139, v165, v6
    v_fmac_f32 v140, v166, v5
    v_fmac_f32 v141, v166, v6
    v_fmac_f32 v142, v167, v5
    v_fmac_f32 v143, v167, v6
    s_waitcnt lgkmcnt(0)
    ds_read_b128 v[160:163], v4 offset:384
    ds_read_b128 v[164:167], v4 offset:400
    v_lshlrev_b32 v5, 16, v75
    v_and_b32 v6, 0xffff0000, v75
    v_fmac_f32 v128, v168, v5
    v_fmac_f32 v129, v168, v6
    v_fmac_f32 v130, v169, v5
    v_fmac_f32 v131, v169, v6
    v_fmac_f32 v132, v170, v5
    v_fmac_f32 v133, v170, v6
    v_fmac_f32 v134, v171, v5
    v_fmac_f32 v135, v171, v6
    v_fmac_f32 v136, v172, v5
    v_fmac_f32 v137, v172, v6
    v_fmac_f32 v138, v173, v5
    v_fmac_f32 v139, v173, v6
    v_fmac_f32 v140, v174, v5
    v_fmac_f32 v141, v174, v6
    v_fmac_f32 v142, v175, v5
    v_fmac_f32 v143, v175, v6
    s_waitcnt lgkmcnt(0)
    ds_read_b128 v[168:171], v4 offset:416
    ds_read_b128 v[172:175], v4 offset:432
    v_lshlrev_b32 v5, 16, v76
    v_and_b32 v6, 0xffff0000, v76
    v_fmac_f32 v128, v160, v5
    v_fmac_f32 v129, v160, v6
    v_fmac_f32 v130, v161, v5
    v_fmac_f32 v131, v161, v6
    v_fmac_f32 v132, v162, v5
    v_fmac_f32 v133, v162, v6
    v_fmac_f32 v134, v163, v5
    v_fmac_f32 v135, v163, v6
    v_fmac_f32 v136, v164, v5
    v_fmac_f32 v137, v164, v6
    v_fmac_f32 v138, v165, v5
    v_fmac_f32 v139, v165, v6
    v_fmac_f32 v140, v166, v5
    v_fmac_f32 v141, v166, v6
    v_fmac_f32 v142, v167, v5
    v_fmac_f32 v143, v167, v6
    s_waitcnt lgkmcnt(0)
    ds_read_b128 v[160:163], v4 offset:448
    ds_read_b128 v[164:167], v4 offset:464
    v_lshlrev_b32 v5, 16, v77
    v_and_b32 v6, 0xffff0000, v77
    v_fmac_f32 v128, v168, v5
    v_fmac_f32 v129, v168, v6
    v_fmac_f32 v130, v169, v5
    v_fmac_f32 v131, v169, v6
    v_fmac_f32 v132, v170, v5
    v_fmac_f32 v133, v170, v6
    v_fmac_f32 v134, v171, v5
    v_fmac_f32 v135, v171, v6
    v_fmac_f32 v136, v172, v5
    v_fmac_f32 v137, v172, v6
    v_fmac_f32 v138, v173, v5
    v_fmac_f32 v139, v173, v6
    v_fmac_f32 v140, v174, v5
    v_fmac_f32 v141, v174, v6
    v_fmac_f32 v142, v175, v5
    v_fmac_f32 v143, v175, v6
    s_waitcnt lgkmcnt(0)
    ds_read_b128 v[168:171], v4 offset:480
    ds_read_b128 v[172:175], v4 offset:496
    v_lshlrev_b32 v5, 16, v78
    v_and_b32 v6, 0xffff0000, v78
    v_fmac_f32 v128, v160, v5
    v_fmac_f32 v129, v160, v6
    v_fmac_f32 v130, v161, v5
    v_fmac_f32 v131, v161, v6
    v_fmac_f32 v132, v162, v5
    v_fmac_f32 v133, v162, v6
    v_fmac_f32 v134, v163, v5
    v_fmac_f32 v135, v163, v6
    v_fmac_f32 v136, v164, v5
    v_fmac_f32 v137, v164, v6
    v_fmac_f32 v138, v165, v5
    v_fmac_f32 v139, v165, v6
    v_fmac_f32 v140, v166, v5
    v_fmac_f32 v141, v166, v6
    v_fmac_f32 v142, v167, v5
    v_fmac_f32 v143, v167, v6
    s_waitcnt lgkmcnt(0)
    ds_read_b128 v[160:163], v4 offset:512
    ds_read_b128 v[164:167], v4 offset:528
    v_lshlrev_b32 v5, 16, v79
    v_and_b32 v6, 0xffff0000, v79
    v_fmac_f32 v128, v168, v5
    v_fmac_f32 v129, v168, v6
    v_fmac_f32 v130, v169, v5
    v_fmac_f32 v131, v169, v6
    v_fmac_f32 v132, v170, v5
    v_fmac_f32 v133, v170, v6
    v_fmac_f32 v134, v171, v5
    v_fmac_f32 v135, v171, v6
    v_fmac_f32 v136, v172, v5
    v_fmac_f32 v137, v172, v6
    v_fmac_f32 v138, v173, v5
    v_fmac_f32 v139, v173, v6
    v_fmac_f32 v140, v174, v5
    v_fmac_f32 v141, v174, v6
    v_fmac_f32 v142, v175, v5
    v_fmac_f32 v143, v175, v6
    s_waitcnt lgkmcnt(0)
    ds_read_b128 v[168:171], v4 offset:544
    ds_read_b128 v[172:175], v4 offset:560
    v_lshlrev_b32 v5, 16, v80
    v_and_b32 v6, 0xffff0000, v80
    v_fmac_f32 v128, v160, v5
    v_fmac_f32 v129, v160, v6
    v_fmac_f32 v130, v161, v5
    v_fmac_f32 v131, v161, v6
    v_fmac_f32 v132, v162, v5
    v_fmac_f32 v133, v162, v6
    v_fmac_f32 v134, v163, v5
    v_fmac_f32 v135, v163, v6
    v_fmac_f32 v136, v164, v5
    v_fmac_f32 v137, v164, v6
    v_fmac_f32 v138, v165, v5
    v_fmac_f32 v139, v165, v6
    v_fmac_f32 v140, v166, v5
    v_fmac_f32 v141, v166, v6
    v_fmac_f32 v142, v167, v5
    v_fmac_f32 v143, v167, v6
    s_waitcnt lgkmcnt(0)
    ds_read_b128 v[160:163], v4 offset:576
    ds_read_b128 v[164:167], v4 offset:592
    v_lshlrev_b32 v5, 16, v81
    v_and_b32 v6, 0xffff0000, v81
    v_fmac_f32 v128, v168, v5
    v_fmac_f32 v129, v168, v6
    v_fmac_f32 v130, v169, v5
    v_fmac_f32 v131, v169, v6
    v_fmac_f32 v132, v170, v5
    v_fmac_f32 v133, v170, v6
    v_fmac_f32 v134, v171, v5
    v_fmac_f32 v135, v171, v6
    v_fmac_f32 v136, v172, v5
    v_fmac_f32 v137, v172, v6
    v_fmac_f32 v138, v173, v5
    v_fmac_f32 v139, v173, v6
    v_fmac_f32 v140, v174, v5
    v_fmac_f32 v141, v174, v6
    v_fmac_f32 v142, v175, v5
    v_fmac_f32 v143, v175, v6
    s_waitcnt lgkmcnt(0)
    ds_read_b128 v[168:171], v4 offset:608
    ds_read_b128 v[172:175], v4 offset:624
    v_lshlrev_b32 v5, 16, v82
    v_and_b32 v6, 0xffff0000, v82
    v_fmac_f32 v128, v160, v5
    v_fmac_f32 v129, v160, v6
    v_fmac_f32 v130, v161, v5
    v_fmac_f32 v131, v161, v6
    v_fmac_f32 v132, v162, v5
    v_fmac_f32 v133, v162, v6
    v_fmac_f32 v134, v163, v5
    v_fmac_f32 v135, v163, v6
    v_fmac_f32 v136, v164, v5
    v_fmac_f32 v137, v164, v6
    v_fmac_f32 v138, v165, v5
    v_fmac_f32 v139, v165, v6
    v_fmac_f32 v140, v166, v5
    v_fmac_f32 v141, v166, v6
    v_fmac_f32 v142, v167, v5
    v_fmac_f32 v143, v167, v6
    s_waitcnt lgkmcnt(0)
    ds_read_b128 v[160:163], v4 offset:640
    ds_read_b128 v[164:167], v4 offset:656
    v_lshlrev_b32 v5, 16, v83
    v_and_b32 v6, 0xffff0000, v83
    v_fmac_f32 v128, v168, v5
    v_fmac_f32 v129, v168, v6
    v_fmac_f32 v130, v169, v5
    v_fmac_f32 v131, v169, v6
    v_fmac_f32 v132, v170, v5
    v_fmac_f32 v133, v170, v6
    v_fmac_f32 v134, v171, v5
    v_fmac_f32 v135, v171, v6
    v_fmac_f32 v136, v172, v5
    v_fmac_f32 v137, v172, v6
    v_fmac_f32 v138, v173, v5
    v_fmac_f32 v139, v173, v6
    v_fmac_f32 v140, v174, v5
    v_fmac_f32 v141, v174, v6
    v_fmac_f32 v142, v175, v5
    v_fmac_f32 v143, v175, v6
    s_waitcnt lgkmcnt(0)
    ds_read_b128 v[168:171], v4 offset:672
    ds_read_b128 v[172:175], v4 offset:688
    v_lshlrev_b32 v5, 16, v84
    v_and_b32 v6, 0xffff0000, v84
    v_fmac_f32 v128, v160, v5
    v_fmac_f32 v129, v160, v6
    v_fmac_f32 v130, v161, v5
    v_fmac_f32 v131, v161, v6
    v_fmac_f32 v132, v162, v5
    v_fmac_f32 v133, v162, v6
    v_fmac_f32 v134, v163, v5
    v_fmac_f32 v135, v163, v6
    v_fmac_f32 v136, v164, v5
    v_fmac_f32 v137, v164, v6
    v_fmac_f32 v138, v165, v5
    v_fmac_f32 v139, v165, v6
    v_fmac_f32 v140, v166, v5
    v_fmac_f32 v141, v166, v6
    v_fmac_f32 v142, v167, v5
    v_fmac_f32 v143, v167, v6
    s_waitcnt lgkmcnt(0)
    ds_read_b128 v[160:163], v4 offset:704
    ds_read_b128 v[164:167], v4 offset:720
    v_lshlrev_b32 v5, 16, v85
    v_and_b32 v6, 0xffff0000, v85
    v_fmac_f32 v128, v168, v5
    v_fmac_f32 v129, v168, v6
    v_fmac_f32 v130, v169, v5
    v_fmac_f32 v131, v169, v6
    v_fmac_f32 v132, v170, v5
    v_fmac_f32 v133, v170, v6
    v_fmac_f32 v134, v171, v5
    v_fmac_f32 v135, v171, v6
    v_fmac_f32 v136, v172, v5
    v_fmac_f32 v137, v172, v6
    v_fmac_f32 v138, v173, v5
    v_fmac_f32 v139, v173, v6
    v_fmac_f32 v140, v174, v5
    v_fmac_f32 v141, v174, v6
    v_fmac_f32 v142, v175, v5
    v_fmac_f32 v143, v175, v6
    s_waitcnt lgkmcnt(0)
    ds_read_b128 v[168:171], v4 offset:736
    ds_read_b128 v[172:175], v4 offset:752
    v_lshlrev_b32 v5, 16, v86
    v_and_b32 v6, 0xffff0000, v86
    v_fmac_f32 v128, v160, v5
    v_fmac_f32 v129, v160, v6
    v_fmac_f32 v130, v161, v5
    v_fmac_f32 v131, v161, v6
    v_fmac_f32 v132, v162, v5
    v_fmac_f32 v133, v162, v6
    v_fmac_f32 v134, v163, v5
    v_fmac_f32 v135, v163, v6
    v_fmac_f32 v136, v164, v5
    v_fmac_f32 v137, v164, v6
    v_fmac_f32 v138, v165, v5
    v_fmac_f32 v139, v165, v6
    v_fmac_f32 v140, v166, v5
    v_fmac_f32 v141, v166, v6
    v_fmac_f32 v142, v167, v5
    v_fmac_f32 v143, v167, v6
    s_waitcnt lgkmcnt(0)
    ds_read_b128 v[160:163], v4 offset:768
    ds_read_b128 v[164:167], v4 offset:784
    v_lshlrev_b32 v5, 16, v87
    v_and_b32 v6, 0xffff0000, v87
    v_fmac_f32 v128, v168, v5
    v_fmac_f32 v129, v168, v6
    v_fmac_f32 v130, v169, v5
    v_fmac_f32 v131, v169, v6
    v_fmac_f32 v132, v170, v5
    v_fmac_f32 v133, v170, v6
    v_fmac_f32 v134, v171, v5
    v_fmac_f32 v135, v171, v6
    v_fmac_f32 v136, v172, v5
    v_fmac_f32 v137, v172, v6
    v_fmac_f32 v138, v173, v5
    v_fmac_f32 v139, v173, v6
    v_fmac_f32 v140, v174, v5
    v_fmac_f32 v141, v174, v6
    v_fmac_f32 v142, v175, v5
    v_fmac_f32 v143, v175, v6
    s_waitcnt lgkmcnt(0)
    ds_read_b128 v[168:171], v4 offset:800
    ds_read_b128 v[172:175], v4 offset:816
    v_lshlrev_b32 v5, 16, v88
    v_and_b32 v6, 0xffff0000, v88
    v_fmac_f32 v128, v160, v5
    v_fmac_f32 v129, v160, v6
    v_fmac_f32 v130, v161, v5
    v_fmac_f32 v131, v161, v6
    v_fmac_f32 v132, v162, v5
    v_fmac_f32 v133, v162, v6
    v_fmac_f32 v134, v163, v5
    v_fmac_f32 v135, v163, v6
    v_fmac_f32 v136, v164, v5
    v_fmac_f32 v137, v164, v6
    v_fmac_f32 v138, v165, v5
    v_fmac_f32 v139, v165, v6
    v_fmac_f32 v140, v166, v5
    v_fmac_f32 v141, v166, v6
    v_fmac_f32 v142, v167, v5
    v_fmac_f32 v143, v167, v6
    s_waitcnt lgkmcnt(0)
    ds_read_b128 v[160:163], v4 offset:832
    ds_read_b128 v[164:167], v4 offset:848
    v_lshlrev_b32 v5, 16, v89
    v_and_b32 v6, 0xffff0000, v89
    v_fmac_f32 v128, v168, v5
    v_fmac_f32 v129, v168, v6
    v_fmac_f32 v130, v169, v5
    v_fmac_f32 v131, v169, v6
    v_fmac_f32 v132, v170, v5
    v_fmac_f32 v133, v170, v6
    v_fmac_f32 v134, v171, v5
    v_fmac_f32 v135, v171, v6
    v_fmac_f32 v136, v172, v5
    v_fmac_f32 v137, v172, v6
    v_fmac_f32 v138, v173, v5
    v_fmac_f32 v139, v173, v6
    v_fmac_f32 v140, v174, v5
    v_fmac_f32 v141, v174, v6
    v_fmac_f32 v142, v175, v5
    v_fmac_f32 v143, v175, v6
    s_waitcnt lgkmcnt(0)
    ds_read_b128 v[168:171], v4 offset:864
    ds_read_b128 v[172:175], v4 offset:880
    v_lshlrev_b32 v5, 16, v90
    v_and_b32 v6, 0xffff0000, v90
    v_fmac_f32 v128, v160, v5
    v_fmac_f32 v129, v160, v6
    v_fmac_f32 v130, v161, v5
    v_fmac_f32 v131, v161, v6
    v_fmac_f32 v132, v162, v5
    v_fmac_f32 v133, v162, v6
    v_fmac_f32 v134, v163, v5
    v_fmac_f32 v135, v163, v6
    v_fmac_f32 v136, v164, v5
    v_fmac_f32 v137, v164, v6
    v_fmac_f32 v138, v165, v5
    v_fmac_f32 v139, v165, v6
    v_fmac_f32 v140, v166, v5
    v_fmac_f32 v141, v166, v6
    v_fmac_f32 v142, v167, v5
    v_fmac_f32 v143, v167, v6
    s_waitcnt lgkmcnt(0)
    ds_read_b128 v[160:163], v4 offset:896
    ds_read_b128 v[164:167], v4 offset:912
    v_lshlrev_b32 v5, 16, v91
    v_and_b32 v6, 0xffff0000, v91
    v_fmac_f32 v128, v168, v5
    v_fmac_f32 v129, v168, v6
    v_fmac_f32 v130, v169, v5
    v_fmac_f32 v131, v169, v6
    v_fmac_f32 v132, v170, v5
    v_fmac_f32 v133, v170, v6
    v_fmac_f32 v134, v171, v5
    v_fmac_f32 v135, v171, v6
    v_fmac_f32 v136, v172, v5
    v_fmac_f32 v137, v172, v6
    v_fmac_f32 v138, v173, v5
    v_fmac_f32 v139, v173, v6
    v_fmac_f32 v140, v174, v5
    v_fmac_f32 v141, v174, v6
    v_fmac_f32 v142, v175, v5
    v_fmac_f32 v143, v175, v6
    s_waitcnt lgkmcnt(0)
    ds_read_b128 v[168:171], v4 offset:928
    ds_read_b128 v[172:175], v4 offset:944
    v_lshlrev_b32 v5, 16, v92
    v_and_b32 v6, 0xffff0000, v92
    v_fmac_f32 v128, v160, v5
    v_fmac_f32 v129, v160, v6
    v_fmac_f32 v130, v161, v5
    v_fmac_f32 v131, v161, v6
    v_fmac_f32 v132, v162, v5
    v_fmac_f32 v133, v162, v6
    v_fmac_f32 v134, v163, v5
    v_fmac_f32 v135, v163, v6
    v_fmac_f32 v136, v164, v5
    v_fmac_f32 v137, v164, v6
    v_fmac_f32 v138, v165, v5
    v_fmac_f32 v139, v165, v6
    v_fmac_f32 v140, v166, v5
    v_fmac_f32 v141, v166, v6
    v_fmac_f32 v142, v167, v5
    v_fmac_f32 v143, v167, v6
    s_waitcnt lgkmcnt(0)
    ds_read_b128 v[160:163], v4 offset:960
    ds_read_b128 v[164:167], v4 offset:976
    v_lshlrev_b32 v5, 16, v93
    v_and_b32 v6, 0xffff0000, v93
    v_fmac_f32 v128, v168, v5
    v_fmac_f32 v129, v168, v6
    v_fmac_f32 v130, v169, v5
    v_fmac_f32 v131, v169, v6
    v_fmac_f32 v132, v170, v5
    v_fmac_f32 v133, v170, v6
    v_fmac_f32 v134, v171, v5
    v_fmac_f32 v135, v171, v6
    v_fmac_f32 v136, v172, v5
    v_fmac_f32 v137, v172, v6
    v_fmac_f32 v138, v173, v5
    v_fmac_f32 v139, v173, v6
    v_fmac_f32 v140, v174, v5
    v_fmac_f32 v141, v174, v6
    v_fmac_f32 v142, v175, v5
    v_fmac_f32 v143, v175, v6
    s_waitcnt lgkmcnt(0)
    ds_read_b128 v[168:171], v4 offset:992
    ds_read_b128 v[172:175], v4 offset:1008
    v_lshlrev_b32 v5, 16, v94
    v_and_b32 v6, 0xffff0000, v94
    v_fmac_f32 v128, v160, v5
    v_fmac_f32 v129, v160, v6
    v_fmac_f32 v130, v161, v5
    v_fmac_f32 v131, v161, v6
    v_fmac_f32 v132, v162, v5
    v_fmac_f32 v133, v162, v6
    v_fmac_f32 v134, v163, v5
    v_fmac_f32 v135, v163, v6
    v_fmac_f32 v136, v164, v5
    v_fmac_f32 v137, v164, v6
    v_fmac_f32 v138, v165, v5
    v_fmac_f32 v139, v165, v6
    v_fmac_f32 v140, v166, v5
    v_fmac_f32 v141, v166, v6
    v_fmac_f32 v142, v167, v5
    v_fmac_f32 v143, v167, v6
    s_waitcnt lgkmcnt(0)
    v_lshlrev_b32 v5, 16, v95
    v_and_b32 v6, 0xffff0000, v95
    v_fmac_f32 v128, v168, v5
    v_fmac_f32 v129, v168, v6
    v_fmac_f32 v130, v169, v5
    v_fmac_f32 v131, v169, v6
    v_fmac_f32 v132, v170, v5
    v_fmac_f32 v133, v170, v6
    v_fmac_f32 v134, v171, v5
    v_fmac_f32 v135, v171, v6
    v_fmac_f32 v136, v172, v5
    v_fmac_f32 v137, v172, v6
    v_fmac_f32 v138, v173, v5
    v_fmac_f32 v139, v173, v6
    v_fmac_f32 v140, v174, v5
    v_fmac_f32 v141, v174, v6
    v_fmac_f32 v142, v175, v5
    v_fmac_f32 v143, v175, v6
    s_lshl_b32 s40, s20, 12
    v_lshlrev_b32 v4, 2, v0
    v_add_u32 v5, s40, v4
    ds_write_b32 v5, v128 offset:8192
    ds_write_b32 v5, v129 offset:8448
    ds_write_b32 v5, v130 offset:8704
    ds_write_b32 v5, v131 offset:8960
    ds_write_b32 v5, v132 offset:9216
    ds_write_b32 v5, v133 offset:9472
    ds_write_b32 v5, v134 offset:9728
    ds_write_b32 v5, v135 offset:9984
    ds_write_b32 v5, v136 offset:10240
    ds_write_b32 v5, v137 offset:10496
    ds_write_b32 v5, v138 offset:10752
    ds_write_b32 v5, v139 offset:11008
    ds_write_b32 v5, v140 offset:11264
    ds_write_b32 v5, v141 offset:11520
    ds_write_b32 v5, v142 offset:11776
    ds_write_b32 v5, v143 offset:12032
    s_waitcnt lgkmcnt(0)
    s_barrier
    s_lshl_b32 s40, s20, 10
    v_add_u32 v5, s40, v4
    ds_read_b32 v64, v5 offset:8192
    ds_read_b32 v65, v5 offset:12288
    ds_read_b32 v66, v5 offset:16384
    ds_read_b32 v67, v5 offset:20480
    ds_read_b32 v68, v5 offset:8448
    ds_read_b32 v69, v5 offset:12544
    ds_read_b32 v70, v5 offset:16640
    ds_read_b32 v71, v5 offset:20736
    ds_read_b32 v72, v5 offset:8704
    ds_read_b32 v73, v5 offset:12800
    ds_read_b32 v74, v5 offset:16896
    ds_read_b32 v75, v5 offset:20992
    ds_read_b32 v76, v5 offset:8960
    ds_read_b32 v77, v5 offset:13056
    ds_read_b32 v78, v5 offset:17152
    ds_read_b32 v79, v5 offset:21248
    s_waitcnt lgkmcnt(0)
    v_add_f32 v128, v64, v65
    v_add_f32 v66, v66, v67
    v_add_f32 v128, v128, v66
    v_add_f32 v129, v68, v69
    v_add_f32 v70, v70, v71
    v_add_f32 v129, v129, v70
    v_add_f32 v130, v72, v73
    v_add_f32 v74, v74, v75
    v_add_f32 v130, v130, v74
    v_add_f32 v131, v76, v77
    v_add_f32 v78, v78, v79
    v_add_f32 v131, v131, v78
    s_lshl_b32 s40, s22, 3
    s_lshl_b32 s41, s20, 1
    s_add_u32 s40, s40, s41
    s_lshl_b32 s40, s40, 12
    s_lshl_b32 s41, s21, 9
    s_add_u32 s40, s40, s41
    v_lshlrev_b32 v4, 3, v0
    buffer_store_dwordx2 v[128:129], v4, s[36:39], s40 offen
    s_add_u32 s40, s40, 4096
    buffer_store_dwordx2 v[130:131], v4, s[36:39], s40 offen
ffn2_kernel_exit1:
    s_endpgm
.section .rodata,"a"
.p2align 6
.amdhsa_kernel ffn2_kernel
  .amdhsa_next_free_vgpr 176
  .amdhsa_next_free_sgpr 80
  .amdhsa_accum_offset 176
  .amdhsa_group_segment_fixed_size 0
  .amdhsa_kernarg_size 88
  .amdhsa_user_sgpr_count 2
  .amdhsa_user_sgpr_kernarg_segment_ptr 1
  .amdhsa_system_sgpr_workgroup_id_x 1
.end_amdhsa_kernel

.text
.globl wo0_kernel
.p2align 8
.type wo0_kernel,@function
wo0_kernel:
    s_cmp_ge_u32 s2, 256
    s_cbranch_scc1 wo0_kernel_exit1
    s_load_dwordx2 s[10:11], s[0:1], 80
    s_load_dwordx2 s[8:9], s[0:1], 0
    v_lshrrev_b32 v1, 6, v0
    v_and_b32 v0, 63, v0
    s_nop 0
    v_readfirstlane_b32 s20, v1
    s_and_b32 s21, s2, 7
    s_lshr_b32 s22, s2, 3
    s_and_b32 s23, s21, 1
    s_lshl_b32 s23, s23, 3
    s_and_b32 s24, s22, 7
    s_add_u32 s23, s23, s24
    s_lshr_b32 s24, s21, 1
    s_lshl_b32 s24, s24, 2
    s_lshr_b32 s25, s22, 3
    s_add_u32 s24, s24, s25
    s_lshr_b32 s25, s20, 1
    s_and_b32 s26, s20, 1
    s_waitcnt lgkmcnt(0)
    s_mov_b32 s12, s10
    s_and_b32 s13, s11, 0xffff
    s_mov_b32 s14, 0x1400000
    s_mov_b32 s15, 0x20000
    s_lshl_b32 s27, s23, 18
    s_add_u32 s40, s27, 0x1000000
    s_add_u32 s41, s27, 0x1010000
    s_add_u32 s42, s27, 0x1020000
    s_add_u32 s43, s27, 0x1030000
    s_lshl_b32 s27, s24, 17
    s_add_u32 s44, s27, 0x600000
    s_add_u32 s45, s27, 0x610000
    s_lshl_b32 s28, s20, 10
    v_lshlrev_b32 v1, 4, v0
    v_add_u32 v1, s28, v1
    v_lshlrev_b32 v2, 4, v0
    s_lshl_b32 s29, s25, 13
    v_add_u32 v2, s29, v2
    s_lshl_b32 s29, s26, 12
    s_add_u32 s29, s29, 16384
    v_lshlrev_b32 v3, 4, v0
    v_add_u32 v3, s29, v3
    s_sub_u32 s40, s40, 4096
    s_sub_u32 s41, s41, 4096
    s_sub_u32 s42, s42, 4096
    s_sub_u32 s43, s43, 4096
    s_sub_u32 s44, s44, 4096
    s_sub_u32 s45, s45, 4096
    s_mov_b32 s34, s28
    s_add_u32 m0, s34, 0x0
    s_add_u32 s40, s40, 4096
    buffer_load_dwordx4 v1, s[12:15], s40 offen lds
    s_add_u32 m0, s34, 0x1000
    s_add_u32 s41, s41, 4096
    buffer_load_dwordx4 v1, s[12:15], s41 offen lds
    s_add_u32 m0, s34, 0x2000
    s_add_u32 s42, s42, 4096
    buffer_load_dwordx4 v1, s[12:15], s42 offen lds
    s_add_u32 m0, s34, 0x3000
    s_add_u32 s43, s43, 4096
    buffer_load_dwordx4 v1, s[12:15], s43 offen lds
    s_add_u32 m0, s34, 0x4000
    s_add_u32 s44, s44, 4096
    buffer_load_dwordx4 v1, s[12:15], s44 offen lds
    s_add_u32 m0, s34, 0x5000
    s_add_u32 s45, s45, 4096
    buffer_load_dwordx4 v1, s[12:15], s45 offen lds
    s_add_u32 s34, s34, 24576
    s_add_u32 m0, s34, 0x0
    s_add_u32 s40, s40, 4096
    buffer_load_dwordx4 v1, s[12:15], s40 offen lds
    s_add_u32 m0, s34, 0x1000
    s_add_u32 s41, s41, 4096
    buffer_load_dwordx4 v1, s[12:15], s41 offen lds
    s_add_u32 m0, s34, 0x2000
    s_add_u32 s42, s42, 4096
    buffer_load_dwordx4 v1, s[12:15], s42 offen lds
    s_add_u32 m0, s34, 0x3000
    s_add_u32 s43, s43, 4096
    buffer_load_dwordx4 v1, s[12:15], s43 offen lds
    s_add_u32 m0, s34, 0x4000
    s_add_u32 s44, s44, 4096
    buffer_load_dwordx4 v1, s[12:15], s44 offen lds
    s_add_u32 m0, s34, 0x5000
    s_add_u32 s45, s45, 4096
    buffer_load_dwordx4 v1, s[12:15], s45 offen lds
    s_add_u32 s34, s34, 24576
    s_add_u32 m0, s34, 0x0
    s_add_u32 s40, s40, 4096
    buffer_load_dwordx4 v1, s[12:15], s40 offen lds
    s_add_u32 m0, s34, 0x1000
    s_add_u32 s41, s41, 4096
    buffer_load_dwordx4 v1, s[12:15], s41 offen lds
    s_add_u32 m0, s34, 0x2000
    s_add_u32 s42, s42, 4096
    buffer_load_dwordx4 v1, s[12:15], s42 offen lds
    s_add_u32 m0, s34, 0x3000
    s_add_u32 s43, s43, 4096
    buffer_load_dwordx4 v1, s[12:15], s43 offen lds
    s_add_u32 m0, s34, 0x4000
    s_add_u32 s44, s44, 4096
    buffer_load_dwordx4 v1, s[12:15], s44 offen lds
    s_add_u32 m0, s34, 0x5000
    s_add_u32 s45, s45, 4096
    buffer_load_dwordx4 v1, s[12:15], s45 offen lds
    s_add_u32 s34, s34, 24576
    v_mov_b32 v48, 0
    v_mov_b32 v49, 0
    v_mov_b32 v50, 0
    v_mov_b32 v51, 0
    v_mov_b32 v52, 0
    v_mov_b32 v53, 0
    v_mov_b32 v54, 0
    v_mov_b32 v55, 0
    v_mov_b32 v56, 0
    v_mov_b32 v57, 0
    v_mov_b32 v58, 0
    v_mov_b32 v59, 0
    v_mov_b32 v60, 0
    v_mov_b32 v61, 0
    v_mov_b32 v62, 0
    v_mov_b32 v63, 0
    v_mov_b32 v64, 0
    v_mov_b32 v65, 0
    v_mov_b32 v66, 0
    v_mov_b32 v67, 0
    v_mov_b32 v68, 0
    v_mov_b32 v69, 0
    v_mov_b32 v70, 0
    v_mov_b32 v71, 0
    v_mov_b32 v72, 0
    v_mov_b32 v73, 0
    v_mov_b32 v74, 0
    v_mov_b32 v75, 0
    v_mov_b32 v76, 0
    v_mov_b32 v77, 0
    v_mov_b32 v78, 0
    v_mov_b32 v79, 0
    s_mov_b32 s32, 0
    s_mov_b32 s33, 0
    s_waitcnt vmcnt(12)
    s_barrier
    v_add_u32 v4, s33, v2
    v_add_u32 v5, s33, v3
    ds_read_b128 v[16:19], v4 offset:0
    ds_read_b128 v[20:23], v4 offset:4096
    ds_read_b128 v[24:27], v5 offset:0
wo0_kernel_loop3:
    s_waitcnt lgkmcnt(0)
    v_mfma_f32_32x32x16_bf16 v[48:63], v[24:27], v[16:19], v[48:63]
    ds_read_b128 v[28:31], v4 offset:1024
    ds_read_b128 v[32:35], v4 offset:5120
    v_mfma_f32_32x32x16_bf16 v[64:79], v[24:27], v[20:23], v[64:79]
    ds_read_b128 v[36:39], v5 offset:1024
    s_add_u32 m0, s34, 0x0
    s_add_u32 s40, s40, 4096
    buffer_load_dwordx4 v1, s[12:15], s40 offen lds
    s_add_u32 m0, s34, 0x1000
    s_add_u32 s41, s41, 4096
    buffer_load_dwordx4 v1, s[12:15], s41 offen lds
    s_waitcnt lgkmcnt(0)
    v_mfma_f32_32x32x16_bf16 v[48:63], v[36:39], v[28:31], v[48:63]
    ds_read_b128 v[16:19], v4 offset:2048
    ds_read_b128 v[20:23], v4 offset:6144
    v_mfma_f32_32x32x16_bf16 v[64:79], v[36:39], v[32:35], v[64:79]
    ds_read_b128 v[24:27], v5 offset:2048
    s_add_u32 m0, s34, 0x2000
    s_add_u32 s42, s42, 4096
    buffer_load_dwordx4 v1, s[12:15], s42 offen lds
    s_add_u32 m0, s34, 0x3000
    s_add_u32 s43, s43, 4096
    buffer_load_dwordx4 v1, s[12:15], s43 offen lds
    s_waitcnt lgkmcnt(0)
    v_mfma_f32_32x32x16_bf16 v[48:63], v[24:27], v[16:19], v[48:63]
    ds_read_b128 v[28:31], v4 offset:3072
    ds_read_b128 v[32:35], v4 offset:7168
    v_mfma_f32_32x32x16_bf16 v[64:79], v[24:27], v[20:23], v[64:79]
    ds_read_b128 v[36:39], v5 offset:3072
    s_add_u32 m0, s34, 0x4000
    s_add_u32 s44, s44, 4096
    buffer_load_dwordx4 v1, s[12:15], s44 offen lds
    s_waitcnt lgkmcnt(0)
    v_mfma_f32_32x32x16_bf16 v[48:63], v[36:39], v[28:31], v[48:63]
    s_waitcnt vmcnt(11)
    s_barrier
    s_add_u32 s33, s33, 24576
    s_cmp_eq_u32 s33, 98304
    s_cselect_b32 s33, 0, s33
    v_add_u32 v4, s33, v2
    v_add_u32 v5, s33, v3
    ds_read_b128 v[16:19], v4 offset:0
    ds_read_b128 v[20:23], v4 offset:4096
    v_mfma_f32_32x32x16_bf16 v[64:79], v[36:39], v[32:35], v[64:79]
    ds_read_b128 v[24:27], v5 offset:0
    s_add_u32 m0, s34, 0x5000
    s_add_u32 s45, s45, 4096
    buffer_load_dwordx4 v1, s[12:15], s45 offen lds
    s_add_u32 s34, s34, 24576
    s_cmp_ge_u32 s34, 98304
    s_cselect_b32 s35, 98304, 0
    s_sub_u32 s34, s34, s35
    s_add_u32 s32, s32, 1
    s_cmp_lt_u32 s32, 13
    s_cbranch_scc1 wo0_kernel_loop3
    s_waitcnt lgkmcnt(0)
    v_mfma_f32_32x32x16_bf16 v[48:63], v[24:27], v[16:19], v[48:63]
    ds_read_b128 v[28:31], v4 offset:1024
    ds_read_b128 v[32:35], v4 offset:5120
    v_mfma_f32_32x32x16_bf16 v[64:79], v[24:27], v[20:23], v[64:79]
    ds_read_b128 v[36:39], v5 offset:1024
    s_waitcnt lgkmcnt(0)
    v_mfma_f32_32x32x16_bf16 v[48:63], v[36:39], v[28:31], v[48:63]
    ds_read_b128 v[16:19], v4 offset:2048
    ds_read_b128 v[20:23], v4 offset:6144
    v_mfma_f32_32x32x16_bf16 v[64:79], v[36:39], v[32:35], v[64:79]
    ds_read_b128 v[24:27], v5 offset:2048
    s_waitcnt lgkmcnt(0)
    v_mfma_f32_32x32x16_bf16 v[48:63], v[24:27], v[16:19], v[48:63]
    ds_read_b128 v[28:31], v4 offset:3072
    ds_read_b128 v[32:35], v4 offset:7168
    v_mfma_f32_32x32x16_bf16 v[64:79], v[24:27], v[20:23], v[64:79]
    ds_read_b128 v[36:39], v5 offset:3072
    s_waitcnt lgkmcnt(0)
    v_mfma_f32_32x32x16_bf16 v[48:63], v[36:39], v[28:31], v[48:63]
    s_waitcnt vmcnt(6)
    s_barrier
    s_add_u32 s33, s33, 24576
    s_cmp_eq_u32 s33, 98304
    s_cselect_b32 s33, 0, s33
    v_add_u32 v4, s33, v2
    v_add_u32 v5, s33, v3
    ds_read_b128 v[16:19], v4 offset:0
    ds_read_b128 v[20:23], v4 offset:4096
    v_mfma_f32_32x32x16_bf16 v[64:79], v[36:39], v[32:35], v[64:79]
    ds_read_b128 v[24:27], v5 offset:0
    s_waitcnt lgkmcnt(0)
    v_mfma_f32_32x32x16_bf16 v[48:63], v[24:27], v[16:19], v[48:63]
    ds_read_b128 v[28:31], v4 offset:1024
    ds_read_b128 v[32:35], v4 offset:5120
    v_mfma_f32_32x32x16_bf16 v[64:79], v[24:27], v[20:23], v[64:79]
    ds_read_b128 v[36:39], v5 offset:1024
    s_waitcnt lgkmcnt(0)
    v_mfma_f32_32x32x16_bf16 v[48:63], v[36:39], v[28:31], v[48:63]
    ds_read_b128 v[16:19], v4 offset:2048
    ds_read_b128 v[20:23], v4 offset:6144
    v_mfma_f32_32x32x16_bf16 v[64:79], v[36:39], v[32:35], v[64:79]
    ds_read_b128 v[24:27], v5 offset:2048
    s_waitcnt lgkmcnt(0)
    v_mfma_f32_32x32x16_bf16 v[48:63], v[24:27], v[16:19], v[48:63]
    ds_read_b128 v[28:31], v4 offset:3072
    ds_read_b128 v[32:35], v4 offset:7168
    v_mfma_f32_32x32x16_bf16 v[64:79], v[24:27], v[20:23], v[64:79]
    ds_read_b128 v[36:39], v5 offset:3072
    s_waitcnt lgkmcnt(0)
    v_mfma_f32_32x32x16_bf16 v[48:63], v[36:39], v[28:31], v[48:63]
    s_waitcnt vmcnt(0)
    s_barrier
    s_add_u32 s33, s33, 24576
    s_cmp_eq_u32 s33, 98304
    s_cselect_b32 s33, 0, s33
    v_add_u32 v4, s33, v2
    v_add_u32 v5, s33, v3
    ds_read_b128 v[16:19], v4 offset:0
    ds_read_b128 v[20:23], v4 offset:4096
    v_mfma_f32_32x32x16_bf16 v[64:79], v[36:39], v[32:35], v[64:79]
    ds_read_b128 v[24:27], v5 offset:0
    s_waitcnt lgkmcnt(0)
    v_mfma_f32_32x32x16_bf16 v[48:63], v[24:27], v[16:19], v[48:63]
    ds_read_b128 v[28:31], v4 offset:1024
    ds_read_b128 v[32:35], v4 offset:5120
    v_mfma_f32_32x32x16_bf16 v[64:79], v[24:27], v[20:23], v[64:79]
    ds_read_b128 v[36:39], v5 offset:1024
    s_waitcnt lgkmcnt(0)
    v_mfma_f32_32x32x16_bf16 v[48:63], v[36:39], v[28:31], v[48:63]
    ds_read_b128 v[16:19], v4 offset:2048
    ds_read_b128 v[20:23], v4 offset:6144
    v_mfma_f32_32x32x16_bf16 v[64:79], v[36:39], v[32:35], v[64:79]
    ds_read_b128 v[24:27], v5 offset:2048
    s_waitcnt lgkmcnt(0)
    v_mfma_f32_32x32x16_bf16 v[48:63], v[24:27], v[16:19], v[48:63]
    ds_read_b128 v[28:31], v4 offset:3072
    ds_read_b128 v[32:35], v4 offset:7168
    v_mfma_f32_32x32x16_bf16 v[64:79], v[24:27], v[20:23], v[64:79]
    ds_read_b128 v[36:39], v5 offset:3072
    s_waitcnt lgkmcnt(0)
    v_mfma_f32_32x32x16_bf16 v[48:63], v[36:39], v[28:31], v[48:63]
    v_mfma_f32_32x32x16_bf16 v[64:79], v[36:39], v[32:35], v[64:79]
    s_mov_b32 s16, s8
    s_and_b32 s17, s9, 0xffff
    s_mov_b32 s18, 0x400000
    s_mov_b32 s19, 0x20000
    s_add_u32 s36, s10, 0x1400000
    s_addc_u32 s37, s11, 0
    s_and_b32 s37, s37, 0xffff
    s_mov_b32 s38, 0x400000
    s_mov_b32 s39, 0x20000
    s_lshl_b32 s27, s23, 2
    s_lshl_b32 s29, s25, 1
    s_add_u32 s27, s27, s29
    s_lshl_b32 s27, s27, 16
    s_lshl_b32 s29, s24, 7
    s_lshl_b32 s30, s26, 6
    s_add_u32 s29, s29, s30
    s_add_u32 s27, s27, s29
    s_add_u32 s28, s27, 65536
    v_and_b32 v6, 31, v0
    v_lshlrev_b32 v6, 11, v6
    v_lshrrev_b32 v7, 5, v0
    v_lshl_add_u32 v6, v7, 5, v6
    buffer_load_dwordx4 v[80:83], v6, s[16:19], s27 offen offset:0
    buffer_load_dwordx4 v[84:87], v6, s[16:19], s27 offen offset:16
    buffer_load_dwordx4 v[88:91], v6, s[16:19], s28 offen offset:0
    buffer_load_dwordx4 v[92:95], v6, s[16:19], s28 offen offset:16
    s_nop 7
    s_waitcnt vmcnt(0)
    v_cvt_pk_bf16_f32 v8, v48, v49
    v_lshlrev_b32 v9, 16, v8
    v_and_b32 v8, 0xffff0000, v8
    v_lshlrev_b32 v10, 16, v80
    v_and_b32 v11, 0xffff0000, v80
    v_add_f32 v9, v9, v10
    v_add_f32 v8, v8, v11
    v_cvt_pk_bf16_f32 v96, v9, v8
    v_cvt_pk_bf16_f32 v8, v50, v51
    v_lshlrev_b32 v9, 16, v8
    v_and_b32 v8, 0xffff0000, v8
    v_lshlrev_b32 v10, 16, v81
    v_and_b32 v11, 0xffff0000, v81
    v_add_f32 v9, v9, v10
    v_add_f32 v8, v8, v11
    v_cvt_pk_bf16_f32 v97, v9, v8
    v_cvt_pk_bf16_f32 v8, v52, v53
    v_lshlrev_b32 v9, 16, v8
    v_and_b32 v8, 0xffff0000, v8
    v_lshlrev_b32 v10, 16, v82
    v_and_b32 v11, 0xffff0000, v82
    v_add_f32 v9, v9, v10
    v_add_f32 v8, v8, v11
    v_cvt_pk_bf16_f32 v98, v9, v8
    v_cvt_pk_bf16_f32 v8, v54, v55
    v_lshlrev_b32 v9, 16, v8
    v_and_b32 v8, 0xffff0000, v8
    v_lshlrev_b32 v10, 16, v83
    v_and_b32 v11, 0xffff0000, v83
    v_add_f32 v9, v9, v10
    v_add_f32 v8, v8, v11
    v_cvt_pk_bf16_f32 v99, v9, v8
    v_cvt_pk_bf16_f32 v8, v56, v57
    v_lshlrev_b32 v9, 16, v8
    v_and_b32 v8, 0xffff0000, v8
    v_lshlrev_b32 v10, 16, v84
    v_and_b32 v11, 0xffff0000, v84
    v_add_f32 v9, v9, v10
    v_add_f32 v8, v8, v11
    v_cvt_pk_bf16_f32 v100, v9, v8
    v_cvt_pk_bf16_f32 v8, v58, v59
    v_lshlrev_b32 v9, 16, v8
    v_and_b32 v8, 0xffff0000, v8
    v_lshlrev_b32 v10, 16, v85
    v_and_b32 v11, 0xffff0000, v85
    v_add_f32 v9, v9, v10
    v_add_f32 v8, v8, v11
    v_cvt_pk_bf16_f32 v101, v9, v8
    v_cvt_pk_bf16_f32 v8, v60, v61
    v_lshlrev_b32 v9, 16, v8
    v_and_b32 v8, 0xffff0000, v8
    v_lshlrev_b32 v10, 16, v86
    v_and_b32 v11, 0xffff0000, v86
    v_add_f32 v9, v9, v10
    v_add_f32 v8, v8, v11
    v_cvt_pk_bf16_f32 v102, v9, v8
    v_cvt_pk_bf16_f32 v8, v62, v63
    v_lshlrev_b32 v9, 16, v8
    v_and_b32 v8, 0xffff0000, v8
    v_lshlrev_b32 v10, 16, v87
    v_and_b32 v11, 0xffff0000, v87
    v_add_f32 v9, v9, v10
    v_add_f32 v8, v8, v11
    v_cvt_pk_bf16_f32 v103, v9, v8
    buffer_store_dwordx4 v[96:99], v6, s[36:39], s27 offen offset:0
    buffer_store_dwordx4 v[100:103], v6, s[36:39], s27 offen offset:16
    v_cvt_pk_bf16_f32 v8, v64, v65
    v_lshlrev_b32 v9, 16, v8
    v_and_b32 v8, 0xffff0000, v8
    v_lshlrev_b32 v10, 16, v88
    v_and_b32 v11, 0xffff0000, v88
    v_add_f32 v9, v9, v10
    v_add_f32 v8, v8, v11
    v_cvt_pk_bf16_f32 v104, v9, v8
    v_cvt_pk_bf16_f32 v8, v66, v67
    v_lshlrev_b32 v9, 16, v8
    v_and_b32 v8, 0xffff0000, v8
    v_lshlrev_b32 v10, 16, v89
    v_and_b32 v11, 0xffff0000, v89
    v_add_f32 v9, v9, v10
    v_add_f32 v8, v8, v11
    v_cvt_pk_bf16_f32 v105, v9, v8
    v_cvt_pk_bf16_f32 v8, v68, v69
    v_lshlrev_b32 v9, 16, v8
    v_and_b32 v8, 0xffff0000, v8
    v_lshlrev_b32 v10, 16, v90
    v_and_b32 v11, 0xffff0000, v90
    v_add_f32 v9, v9, v10
    v_add_f32 v8, v8, v11
    v_cvt_pk_bf16_f32 v106, v9, v8
    v_cvt_pk_bf16_f32 v8, v70, v71
    v_lshlrev_b32 v9, 16, v8
    v_and_b32 v8, 0xffff0000, v8
    v_lshlrev_b32 v10, 16, v91
    v_and_b32 v11, 0xffff0000, v91
    v_add_f32 v9, v9, v10
    v_add_f32 v8, v8, v11
    v_cvt_pk_bf16_f32 v107, v9, v8
    v_cvt_pk_bf16_f32 v8, v72, v73
    v_lshlrev_b32 v9, 16, v8
    v_and_b32 v8, 0xffff0000, v8
    v_lshlrev_b32 v10, 16, v92
    v_and_b32 v11, 0xffff0000, v92
    v_add_f32 v9, v9, v10
    v_add_f32 v8, v8, v11
    v_cvt_pk_bf16_f32 v108, v9, v8
    v_cvt_pk_bf16_f32 v8, v74, v75
    v_lshlrev_b32 v9, 16, v8
    v_and_b32 v8, 0xffff0000, v8
    v_lshlrev_b32 v10, 16, v93
    v_and_b32 v11, 0xffff0000, v93
    v_add_f32 v9, v9, v10
    v_add_f32 v8, v8, v11
    v_cvt_pk_bf16_f32 v109, v9, v8
    v_cvt_pk_bf16_f32 v8, v76, v77
    v_lshlrev_b32 v9, 16, v8
    v_and_b32 v8, 0xffff0000, v8
    v_lshlrev_b32 v10, 16, v94
    v_and_b32 v11, 0xffff0000, v94
    v_add_f32 v9, v9, v10
    v_add_f32 v8, v8, v11
    v_cvt_pk_bf16_f32 v110, v9, v8
    v_cvt_pk_bf16_f32 v8, v78, v79
    v_lshlrev_b32 v9, 16, v8
    v_and_b32 v8, 0xffff0000, v8
    v_lshlrev_b32 v10, 16, v95
    v_and_b32 v11, 0xffff0000, v95
    v_add_f32 v9, v9, v10
    v_add_f32 v8, v8, v11
    v_cvt_pk_bf16_f32 v111, v9, v8
    buffer_store_dwordx4 v[104:107], v6, s[36:39], s28 offen offset:0
    buffer_store_dwordx4 v[108:111], v6, s[36:39], s28 offen offset:16
wo0_kernel_exit1:
    s_endpgm
.section .rodata,"a"
.p2align 6
.amdhsa_kernel wo0_kernel
  .amdhsa_next_free_vgpr 112
  .amdhsa_next_free_sgpr 56
  .amdhsa_accum_offset 112
  .amdhsa_group_segment_fixed_size 0
  .amdhsa_kernarg_size 88
  .amdhsa_user_sgpr_count 2
  .amdhsa_user_sgpr_kernarg_segment_ptr 1
  .amdhsa_system_sgpr_workgroup_id_x 1
.end_amdhsa_kernel

.text
.globl ln2_0_kernel
.p2align 8
.type ln2_0_kernel,@function
ln2_0_kernel:
    s_cmp_ge_u32 s2, 256
    s_cbranch_scc1 ln2_0_kernel_exit1
    s_load_dwordx2 s[10:11], s[0:1], 80
    s_load_dwordx2 s[8:9], s[0:1], 32
    s_load_dwordx2 s[6:7], s[0:1], 64
    v_lshrrev_b32 v1, 6, v0
    v_and_b32 v0, 63, v0
    s_nop 0
    v_readfirstlane_b32 s20, v1
    s_lshl_b32 s21, s2, 3
    s_add_u32 s22, s21, s20
    s_lshl_b32 s23, s22, 11
    v_lshlrev_b32 v2, 5, v0
    s_waitcnt lgkmcnt(0)
    s_add_u32 s12, s10, 0x1400000
    s_addc_u32 s13, s11, 0
    s_and_b32 s13, s13, 0xffff
    s_mov_b32 s14, 0x400000
    s_mov_b32 s15, 0x20000
    s_mov_b32 s16, s8
    s_and_b32 s17, s9, 0xffff
    s_mov_b32 s18, 0x800
    s_mov_b32 s19, 0x20000
    s_add_u32 s24, s10, 0x1c00000
    s_addc_u32 s25, s11, 0
    s_and_b32 s25, s25, 0xffff
    s_mov_b32 s26, 0x400000
    s_mov_b32 s27, 0x20000
    s_add_u32 s28, s10, 0x2210000
    s_addc_u32 s29, s11, 0
    s_and_b32 s29, s29, 0xffff
    s_mov_b32 s30, 0x2000
    s_mov_b32 s31, 0x20000
    s_add_u32 s32, s10, 0x1800000
    s_addc_u32 s33, s11, 0
    s_and_b32 s33, s33, 0xffff
    s_mov_b32 s34, 0x400000
    s_mov_b32 s35, 0x20000
    s_add_u32 s36, s10, 0x800000
    s_addc_u32 s37, s11, 0
    s_and_b32 s37, s37, 0xffff
    s_mov_b32 s38, 0x400000
    s_mov_b32 s39, 0x20000
    buffer_load_dwordx4 v[8:11], v2, s[12:15], s23 offen
    buffer_load_dwordx4 v[12:15], v2, s[12:15], s23 offen offset:16
    buffer_load_dwordx4 v[16:19], v2, s[16:19], 0 offen
    buffer_load_dwordx4 v[20:23], v2, s[16:19], 0 offen offset:16
    s_waitcnt vmcnt(2)
    v_lshlrev_b32 v32, 16, v8
    v_and_b32 v33, 0xffff0000, v8
    v_lshlrev_b32 v34, 16, v9
    v_and_b32 v35, 0xffff0000, v9
    v_lshlrev_b32 v36, 16, v10
    v_and_b32 v37, 0xffff0000, v10
    v_lshlrev_b32 v38, 16, v11
    v_and_b32 v39, 0xffff0000, v11
    v_lshlrev_b32 v40, 16, v12
    v_and_b32 v41, 0xffff0000, v12
    v_lshlrev_b32 v42, 16, v13
    v_and_b32 v43, 0xffff0000, v13
    v_lshlrev_b32 v44, 16, v14
    v_and_b32 v45, 0xffff0000, v14
    v_lshlrev_b32 v46, 16, v15
    v_and_b32 v47, 0xffff0000, v15
    v_add_f32 v48, v32, v33
    v_add_f32 v49, v34, v35
    v_add_f32 v48, v48, v36
    v_add_f32 v49, v49, v37
    v_add_f32 v48, v48, v38
    v_add_f32 v49, v49, v39
    v_add_f32 v48, v48, v40
    v_add_f32 v49, v49, v41
    v_add_f32 v48, v48, v42
    v_add_f32 v49, v49, v43
    v_add_f32 v48, v48, v44
    v_add_f32 v49, v49, v45
    v_add_f32 v48, v48, v46
    v_add_f32 v49, v49, v47
    v_add_f32 v48, v48, v49
    s_nop 1
    v_add_f32_dpp v48, v48, v48 quad_perm:[1,0,3,2] row_mask:0xf bank_mask:0xf
    s_nop 1
    v_add_f32_dpp v48, v48, v48 quad_perm:[2,3,0,1] row_mask:0xf bank_mask:0xf
    s_nop 1
    v_add_f32_dpp v48, v48, v48 row_half_mirror row_mask:0xf bank_mask:0xf
    s_nop 1
    v_add_f32_dpp v48, v48, v48 row_mirror row_mask:0xf bank_mask:0xf
    s_nop 1
    v_readlane_b32 s40, v48, 0
    v_readlane_b32 s41, v48, 16
    v_readlane_b32 s42, v48, 32
    v_readlane_b32 s43, v48, 48
    s_nop 1
    v_mov_b32 v48, s40
    v_add_f32 v48, s41, v48
    v_add_f32 v48, s42, v48
    v_add_f32 v48, s43, v48
    v_mul_f32 v50, 0x3a800000, v48
    v_mov_b32 v48, 0
    v_mov_b32 v49, 0
    v_sub_f32 v54, v32, v50
    v_sub_f32 v55, v33, v50
    v_fmac_f32 v48, v54, v54
    v_fmac_f32 v49, v55, v55
    v_sub_f32 v54, v34, v50
    v_sub_f32 v55, v35, v50
    v_fmac_f32 v48, v54, v54
    v_fmac_f32 v49, v55, v55
    v_sub_f32 v54, v36, v50
    v_sub_f32 v55, v37, v50
    v_fmac_f32 v48, v54, v54
    v_fmac_f32 v49, v55, v55
    v_sub_f32 v54, v38, v50
    v_sub_f32 v55, v39, v50
    v_fmac_f32 v48, v54, v54
    v_fmac_f32 v49, v55, v55
    v_sub_f32 v54, v40, v50
    v_sub_f32 v55, v41, v50
    v_fmac_f32 v48, v54, v54
    v_fmac_f32 v49, v55, v55
    v_sub_f32 v54, v42, v50
    v_sub_f32 v55, v43, v50
    v_fmac_f32 v48, v54, v54
    v_fmac_f32 v49, v55, v55
    v_sub_f32 v54, v44, v50
    v_sub_f32 v55, v45, v50
    v_fmac_f32 v48, v54, v54
    v_fmac_f32 v49, v55, v55
    v_sub_f32 v54, v46, v50
    v_sub_f32 v55, v47, v50
    v_fmac_f32 v48, v54, v54
    v_fmac_f32 v49, v55, v55
    v_add_f32 v48, v48, v49
    s_nop 1
    v_add_f32_dpp v48, v48, v48 quad_perm:[1,0,3,2] row_mask:0xf bank_mask:0xf
    s_nop 1
    v_add_f32_dpp v48, v48, v48 quad_perm:[2,3,0,1] row_mask:0xf bank_mask:0xf
    s_nop 1
    v_add_f32_dpp v48, v48, v48 row_half_mirror row_mask:0xf bank_mask:0xf
    s_nop 1
    v_add_f32_dpp v48, v48, v48 row_mirror row_mask:0xf bank_mask:0xf
    s_nop 1
    v_readlane_b32 s40, v48, 0
    v_readlane_b32 s41, v48, 16
    v_readlane_b32 s42, v48, 32
    v_readlane_b32 s43, v48, 48
    s_nop 1
    v_mov_b32 v48, s40
    v_add_f32 v48, s41, v48
    v_add_f32 v48, s42, v48
    v_add_f32 v48, s43, v48
    v_mul_f32 v48, 0x3a800000, v48
    v_cvt_pk_bf16_f32 v54, v50, v48
    v_lshlrev_b32 v51, 16, v54
    v_and_b32 v48, 0xffff0000, v54
    v_add_f32 v48, 0x3727c5ac, v48
    v_cvt_pk_bf16_f32 v48, v48, v48
    v_lshlrev_b32 v48, 16, v48
    v_sqrt_f32 v48, v48
    s_nop 0
    v_cvt_pk_bf16_f32 v48, v48, v48
    v_lshlrev_b32 v52, 16, v48
    v_rcp_f32 v53, v52
    s_nop 0
    v_sub_f32 v48, v32, v51
    v_sub_f32 v49, v33, v51
    v_cvt_pk_bf16_f32 v48, v48, v49
    v_and_b32 v49, 0xffff0000, v48
    v_lshlrev_b32 v48, 16, v48
    v_mul_f32 v54, v48, v53
    v_mul_f32 v55, v49, v53
    v_fma_f32 v56, -v54, v52, v48
    v_fma_f32 v57, -v55, v52, v49
    v_fma_f32 v54, v56, v53, v54
    v_fma_f32 v55, v57, v53, v55
    v_cvt_pk_bf16_f32 v24, v54, v55
    v_sub_f32 v48, v34, v51
    v_sub_f32 v49, v35, v51
    v_cvt_pk_bf16_f32 v48, v48, v49
    v_and_b32 v49, 0xffff0000, v48
    v_lshlrev_b32 v48, 16, v48
    v_mul_f32 v54, v48, v53
    v_mul_f32 v55, v49, v53
    v_fma_f32 v56, -v54, v52, v48
    v_fma_f32 v57, -v55, v52, v49
    v_fma_f32 v54, v56, v53, v54
    v_fma_f32 v55, v57, v53, v55
    v_cvt_pk_bf16_f32 v25, v54, v55
    v_sub_f32 v48, v36, v51
    v_sub_f32 v49, v37, v51
    v_cvt_pk_bf16_f32 v48, v48, v49
    v_and_b32 v49, 0xffff0000, v48
    v_lshlrev_b32 v48, 16, v48
    v_mul_f32 v54, v48, v53
    v_mul_f32 v55, v49, v53
    v_fma_f32 v56, -v54, v52, v48
    v_fma_f32 v57, -v55, v52, v49
    v_fma_f32 v54, v56, v53, v54
    v_fma_f32 v55, v57, v53, v55
    v_cvt_pk_bf16_f32 v26, v54, v55
    v_sub_f32 v48, v38, v51
    v_sub_f32 v49, v39, v51
    v_cvt_pk_bf16_f32 v48, v48, v49
    v_and_b32 v49, 0xffff0000, v48
    v_lshlrev_b32 v48, 16, v48
    v_mul_f32 v54, v48, v53
    v_mul_f32 v55, v49, v53
    v_fma_f32 v56, -v54, v52, v48
    v_fma_f32 v57, -v55, v52, v49
    v_fma_f32 v54, v56, v53, v54
    v_fma_f32 v55, v57, v53, v55
    v_cvt_pk_bf16_f32 v27, v54, v55
    v_sub_f32 v48, v40, v51
    v_sub_f32 v49, v41, v51
    v_cvt_pk_bf16_f32 v48, v48, v49
    v_and_b32 v49, 0xffff0000, v48
    v_lshlrev_b32 v48, 16, v48
    v_mul_f32 v54, v48, v53
    v_mul_f32 v55, v49, v53
    v_fma_f32 v56, -v54, v52, v48
    v_fma_f32 v57, -v55, v52, v49
    v_fma_f32 v54, v56, v53, v54
    v_fma_f32 v55, v57, v53, v55
    v_cvt_pk_bf16_f32 v28, v54, v55
    v_sub_f32 v48, v42, v51
    v_sub_f32 v49, v43, v51
    v_cvt_pk_bf16_f32 v48, v48, v49
    v_and_b32 v49, 0xffff0000, v48
    v_lshlrev_b32 v48, 16, v48
    v_mul_f32 v54, v48, v53
    v_mul_f32 v55, v49, v53
    v_fma_f32 v56, -v54, v52, v48
    v_fma_f32 v57, -v55, v52, v49
    v_fma_f32 v54, v56, v53, v54
    v_fma_f32 v55, v57, v53, v55
    v_cvt_pk_bf16_f32 v29, v54, v55
    v_sub_f32 v48, v44, v51
    v_sub_f32 v49, v45, v51
    v_cvt_pk_bf16_f32 v48, v48, v49
    v_and_b32 v49, 0xffff0000, v48
    v_lshlrev_b32 v48, 16, v48
    v_mul_f32 v54, v48, v53
    v_mul_f32 v55, v49, v53
    v_fma_f32 v56, -v54, v52, v48
    v_fma_f32 v57, -v55, v52, v49
    v_fma_f32 v54, v56, v53, v54
    v_fma_f32 v55, v57, v53, v55
    v_cvt_pk_bf16_f32 v30, v54, v55
    v_sub_f32 v48, v46, v51
    v_sub_f32 v49, v47, v51
    v_cvt_pk_bf16_f32 v48, v48, v49
    v_and_b32 v49, 0xffff0000, v48
    v_lshlrev_b32 v48, 16, v48
    v_mul_f32 v54, v48, v53
    v_mul_f32 v55, v49, v53
    v_fma_f32 v56, -v54, v52, v48
    v_fma_f32 v57, -v55, v52, v49
    v_fma_f32 v54, v56, v53, v54
    v_fma_f32 v55, v57, v53, v55
    v_cvt_pk_bf16_f32 v31, v54, v55
    buffer_store_dwordx4 v[24:27], v2, s[24:27], s23 offen
    buffer_store_dwordx4 v[28:31], v2, s[24:27], s23 offen offset:16
    s_waitcnt vmcnt(2)
    v_mov_b32 v52, 0
    v_mov_b32 v53, 0
    v_lshlrev_b32 v48, 16, v24
    v_and_b32 v49, 0xffff0000, v24
    v_lshlrev_b32 v50, 16, v16
    v_and_b32 v51, 0xffff0000, v16
    v_fmac_f32 v52, v48, v50
    v_fmac_f32 v53, v49, v51
    v_add_f32 v32, v32, v48
    v_add_f32 v33, v33, v49
    v_cvt_pk_bf16_f32 v8, v32, v33
    v_lshlrev_b32 v48, 16, v25
    v_and_b32 v49, 0xffff0000, v25
    v_lshlrev_b32 v50, 16, v17
    v_and_b32 v51, 0xffff0000, v17
    v_fmac_f32 v52, v48, v50
    v_fmac_f32 v53, v49, v51
    v_add_f32 v34, v34, v48
    v_add_f32 v35, v35, v49
    v_cvt_pk_bf16_f32 v9, v34, v35
    v_lshlrev_b32 v48, 16, v26
    v_and_b32 v49, 0xffff0000, v26
    v_lshlrev_b32 v50, 16, v18
    v_and_b32 v51, 0xffff0000, v18
    v_fmac_f32 v52, v48, v50
    v_fmac_f32 v53, v49, v51
    v_add_f32 v36, v36, v48
    v_add_f32 v37, v37, v49
    v_cvt_pk_bf16_f32 v10, v36, v37
    v_lshlrev_b32 v48, 16, v27
    v_and_b32 v49, 0xffff0000, v27
    v_lshlrev_b32 v50, 16, v19
    v_and_b32 v51, 0xffff0000, v19
    v_fmac_f32 v52, v48, v50
    v_fmac_f32 v53, v49, v51
    v_add_f32 v38, v38, v48
    v_add_f32 v39, v39, v49
    v_cvt_pk_bf16_f32 v11, v38, v39
    v_lshlrev_b32 v48, 16, v28
    v_and_b32 v49, 0xffff0000, v28
    v_lshlrev_b32 v50, 16, v20
    v_and_b32 v51, 0xffff0000, v20
    v_fmac_f32 v52, v48, v50
    v_fmac_f32 v53, v49, v51
    v_add_f32 v40, v40, v48
    v_add_f32 v41, v41, v49
    v_cvt_pk_bf16_f32 v12, v40, v41
    v_lshlrev_b32 v48, 16, v29
    v_and_b32 v49, 0xffff0000, v29
    v_lshlrev_b32 v50, 16, v21
    v_and_b32 v51, 0xffff0000, v21
    v_fmac_f32 v52, v48, v50
    v_fmac_f32 v53, v49, v51
    v_add_f32 v42, v42, v48
    v_add_f32 v43, v43, v49
    v_cvt_pk_bf16_f32 v13, v42, v43
    v_lshlrev_b32 v48, 16, v30
    v_and_b32 v49, 0xffff0000, v30
    v_lshlrev_b32 v50, 16, v22
    v_and_b32 v51, 0xffff0000, v22
    v_fmac_f32 v52, v48, v50
    v_fmac_f32 v53, v49, v51
    v_add_f32 v44, v44, v48
    v_add_f32 v45, v45, v49
    v_cvt_pk_bf16_f32 v14, v44, v45
    v_lshlrev_b32 v48, 16, v31
    v_and_b32 v49, 0xffff0000, v31
    v_lshlrev_b32 v50, 16, v23
    v_and_b32 v51, 0xffff0000, v23
    v_fmac_f32 v52, v48, v50
    v_fmac_f32 v53, v49, v51
    v_add_f32 v46, v46, v48
    v_add_f32 v47, v47, v49
    v_cvt_pk_bf16_f32 v15, v46, v47
    buffer_store_dwordx4 v[8:11], v2, s[32:35], s23 offen
    buffer_store_dwordx4 v[12:15], v2, s[32:35], s23 offen offset:16
    v_add_f32 v52, v52, v53
    s_nop 1
    v_add_f32_dpp v52, v52, v52 quad_perm:[1,0,3,2] row_mask:0xf bank_mask:0xf
    s_nop 1
    v_add_f32_dpp v52, v52, v52 quad_perm:[2,3,0,1] row_mask:0xf bank_mask:0xf
    s_nop 1
    v_add_f32_dpp v52, v52, v52 row_half_mirror row_mask:0xf bank_mask:0xf
    s_nop 1
    v_add_f32_dpp v52, v52, v52 row_mirror row_mask:0xf bank_mask:0xf
    s_nop 1
    v_readlane_b32 s40, v52, 0
    v_readlane_b32 s41, v52, 16
    v_readlane_b32 s42, v52, 32
    v_readlane_b32 s43, v52, 48
    s_nop 1
    v_mov_b32 v52, s40
    v_add_f32 v52, s41, v52
    v_add_f32 v52, s42, v52
    v_add_f32 v52, s43, v52
    v_cvt_pk_bf16_f32 v52, v52, v52
    v_and_b32 v48, 0xffff, v52
    v_xor_b32 v49, 0xffff, v48
    v_or_b32 v50, 0x8000, v48
    v_cmp_lt_u32 vcc, 0x7fff, v48
    s_sub_u32 s44, 0xffff, s22
    s_lshl_b32 s45, s22, 2
    v_cndmask_b32 v48, v50, v49, vcc
    v_lshl_or_b32 v48, v48, 16, s44
    v_mov_b32 v49, 0
    v_cmp_eq_u32 vcc, 0, v0
    s_and_saveexec_b64 s[46:47], vcc
    buffer_store_dword v48, v49, s[28:31], s45 offen
    s_mov_b64 exec, s[46:47]
    v_lshlrev_b32 v32, 16, v8
    v_and_b32 v33, 0xffff0000, v8
    v_lshlrev_b32 v34, 16, v9
    v_and_b32 v35, 0xffff0000, v9
    v_lshlrev_b32 v36, 16, v10
    v_and_b32 v37, 0xffff0000, v10
    v_lshlrev_b32 v38, 16, v11
    v_and_b32 v39, 0xffff0000, v11
    v_lshlrev_b32 v40, 16, v12
    v_and_b32 v41, 0xffff0000, v12
    v_lshlrev_b32 v42, 16, v13
    v_and_b32 v43, 0xffff0000, v13
    v_lshlrev_b32 v44, 16, v14
    v_and_b32 v45, 0xffff0000, v14
    v_lshlrev_b32 v46, 16, v15
    v_and_b32 v47, 0xffff0000, v15
    v_add_f32 v48, v32, v33
    v_add_f32 v49, v34, v35
    v_add_f32 v48, v48, v36
    v_add_f32 v49, v49, v37
    v_add_f32 v48, v48, v38
    v_add_f32 v49, v49, v39
    v_add_f32 v48, v48, v40
    v_add_f32 v49, v49, v41
    v_add_f32 v48, v48, v42
    v_add_f32 v49, v49, v43
    v_add_f32 v48, v48, v44
    v_add_f32 v49, v49, v45
    v_add_f32 v48, v48, v46
    v_add_f32 v49, v49, v47
    v_add_f32 v48, v48, v49
    s_nop 1
    v_add_f32_dpp v48, v48, v48 quad_perm:[1,0,3,2] row_mask:0xf bank_mask:0xf
    s_nop 1
    v_add_f32_dpp v48, v48, v48 quad_perm:[2,3,0,1] row_mask:0xf bank_mask:0xf
    s_nop 1
    v_add_f32_dpp v48, v48, v48 row_half_mirror row_mask:0xf bank_mask:0xf
    s_nop 1
    v_add_f32_dpp v48, v48, v48 row_mirror row_mask:0xf bank_mask:0xf
    s_nop 1
    v_readlane_b32 s40, v48, 0
    v_readlane_b32 s41, v48, 16
    v_readlane_b32 s42, v48, 32
    v_readlane_b32 s43, v48, 48
    s_nop 1
    v_mov_b32 v48, s40
    v_add_f32 v48, s41, v48
    v_add_f32 v48, s42, v48
    v_add_f32 v48, s43, v48
    v_mul_f32 v50, 0x3a800000, v48
    v_mov_b32 v48, 0
    v_mov_b32 v49, 0
    v_sub_f32 v54, v32, v50
    v_sub_f32 v55, v33, v50
    v_fmac_f32 v48, v54, v54
    v_fmac_f32 v49, v55, v55
    v_sub_f32 v54, v34, v50
    v_sub_f32 v55, v35, v50
    v_fmac_f32 v48, v54, v54
    v_fmac_f32 v49, v55, v55
    v_sub_f32 v54, v36, v50
    v_sub_f32 v55, v37, v50
    v_fmac_f32 v48, v54, v54
    v_fmac_f32 v49, v55, v55
    v_sub_f32 v54, v38, v50
    v_sub_f32 v55, v39, v50
    v_fmac_f32 v48, v54, v54
    v_fmac_f32 v49, v55, v55
    v_sub_f32 v54, v40, v50
    v_sub_f32 v55, v41, v50
    v_fmac_f32 v48, v54, v54
    v_fmac_f32 v49, v55, v55
    v_sub_f32 v54, v42, v50
    v_sub_f32 v55, v43, v50
    v_fmac_f32 v48, v54, v54
    v_fmac_f32 v49, v55, v55
    v_sub_f32 v54, v44, v50
    v_sub_f32 v55, v45, v50
    v_fmac_f32 v48, v54, v54
    v_fmac_f32 v49, v55, v55
    v_sub_f32 v54, v46, v50
    v_sub_f32 v55, v47, v50
    v_fmac_f32 v48, v54, v54
    v_fmac_f32 v49, v55, v55
    v_add_f32 v48, v48, v49
    s_nop 1
    v_add_f32_dpp v48, v48, v48 quad_perm:[1,0,3,2] row_mask:0xf bank_mask:0xf
    s_nop 1
    v_add_f32_dpp v48, v48, v48 quad_perm:[2,3,0,1] row_mask:0xf bank_mask:0xf
    s_nop 1
    v_add_f32_dpp v48, v48, v48 row_half_mirror row_mask:0xf bank_mask:0xf
    s_nop 1
    v_add_f32_dpp v48, v48, v48 row_mirror row_mask:0xf bank_mask:0xf
    s_nop 1
    v_readlane_b32 s40, v48, 0
    v_readlane_b32 s41, v48, 16
    v_readlane_b32 s42, v48, 32
    v_readlane_b32 s43, v48, 48
    s_nop 1
    v_mov_b32 v48, s40
    v_add_f32 v48, s41, v48
    v_add_f32 v48, s42, v48
    v_add_f32 v48, s43, v48
    v_mul_f32 v48, 0x3a800000, v48
    v_cvt_pk_bf16_f32 v54, v50, v48
    v_lshlrev_b32 v51, 16, v54
    v_and_b32 v48, 0xffff0000, v54
    v_add_f32 v48, 0x3727c5ac, v48
    v_cvt_pk_bf16_f32 v48, v48, v48
    v_lshlrev_b32 v48, 16, v48
    v_sqrt_f32 v48, v48
    s_nop 0
    v_cvt_pk_bf16_f32 v48, v48, v48
    v_lshlrev_b32 v52, 16, v48
    v_rcp_f32 v53, v52
    s_nop 0
    v_sub_f32 v48, v32, v51
    v_sub_f32 v49, v33, v51
    v_cvt_pk_bf16_f32 v48, v48, v49
    v_and_b32 v49, 0xffff0000, v48
    v_lshlrev_b32 v48, 16, v48
    v_mul_f32 v54, v48, v53
    v_mul_f32 v55, v49, v53
    v_fma_f32 v56, -v54, v52, v48
    v_fma_f32 v57, -v55, v52, v49
    v_fma_f32 v54, v56, v53, v54
    v_fma_f32 v55, v57, v53, v55
    v_cvt_pk_bf16_f32 v24, v54, v55
    v_sub_f32 v48, v34, v51
    v_sub_f32 v49, v35, v51
    v_cvt_pk_bf16_f32 v48, v48, v49
    v_and_b32 v49, 0xffff0000, v48
    v_lshlrev_b32 v48, 16, v48
    v_mul_f32 v54, v48, v53
    v_mul_f32 v55, v49, v53
    v_fma_f32 v56, -v54, v52, v48
    v_fma_f32 v57, -v55, v52, v49
    v_fma_f32 v54, v56, v53, v54
    v_fma_f32 v55, v57, v53, v55
    v_cvt_pk_bf16_f32 v25, v54, v55
    v_sub_f32 v48, v36, v51
    v_sub_f32 v49, v37, v51
    v_cvt_pk_bf16_f32 v48, v48, v49
    v_and_b32 v49, 0xffff0000, v48
    v_lshlrev_b32 v48, 16, v48
    v_mul_f32 v54, v48, v53
    v_mul_f32 v55, v49, v53
    v_fma_f32 v56, -v54, v52, v48
    v_fma_f32 v57, -v55, v52, v49
    v_fma_f32 v54, v56, v53, v54
    v_fma_f32 v55, v57, v53, v55
    v_cvt_pk_bf16_f32 v26, v54, v55
    v_sub_f32 v48, v38, v51
    v_sub_f32 v49, v39, v51
    v_cvt_pk_bf16_f32 v48, v48, v49
    v_and_b32 v49, 0xffff0000, v48
    v_lshlrev_b32 v48, 16, v48
    v_mul_f32 v54, v48, v53
    v_mul_f32 v55, v49, v53
    v_fma_f32 v56, -v54, v52, v48
    v_fma_f32 v57, -v55, v52, v49
    v_fma_f32 v54, v56, v53, v54
    v_fma_f32 v55, v57, v53, v55
    v_cvt_pk_bf16_f32 v27, v54, v55
    v_sub_f32 v48, v40, v51
    v_sub_f32 v49, v41, v51
    v_cvt_pk_bf16_f32 v48, v48, v49
    v_and_b32 v49, 0xffff0000, v48
    v_lshlrev_b32 v48, 16, v48
    v_mul_f32 v54, v48, v53
    v_mul_f32 v55, v49, v53
    v_fma_f32 v56, -v54, v52, v48
    v_fma_f32 v57, -v55, v52, v49
    v_fma_f32 v54, v56, v53, v54
    v_fma_f32 v55, v57, v53, v55
    v_cvt_pk_bf16_f32 v28, v54, v55
    v_sub_f32 v48, v42, v51
    v_sub_f32 v49, v43, v51
    v_cvt_pk_bf16_f32 v48, v48, v49
    v_and_b32 v49, 0xffff0000, v48
    v_lshlrev_b32 v48, 16, v48
    v_mul_f32 v54, v48, v53
    v_mul_f32 v55, v49, v53
    v_fma_f32 v56, -v54, v52, v48
    v_fma_f32 v57, -v55, v52, v49
    v_fma_f32 v54, v56, v53, v54
    v_fma_f32 v55, v57, v53, v55
    v_cvt_pk_bf16_f32 v29, v54, v55
    v_sub_f32 v48, v44, v51
    v_sub_f32 v49, v45, v51
    v_cvt_pk_bf16_f32 v48, v48, v49
    v_and_b32 v49, 0xffff0000, v48
    v_lshlrev_b32 v48, 16, v48
    v_mul_f32 v54, v48, v53
    v_mul_f32 v55, v49, v53
    v_fma_f32 v56, -v54, v52, v48
    v_fma_f32 v57, -v55, v52, v49
    v_fma_f32 v54, v56, v53, v54
    v_fma_f32 v55, v57, v53, v55
    v_cvt_pk_bf16_f32 v30, v54, v55
    v_sub_f32 v48, v46, v51
    v_sub_f32 v49, v47, v51
    v_cvt_pk_bf16_f32 v48, v48, v49
    v_and_b32 v49, 0xffff0000, v48
    v_lshlrev_b32 v48, 16, v48
    v_mul_f32 v54, v48, v53
    v_mul_f32 v55, v49, v53
    v_fma_f32 v56, -v54, v52, v48
    v_fma_f32 v57, -v55, v52, v49
    v_fma_f32 v54, v56, v53, v54
    v_fma_f32 v55, v57, v53, v55
    v_cvt_pk_bf16_f32 v31, v54, v55
    s_mul_i32 s44, s20, 2064
    v_lshlrev_b32 v3, 5, v0
    v_add_u32 v3, s44, v3
    ds_write_b128 v3, v[24:27]
    ds_write_b128 v3, v[28:31] offset:16
    s_lshl_b32 s44, s20, 6
    v_add_u32 v3, s44, v0
    v_and_b32 v4, 7, v3
    v_lshrrev_b32 v3, 3, v3
    v_mul_u32_u24 v5, 2064, v4
    v_lshl_add_u32 v5, v3, 4, v5
    s_waitcnt lgkmcnt(0)
    s_barrier
    ds_read_b128 v[24:27], v5
    ds_read_b128 v[28:31], v5 offset:1024
    s_and_b32 s44, s21, 31
    v_add_u32 v4, s44, v4
    v_lshlrev_b32 v4, 4, v4
    v_and_b32 v5, 1, v3
    v_lshl_add_u32 v4, v5, 9, v4
    v_lshrrev_b32 v3, 1, v3
    v_lshl_add_u32 v4, v3, 10, v4
    s_lshr_b32 s44, s21, 5
    s_lshl_b32 s44, s44, 16
    s_waitcnt lgkmcnt(0)
    buffer_store_dwordx4 v[24:27], v4, s[36:39], s44 offen
    s_add_u32 s44, s44, 32768
    buffer_store_dwordx4 v[28:31], v4, s[36:39], s44 offen
ln2_0_kernel_exit1:
    s_endpgm
.section .rodata,"a"
.p2align 6
.amdhsa_kernel ln2_0_kernel
  .amdhsa_next_free_vgpr 64
  .amdhsa_next_free_sgpr 56
  .amdhsa_accum_offset 64
  .amdhsa_group_segment_fixed_size 0
  .amdhsa_kernarg_size 88
  .amdhsa_user_sgpr_count 2
  .amdhsa_user_sgpr_kernarg_segment_ptr 1
  .amdhsa_system_sgpr_workgroup_id_x 1
.end_amdhsa_kernel

.text
.globl fix0_kernel
.p2align 8
.type fix0_kernel,@function
fix0_kernel:
    s_cmp_ge_u32 s2, 8
    s_cbranch_scc1 fix0_kernel_exit1
    s_load_dwordx2 s[10:11], s[0:1], 80
    s_load_dwordx2 s[6:7], s[0:1], 64
    s_waitcnt lgkmcnt(0)
    s_add_u32 s12, s10, 0x2500000
    s_addc_u32 s13, s11, 0
    s_and_b32 s13, s13, 0xffff
    s_mov_b32 s14, 0x100000
    s_mov_b32 s15, 0x20000
    s_add_u32 s16, s10, 0x1c00000
    s_addc_u32 s17, s11, 0
    s_and_b32 s17, s17, 0xffff
    s_mov_b32 s18, 0x400000
    s_mov_b32 s19, 0x20000
    s_add_u32 s24, s10, 0x1400000
    s_addc_u32 s25, s11, 0
    s_and_b32 s25, s25, 0xffff
    s_mov_b32 s26, 0x400000
    s_mov_b32 s27, 0x20000
    s_add_u32 s28, s10, 0x1800000
    s_addc_u32 s29, s11, 0
    s_and_b32 s29, s29, 0xffff
    s_mov_b32 s30, 0x400000
    s_mov_b32 s31, 0x20000
    s_add_u32 s32, s10, 0x800000
    s_addc_u32 s33, s11, 0
    s_and_b32 s33, s33, 0xffff
    s_mov_b32 s34, 0x400000
    s_mov_b32 s35, 0x20000
    s_add_u32 s36, s10, 0x2214000
    s_addc_u32 s37, s11, 0
    s_lshl_b32 s21, s2, 2
    s_load_dword s22, s[36:37], s21
    v_lshlrev_b32 v1, 4, v0
    s_lshl_b32 s23, s2, 12
    buffer_load_dwordx4 v[16:19], v1, s[12:15], s23 offen
    s_add_u32 s23, s23, 32768
    buffer_load_dwordx4 v[20:23], v1, s[12:15], s23 offen
    s_add_u32 s23, s23, 32768
    buffer_load_dwordx4 v[24:27], v1, s[12:15], s23 offen
    s_add_u32 s23, s23, 32768
    buffer_load_dwordx4 v[28:31], v1, s[12:15], s23 offen
    s_add_u32 s23, s23, 32768
    buffer_load_dwordx4 v[32:35], v1, s[12:15], s23 offen
    s_add_u32 s23, s23, 32768
    buffer_load_dwordx4 v[36:39], v1, s[12:15], s23 offen
    s_add_u32 s23, s23, 32768
    buffer_load_dwordx4 v[40:43], v1, s[12:15], s23 offen
    s_add_u32 s23, s23, 32768
    buffer_load_dwordx4 v[44:47], v1, s[12:15], s23 offen
    s_add_u32 s23, s23, 32768
    buffer_load_dwordx4 v[48:51], v1, s[12:15], s23 offen
    s_add_u32 s23, s23, 32768
    buffer_load_dwordx4 v[52:55], v1, s[12:15], s23 offen
    s_add_u32 s23, s23, 32768
    buffer_load_dwordx4 v[56:59], v1, s[12:15], s23 offen
    s_add_u32 s23, s23, 32768
    buffer_load_dwordx4 v[60:63], v1, s[12:15], s23 offen
    s_add_u32 s23, s23, 32768
    buffer_load_dwordx4 v[64:67], v1, s[12:15], s23 offen
    s_add_u32 s23, s23, 32768
    buffer_load_dwordx4 v[68:71], v1, s[12:15], s23 offen
    s_add_u32 s23, s23, 32768
    buffer_load_dwordx4 v[72:75], v1, s[12:15], s23 offen
    s_add_u32 s23, s23, 32768
    buffer_load_dwordx4 v[76:79], v1, s[12:15], s23 offen
    s_add_u32 s23, s23, 32768
    buffer_load_dwordx4 v[80:83], v1, s[12:15], s23 offen
    s_add_u32 s23, s23, 32768
    buffer_load_dwordx4 v[84:87], v1, s[12:15], s23 offen
    s_add_u32 s23, s23, 32768
    buffer_load_dwordx4 v[88:91], v1, s[12:15], s23 offen
    s_add_u32 s23, s23, 32768
    buffer_load_dwordx4 v[92:95], v1, s[12:15], s23 offen
    s_add_u32 s23, s23, 32768
    buffer_load_dwordx4 v[96:99], v1, s[12:15], s23 offen
    s_add_u32 s23, s23, 32768
    buffer_load_dwordx4 v[100:103], v1, s[12:15], s23 offen
    s_add_u32 s23, s23, 32768
    buffer_load_dwordx4 v[104:107], v1, s[12:15], s23 offen
    s_add_u32 s23, s23, 32768
    buffer_load_dwordx4 v[108:111], v1, s[12:15], s23 offen
    s_add_u32 s23, s23, 32768
    buffer_load_dwordx4 v[112:115], v1, s[12:15], s23 offen
    s_add_u32 s23, s23, 32768
    buffer_load_dwordx4 v[116:119], v1, s[12:15], s23 offen
    s_add_u32 s23, s23, 32768
    buffer_load_dwordx4 v[120:123], v1, s[12:15], s23 offen
    s_add_u32 s23, s23, 32768
    buffer_load_dwordx4 v[124:127], v1, s[12:15], s23 offen
    s_add_u32 s23, s23, 32768
    s_waitcnt lgkmcnt(0)
    s_and_b32 s38, s22, 0xffff
    s_sub_u32 s38, 0xffff, s38
    s_lshl_b32 s39, s38, 11
    v_lshlrev_b32 v2, 3, v0
    buffer_load_dwordx2 v[4:5], v2, s[16:19], s39 offen
    buffer_load_dwordx2 v[6:7], v2, s[24:27], s39 offen
    s_lshr_b32 s40, s22, 16
    s_and_b32 s41, s40, 0x8000
    s_and_b32 s42, s40, 0x7fff
    s_xor_b32 s43, s40, 0xffff
    s_cmp_lg_u32 s41, 0
    s_cselect_b32 s40, s42, s43
    s_lshl_b32 s40, s40, 16
    v_mov_b32 v8, s40
    v_mul_f32 v9, 0x3fb8aa3b, v8
    v_exp_f32 v9, -v9
    s_nop 0
    v_add_f32 v9, 1.0, v9
    v_rcp_f32 v10, v9
    s_nop 0
    v_fma_f32 v11, -v10, v9, 1.0
    v_fma_f32 v10, v11, v10, v10
    v_cvt_pk_bf16_f32 v10, v10, v10
    v_lshlrev_b32 v10, 16, v10
    s_waitcnt vmcnt(0)
    v_add_f32 v16, v16, v20
    v_add_f32 v16, v16, v24
    v_add_f32 v16, v16, v28
    v_add_f32 v16, v16, v32
    v_add_f32 v16, v16, v36
    v_add_f32 v16, v16, v40
    v_add_f32 v16, v16, v44
    v_add_f32 v16, v16, v48
    v_add_f32 v16, v16, v52
    v_add_f32 v16, v16, v56
    v_add_f32 v16, v16, v60
    v_add_f32 v16, v16, v64
    v_add_f32 v16, v16, v68
    v_add_f32 v16, v16, v72
    v_add_f32 v16, v16, v76
    v_add_f32 v16, v16, v80
    v_add_f32 v16, v16, v84
    v_add_f32 v16, v16, v88
    v_add_f32 v16, v16, v92
    v_add_f32 v16, v16, v96
    v_add_f32 v16, v16, v100
    v_add_f32 v16, v16, v104
    v_add_f32 v16, v16, v108
    v_add_f32 v16, v16, v112
    v_add_f32 v16, v16, v116
    v_add_f32 v16, v16, v120
    v_add_f32 v16, v16, v124
    v_add_f32 v17, v17, v21
    v_add_f32 v17, v17, v25
    v_add_f32 v17, v17, v29
    v_add_f32 v17, v17, v33
    v_add_f32 v17, v17, v37
    v_add_f32 v17, v17, v41
    v_add_f32 v17, v17, v45
    v_add_f32 v17, v17, v49
    v_add_f32 v17, v17, v53
    v_add_f32 v17, v17, v57
    v_add_f32 v17, v17, v61
    v_add_f32 v17, v17, v65
    v_add_f32 v17, v17, v69
    v_add_f32 v17, v17, v73
    v_add_f32 v17, v17, v77
    v_add_f32 v17, v17, v81
    v_add_f32 v17, v17, v85
    v_add_f32 v17, v17, v89
    v_add_f32 v17, v17, v93
    v_add_f32 v17, v17, v97
    v_add_f32 v17, v17, v101
    v_add_f32 v17, v17, v105
    v_add_f32 v17, v17, v109
    v_add_f32 v17, v17, v113
    v_add_f32 v17, v17, v117
    v_add_f32 v17, v17, v121
    v_add_f32 v17, v17, v125
    v_add_f32 v18, v18, v22
    v_add_f32 v18, v18, v26
    v_add_f32 v18, v18, v30
    v_add_f32 v18, v18, v34
    v_add_f32 v18, v18, v38
    v_add_f32 v18, v18, v42
    v_add_f32 v18, v18, v46
    v_add_f32 v18, v18, v50
    v_add_f32 v18, v18, v54
    v_add_f32 v18, v18, v58
    v_add_f32 v18, v18, v62
    v_add_f32 v18, v18, v66
    v_add_f32 v18, v18, v70
    v_add_f32 v18, v18, v74
    v_add_f32 v18, v18, v78
    v_add_f32 v18, v18, v82
    v_add_f32 v18, v18, v86
    v_add_f32 v18, v18, v90
    v_add_f32 v18, v18, v94
    v_add_f32 v18, v18, v98
    v_add_f32 v18, v18, v102
    v_add_f32 v18, v18, v106
    v_add_f32 v18, v18, v110
    v_add_f32 v18, v18, v114
    v_add_f32 v18, v18, v118
    v_add_f32 v18, v18, v122
    v_add_f32 v18, v18, v126
    v_add_f32 v19, v19, v23
    v_add_f32 v19, v19, v27
    v_add_f32 v19, v19, v31
    v_add_f32 v19, v19, v35
    v_add_f32 v19, v19, v39
    v_add_f32 v19, v19, v43
    v_add_f32 v19, v19, v47
    v_add_f32 v19, v19, v51
    v_add_f32 v19, v19, v55
    v_add_f32 v19, v19, v59
    v_add_f32 v19, v19, v63
    v_add_f32 v19, v19, v67
    v_add_f32 v19, v19, v71
    v_add_f32 v19, v19, v75
    v_add_f32 v19, v19, v79
    v_add_f32 v19, v19, v83
    v_add_f32 v19, v19, v87
    v_add_f32 v19, v19, v91
    v_add_f32 v19, v19, v95
    v_add_f32 v19, v19, v99
    v_add_f32 v19, v19, v103
    v_add_f32 v19, v19, v107
    v_add_f32 v19, v19, v111
    v_add_f32 v19, v19, v115
    v_add_f32 v19, v19, v119
    v_add_f32 v19, v19, v123
    v_add_f32 v19, v19, v127
    v_cvt_pk_bf16_f32 v8, v16, v16
    v_lshlrev_b32 v8, 16, v8
    v_mul_f32 v8, v8, v10
    v_cvt_pk_bf16_f32 v8, v8, v8
    v_lshlrev_b32 v8, 16, v8
    v_lshlrev_b32 v9, 16, v4
    v_lshlrev_b32 v11, 16, v6
    v_add_f32 v8, v8, v9
    v_cvt_pk_bf16_f32 v8, v8, v8
    v_lshlrev_b32 v8, 16, v8
    v_add_f32 v8, v8, v11
    v_cvt_pk_bf16_f32 v8, v8, v8
    v_lshlrev_b32 v12, 16, v8
    v_cvt_pk_bf16_f32 v8, v17, v17
    v_lshlrev_b32 v8, 16, v8
    v_mul_f32 v8, v8, v10
    v_cvt_pk_bf16_f32 v8, v8, v8
    v_lshlrev_b32 v8, 16, v8
    v_and_b32 v9, 0xffff0000, v4
    v_and_b32 v11, 0xffff0000, v6
    v_add_f32 v8, v8, v9
    v_cvt_pk_bf16_f32 v8, v8, v8
    v_lshlrev_b32 v8, 16, v8
    v_add_f32 v8, v8, v11
    v_cvt_pk_bf16_f32 v8, v8, v8
    v_lshlrev_b32 v13, 16, v8
    v_cvt_pk_bf16_f32 v8, v18, v18
    v_lshlrev_b32 v8, 16, v8
    v_mul_f32 v8, v8, v10
    v_cvt_pk_bf16_f32 v8, v8, v8
    v_lshlrev_b32 v8, 16, v8
    v_lshlrev_b32 v9, 16, v5
    v_lshlrev_b32 v11, 16, v7
    v_add_f32 v8, v8, v9
    v_cvt_pk_bf16_f32 v8, v8, v8
    v_lshlrev_b32 v8, 16, v8
    v_add_f32 v8, v8, v11
    v_cvt_pk_bf16_f32 v8, v8, v8
    v_lshlrev_b32 v14, 16, v8
    v_cvt_pk_bf16_f32 v8, v19, v19
    v_lshlrev_b32 v8, 16, v8
    v_mul_f32 v8, v8, v10
    v_cvt_pk_bf16_f32 v8, v8, v8
    v_lshlrev_b32 v8, 16, v8
    v_and_b32 v9, 0xffff0000, v5
    v_and_b32 v11, 0xffff0000, v7
    v_add_f32 v8, v8, v9
    v_cvt_pk_bf16_f32 v8, v8, v8
    v_lshlrev_b32 v8, 16, v8
    v_add_f32 v8, v8, v11
    v_cvt_pk_bf16_f32 v8, v8, v8
    v_lshlrev_b32 v15, 16, v8
    v_lshrrev_b32 v8, 16, v12
    v_or_b32 v4, v13, v8
    v_lshrrev_b32 v8, 16, v14
    v_or_b32 v5, v15, v8
    buffer_store_dwordx2 v[4:5], v2, s[28:31], s39 offen
    v_add_f32 v8, v12, v13
    v_add_f32 v9, v14, v15
    v_add_f32 v8, v8, v9
    s_nop 1
    v_add_f32_dpp v8, v8, v8 quad_perm:[1,0,3,2] row_mask:0xf bank_mask:0xf
    s_nop 1
    v_add_f32_dpp v8, v8, v8 quad_perm:[2,3,0,1] row_mask:0xf bank_mask:0xf
    s_nop 1
    v_add_f32_dpp v8, v8, v8 row_half_mirror row_mask:0xf bank_mask:0xf
    s_nop 1
    v_add_f32_dpp v8, v8, v8 row_mirror row_mask:0xf bank_mask:0xf
    s_nop 1
    v_readlane_b32 s44, v8, 0
    v_readlane_b32 s45, v8, 16
    v_readlane_b32 s46, v8, 32
    v_readlane_b32 s47, v8, 48
    v_mov_b32 v8, s44
    v_add_f32 v8, s45, v8
    v_add_f32 v8, s46, v8
    v_add_f32 v8, s47, v8
    v_lshrrev_b32 v9, 6, v0
    v_lshlrev_b32 v9, 2, v9
    ds_write_b32 v9, v8 offset:0
    s_waitcnt lgkmcnt(0)
    s_barrier
    v_mov_b32 v9, 0
    ds_read_b128 v[16:19], v9 offset:0
    s_waitcnt lgkmcnt(0)
    v_add_f32 v8, v16, v17
    v_add_f32 v18, v18, v19
    v_add_f32 v8, v8, v18
    v_mul_f32 v8, 0x3a800000, v8
    v_sub_f32 v9, v12, v8
    v_mul_f32 v10, v9, v9
    v_sub_f32 v9, v13, v8
    v_fmac_f32 v10, v9, v9
    v_sub_f32 v9, v14, v8
    v_fmac_f32 v10, v9, v9
    v_sub_f32 v9, v15, v8
    v_fmac_f32 v10, v9, v9
    s_nop 1
    v_add_f32_dpp v10, v10, v10 quad_perm:[1,0,3,2] row_mask:0xf bank_mask:0xf
    s_nop 1
    v_add_f32_dpp v10, v10, v10 quad_perm:[2,3,0,1] row_mask:0xf bank_mask:0xf
    s_nop 1
    v_add_f32_dpp v10, v10, v10 row_half_mirror row_mask:0xf bank_mask:0xf
    s_nop 1
    v_add_f32_dpp v10, v10, v10 row_mirror row_mask:0xf bank_mask:0xf
    s_nop 1
    v_readlane_b32 s44, v10, 0
    v_readlane_b32 s45, v10, 16
    v_readlane_b32 s46, v10, 32
    v_readlane_b32 s47, v10, 48
    v_mov_b32 v10, s44
    v_add_f32 v10, s45, v10
    v_add_f32 v10, s46, v10
    v_add_f32 v10, s47, v10
    v_lshrrev_b32 v9, 6, v0
    v_lshlrev_b32 v9, 2, v9
    ds_write_b32 v9, v10 offset:16
    s_waitcnt lgkmcnt(0)
    s_barrier
    v_mov_b32 v9, 0
    ds_read_b128 v[16:19], v9 offset:16
    s_waitcnt lgkmcnt(0)
    v_add_f32 v10, v16, v17
    v_add_f32 v18, v18, v19
    v_add_f32 v10, v10, v18
    v_mul_f32 v10, 0x3a800000, v10
    v_cvt_pk_bf16_f32 v9, v8, v10
    v_lshlrev_b32 v8, 16, v9
    v_and_b32 v10, 0xffff0000, v9
    v_add_f32 v10, 0x3727c5ac, v10
    v_cvt_pk_bf16_f32 v10, v10, v10
    v_lshlrev_b32 v10, 16, v10
    v_sqrt_f32 v10, v10
    s_nop 0
    v_cvt_pk_bf16_f32 v10, v10, v10
    v_lshlrev_b32 v10, 16, v10
    v_rcp_f32 v11, v10
    s_nop 0
    v_sub_f32 v12, v12, v8
    v_sub_f32 v13, v13, v8
    v_cvt_pk_bf16_f32 v12, v12, v13
    v_and_b32 v13, 0xffff0000, v12
    v_lshlrev_b32 v12, 16, v12
    v_mul_f32 v16, v12, v11
    v_mul_f32 v17, v13, v11
    v_fma_f32 v18, -v16, v10, v12
    v_fma_f32 v19, -v17, v10, v13
    v_fma_f32 v16, v18, v11, v16
    v_fma_f32 v17, v19, v11, v17
    v_cvt_pk_bf16_f32 v4, v16, v17
    v_sub_f32 v14, v14, v8
    v_sub_f32 v15, v15, v8
    v_cvt_pk_bf16_f32 v14, v14, v15
    v_and_b32 v15, 0xffff0000, v14
    v_lshlrev_b32 v14, 16, v14
    v_mul_f32 v16, v14, v11
    v_mul_f32 v17, v15, v11
    v_fma_f32 v18, -v16, v10, v14
    v_fma_f32 v19, -v17, v10, v15
    v_fma_f32 v16, v18, v11, v16
    v_fma_f32 v17, v19, v11, v17
    v_cvt_pk_bf16_f32 v5, v16, v17
    s_lshr_b32 s44, s38, 5
    s_lshl_b32 s44, s44, 16
    s_and_b32 s45, s38, 31
    s_lshl_b32 s45, s45, 4
    s_add_u32 s44, s44, s45
    v_lshrrev_b32 v8, 2, v0
    v_lshlrev_b32 v8, 10, v8
    v_bfe_u32 v9, v0, 1, 1
    v_lshl_add_u32 v8, v9, 9, v8
    v_and_b32 v9, 1, v0
    v_lshl_add_u32 v8, v9, 3, v8
    buffer_store_dwordx2 v[4:5], v8, s[32:35], s44 offen
fix0_kernel_exit1:
    s_endpgm
.section .rodata,"a"
.p2align 6
.amdhsa_kernel fix0_kernel
  .amdhsa_next_free_vgpr 136
  .amdhsa_next_free_sgpr 56
  .amdhsa_accum_offset 136
  .amdhsa_group_segment_fixed_size 0
  .amdhsa_kernarg_size 88
  .amdhsa_user_sgpr_count 2
  .amdhsa_user_sgpr_kernarg_segment_ptr 1
  .amdhsa_system_sgpr_workgroup_id_x 1
.end_amdhsa_kernel

.text
.globl wo1_kernel
.p2align 8
.type wo1_kernel,@function
wo1_kernel:
    s_cmp_ge_u32 s2, 256
    s_cbranch_scc1 wo1_kernel_exit1
    s_load_dwordx2 s[10:11], s[0:1], 80
    s_load_dwordx2 s[8:9], s[0:1], 0
    v_lshrrev_b32 v1, 6, v0
    v_and_b32 v0, 63, v0
    s_nop 0
    v_readfirstlane_b32 s20, v1
    s_and_b32 s21, s2, 7
    s_lshr_b32 s22, s2, 3
    s_and_b32 s23, s21, 1
    s_lshl_b32 s23, s23, 3
    s_and_b32 s24, s22, 7
    s_add_u32 s23, s23, s24
    s_lshr_b32 s24, s21, 1
    s_lshl_b32 s24, s24, 2
    s_lshr_b32 s25, s22, 3
    s_add_u32 s24, s24, s25
    s_lshr_b32 s25, s20, 1
    s_and_b32 s26, s20, 1
    s_waitcnt lgkmcnt(0)
    s_mov_b32 s12, s10
    s_and_b32 s13, s11, 0xffff
    s_mov_b32 s14, 0x1400000
    s_mov_b32 s15, 0x20000
    s_lshl_b32 s27, s23, 18
    s_add_u32 s40, s27, 0x1000000
    s_add_u32 s41, s27, 0x1010000
    s_add_u32 s42, s27, 0x1020000
    s_add_u32 s43, s27, 0x1030000
    s_lshl_b32 s27, s24, 17
    s_add_u32 s44, s27, 0x600000
    s_add_u32 s45, s27, 0x610000
    s_lshl_b32 s28, s20, 10
    v_lshlrev_b32 v1, 4, v0
    v_add_u32 v1, s28, v1
    v_lshlrev_b32 v2, 4, v0
    s_lshl_b32 s29, s25, 13
    v_add_u32 v2, s29, v2
    s_lshl_b32 s29, s26, 12
    s_add_u32 s29, s29, 16384
    v_lshlrev_b32 v3, 4, v0
    v_add_u32 v3, s29, v3
    s_sub_u32 s40, s40, 4096
    s_sub_u32 s41, s41, 4096
    s_sub_u32 s42, s42, 4096
    s_sub_u32 s43, s43, 4096
    s_sub_u32 s44, s44, 4096
    s_sub_u32 s45, s45, 4096
    s_mov_b32 s34, s28
    s_add_u32 m0, s34, 0x0
    s_add_u32 s40, s40, 4096
    buffer_load_dwordx4 v1, s[12:15], s40 offen lds
    s_add_u32 m0, s34, 0x1000
    s_add_u32 s41, s41, 4096
    buffer_load_dwordx4 v1, s[12:15], s41 offen lds
    s_add_u32 m0, s34, 0x2000
    s_add_u32 s42, s42, 4096
    buffer_load_dwordx4 v1, s[12:15], s42 offen lds
    s_add_u32 m0, s34, 0x3000
    s_add_u32 s43, s43, 4096
    buffer_load_dwordx4 v1, s[12:15], s43 offen lds
    s_add_u32 m0, s34, 0x4000
    s_add_u32 s44, s44, 4096
    buffer_load_dwordx4 v1, s[12:15], s44 offen lds
    s_add_u32 m0, s34, 0x5000
    s_add_u32 s45, s45, 4096
    buffer_load_dwordx4 v1, s[12:15], s45 offen lds
    s_add_u32 s34, s34, 24576
    s_add_u32 m0, s34, 0x0
    s_add_u32 s40, s40, 4096
    buffer_load_dwordx4 v1, s[12:15], s40 offen lds
    s_add_u32 m0, s34, 0x1000
    s_add_u32 s41, s41, 4096
    buffer_load_dwordx4 v1, s[12:15], s41 offen lds
    s_add_u32 m0, s34, 0x2000
    s_add_u32 s42, s42, 4096
    buffer_load_dwordx4 v1, s[12:15], s42 offen lds
    s_add_u32 m0, s34, 0x3000
    s_add_u32 s43, s43, 4096
    buffer_load_dwordx4 v1, s[12:15], s43 offen lds
    s_add_u32 m0, s34, 0x4000
    s_add_u32 s44, s44, 4096
    buffer_load_dwordx4 v1, s[12:15], s44 offen lds
    s_add_u32 m0, s34, 0x5000
    s_add_u32 s45, s45, 4096
    buffer_load_dwordx4 v1, s[12:15], s45 offen lds
    s_add_u32 s34, s34, 24576
    s_add_u32 m0, s34, 0x0
    s_add_u32 s40, s40, 4096
    buffer_load_dwordx4 v1, s[12:15], s40 offen lds
    s_add_u32 m0, s34, 0x1000
    s_add_u32 s41, s41, 4096
    buffer_load_dwordx4 v1, s[12:15], s41 offen lds
    s_add_u32 m0, s34, 0x2000
    s_add_u32 s42, s42, 4096
    buffer_load_dwordx4 v1, s[12:15], s42 offen lds
    s_add_u32 m0, s34, 0x3000
    s_add_u32 s43, s43, 4096
    buffer_load_dwordx4 v1, s[12:15], s43 offen lds
    s_add_u32 m0, s34, 0x4000
    s_add_u32 s44, s44, 4096
    buffer_load_dwordx4 v1, s[12:15], s44 offen lds
    s_add_u32 m0, s34, 0x5000
    s_add_u32 s45, s45, 4096
    buffer_load_dwordx4 v1, s[12:15], s45 offen lds
    s_add_u32 s34, s34, 24576
    v_mov_b32 v48, 0
    v_mov_b32 v49, 0
    v_mov_b32 v50, 0
    v_mov_b32 v51, 0
    v_mov_b32 v52, 0
    v_mov_b32 v53, 0
    v_mov_b32 v54, 0
    v_mov_b32 v55, 0
    v_mov_b32 v56, 0
    v_mov_b32 v57, 0
    v_mov_b32 v58, 0
    v_mov_b32 v59, 0
    v_mov_b32 v60, 0
    v_mov_b32 v61, 0
    v_mov_b32 v62, 0
    v_mov_b32 v63, 0
    v_mov_b32 v64, 0
    v_mov_b32 v65, 0
    v_mov_b32 v66, 0
    v_mov_b32 v67, 0
    v_mov_b32 v68, 0
    v_mov_b32 v69, 0
    v_mov_b32 v70, 0
    v_mov_b32 v71, 0
    v_mov_b32 v72, 0
    v_mov_b32 v73, 0
    v_mov_b32 v74, 0
    v_mov_b32 v75, 0
    v_mov_b32 v76, 0
    v_mov_b32 v77, 0
    v_mov_b32 v78, 0
    v_mov_b32 v79, 0
    s_mov_b32 s32, 0
    s_mov_b32 s33, 0
    s_waitcnt vmcnt(12)
    s_barrier
    v_add_u32 v4, s33, v2
    v_add_u32 v5, s33, v3
    ds_read_b128 v[16:19], v4 offset:0
    ds_read_b128 v[20:23], v4 offset:4096
    ds_read_b128 v[24:27], v5 offset:0
wo1_kernel_loop3:
    s_waitcnt lgkmcnt(0)
    v_mfma_f32_32x32x16_bf16 v[48:63], v[24:27], v[16:19], v[48:63]
    ds_read_b128 v[28:31], v4 offset:1024
    ds_read_b128 v[32:35], v4 offset:5120
    v_mfma_f32_32x32x16_bf16 v[64:79], v[24:27], v[20:23], v[64:79]
    ds_read_b128 v[36:39], v5 offset:1024
    s_add_u32 m0, s34, 0x0
    s_add_u32 s40, s40, 4096
    buffer_load_dwordx4 v1, s[12:15], s40 offen lds
    s_add_u32 m0, s34, 0x1000
    s_add_u32 s41, s41, 4096
    buffer_load_dwordx4 v1, s[12:15], s41 offen lds
    s_waitcnt lgkmcnt(0)
    v_mfma_f32_32x32x16_bf16 v[48:63], v[36:39], v[28:31], v[48:63]
    ds_read_b128 v[16:19], v4 offset:2048
    ds_read_b128 v[20:23], v4 offset:6144
    v_mfma_f32_32x32x16_bf16 v[64:79], v[36:39], v[32:35], v[64:79]
    ds_read_b128 v[24:27], v5 offset:2048
    s_add_u32 m0, s34, 0x2000
    s_add_u32 s42, s42, 4096
    buffer_load_dwordx4 v1, s[12:15], s42 offen lds
    s_add_u32 m0, s34, 0x3000
    s_add_u32 s43, s43, 4096
    buffer_load_dwordx4 v1, s[12:15], s43 offen lds
    s_waitcnt lgkmcnt(0)
    v_mfma_f32_32x32x16_bf16 v[48:63], v[24:27], v[16:19], v[48:63]
    ds_read_b128 v[28:31], v4 offset:3072
    ds_read_b128 v[32:35], v4 offset:7168
    v_mfma_f32_32x32x16_bf16 v[64:79], v[24:27], v[20:23], v[64:79]
    ds_read_b128 v[36:39], v5 offset:3072
    s_add_u32 m0, s34, 0x4000
    s_add_u32 s44, s44, 4096
    buffer_load_dwordx4 v1, s[12:15], s44 offen lds
    s_waitcnt lgkmcnt(0)
    v_mfma_f32_32x32x16_bf16 v[48:63], v[36:39], v[28:31], v[48:63]
    s_waitcnt vmcnt(11)
    s_barrier
    s_add_u32 s33, s33, 24576
    s_cmp_eq_u32 s33, 98304
    s_cselect_b32 s33, 0, s33
    v_add_u32 v4, s33, v2
    v_add_u32 v5, s33, v3
    ds_read_b128 v[16:19], v4 offset:0
    ds_read_b128 v[20:23], v4 offset:4096
    v_mfma_f32_32x32x16_bf16 v[64:79], v[36:39], v[32:35], v[64:79]
    ds_read_b128 v[24:27], v5 offset:0
    s_add_u32 m0, s34, 0x5000
    s_add_u32 s45, s45, 4096
    buffer_load_dwordx4 v1, s[12:15], s45 offen lds
    s_add_u32 s34, s34, 24576
    s_cmp_ge_u32 s34, 98304
    s_cselect_b32 s35, 98304, 0
    s_sub_u32 s34, s34, s35
    s_add_u32 s32, s32, 1
    s_cmp_lt_u32 s32, 13
    s_cbranch_scc1 wo1_kernel_loop3
    s_waitcnt lgkmcnt(0)
    v_mfma_f32_32x32x16_bf16 v[48:63], v[24:27], v[16:19], v[48:63]
    ds_read_b128 v[28:31], v4 offset:1024
    ds_read_b128 v[32:35], v4 offset:5120
    v_mfma_f32_32x32x16_bf16 v[64:79], v[24:27], v[20:23], v[64:79]
    ds_read_b128 v[36:39], v5 offset:1024
    s_waitcnt lgkmcnt(0)
    v_mfma_f32_32x32x16_bf16 v[48:63], v[36:39], v[28:31], v[48:63]
    ds_read_b128 v[16:19], v4 offset:2048
    ds_read_b128 v[20:23], v4 offset:6144
    v_mfma_f32_32x32x16_bf16 v[64:79], v[36:39], v[32:35], v[64:79]
    ds_read_b128 v[24:27], v5 offset:2048
    s_waitcnt lgkmcnt(0)
    v_mfma_f32_32x32x16_bf16 v[48:63], v[24:27], v[16:19], v[48:63]
    ds_read_b128 v[28:31], v4 offset:3072
    ds_read_b128 v[32:35], v4 offset:7168
    v_mfma_f32_32x32x16_bf16 v[64:79], v[24:27], v[20:23], v[64:79]
    ds_read_b128 v[36:39], v5 offset:3072
    s_waitcnt lgkmcnt(0)
    v_mfma_f32_32x32x16_bf16 v[48:63], v[36:39], v[28:31], v[48:63]
    s_waitcnt vmcnt(6)
    s_barrier
    s_add_u32 s33, s33, 24576
    s_cmp_eq_u32 s33, 98304
    s_cselect_b32 s33, 0, s33
    v_add_u32 v4, s33, v2
    v_add_u32 v5, s33, v3
    ds_read_b128 v[16:19], v4 offset:0
    ds_read_b128 v[20:23], v4 offset:4096
    v_mfma_f32_32x32x16_bf16 v[64:79], v[36:39], v[32:35], v[64:79]
    ds_read_b128 v[24:27], v5 offset:0
    s_waitcnt lgkmcnt(0)
    v_mfma_f32_32x32x16_bf16 v[48:63], v[24:27], v[16:19], v[48:63]
    ds_read_b128 v[28:31], v4 offset:1024
    ds_read_b128 v[32:35], v4 offset:5120
    v_mfma_f32_32x32x16_bf16 v[64:79], v[24:27], v[20:23], v[64:79]
    ds_read_b128 v[36:39], v5 offset:1024
    s_waitcnt lgkmcnt(0)
    v_mfma_f32_32x32x16_bf16 v[48:63], v[36:39], v[28:31], v[48:63]
    ds_read_b128 v[16:19], v4 offset:2048
    ds_read_b128 v[20:23], v4 offset:6144
    v_mfma_f32_32x32x16_bf16 v[64:79], v[36:39], v[32:35], v[64:79]
    ds_read_b128 v[24:27], v5 offset:2048
    s_waitcnt lgkmcnt(0)
    v_mfma_f32_32x32x16_bf16 v[48:63], v[24:27], v[16:19], v[48:63]
    ds_read_b128 v[28:31], v4 offset:3072
    ds_read_b128 v[32:35], v4 offset:7168
    v_mfma_f32_32x32x16_bf16 v[64:79], v[24:27], v[20:23], v[64:79]
    ds_read_b128 v[36:39], v5 offset:3072
    s_waitcnt lgkmcnt(0)
    v_mfma_f32_32x32x16_bf16 v[48:63], v[36:39], v[28:31], v[48:63]
    s_waitcnt vmcnt(0)
    s_barrier
    s_add_u32 s33, s33, 24576
    s_cmp_eq_u32 s33, 98304
    s_cselect_b32 s33, 0, s33
    v_add_u32 v4, s33, v2
    v_add_u32 v5, s33, v3
    ds_read_b128 v[16:19], v4 offset:0
    ds_read_b128 v[20:23], v4 offset:4096
    v_mfma_f32_32x32x16_bf16 v[64:79], v[36:39], v[32:35], v[64:79]
    ds_read_b128 v[24:27], v5 offset:0
    s_waitcnt lgkmcnt(0)
    v_mfma_f32_32x32x16_bf16 v[48:63], v[24:27], v[16:19], v[48:63]
    ds_read_b128 v[28:31], v4 offset:1024
    ds_read_b128 v[32:35], v4 offset:5120
    v_mfma_f32_32x32x16_bf16 v[64:79], v[24:27], v[20:23], v[64:79]
    ds_read_b128 v[36:39], v5 offset:1024
    s_waitcnt lgkmcnt(0)
    v_mfma_f32_32x32x16_bf16 v[48:63], v[36:39], v[28:31], v[48:63]
    ds_read_b128 v[16:19], v4 offset:2048
    ds_read_b128 v[20:23], v4 offset:6144
    v_mfma_f32_32x32x16_bf16 v[64:79], v[36:39], v[32:35], v[64:79]
    ds_read_b128 v[24:27], v5 offset:2048
    s_waitcnt lgkmcnt(0)
    v_mfma_f32_32x32x16_bf16 v[48:63], v[24:27], v[16:19], v[48:63]
    ds_read_b128 v[28:31], v4 offset:3072
    ds_read_b128 v[32:35], v4 offset:7168
    v_mfma_f32_32x32x16_bf16 v[64:79], v[24:27], v[20:23], v[64:79]
    ds_read_b128 v[36:39], v5 offset:3072
    s_waitcnt lgkmcnt(0)
    v_mfma_f32_32x32x16_bf16 v[48:63], v[36:39], v[28:31], v[48:63]
    v_mfma_f32_32x32x16_bf16 v[64:79], v[36:39], v[32:35], v[64:79]
    s_add_u32 s16, s10, 0x1800000
    s_addc_u32 s17, s11, 0
    s_and_b32 s17, s17, 0xffff
    s_mov_b32 s18, 0x400000
    s_mov_b32 s19, 0x20000
    s_add_u32 s36, s10, 0x1400000
    s_addc_u32 s37, s11, 0
    s_and_b32 s37, s37, 0xffff
    s_mov_b32 s38, 0x400000
    s_mov_b32 s39, 0x20000
    s_lshl_b32 s27, s23, 2
    s_lshl_b32 s29, s25, 1
    s_add_u32 s27, s27, s29
    s_lshl_b32 s27, s27, 16
    s_lshl_b32 s29, s24, 7
    s_lshl_b32 s30, s26, 6
    s_add_u32 s29, s29, s30
    s_add_u32 s27, s27, s29
    s_add_u32 s28, s27, 65536
    v_and_b32 v6, 31, v0
    v_lshlrev_b32 v6, 11, v6
    v_lshrrev_b32 v7, 5, v0
    v_lshl_add_u32 v6, v7, 5, v6
    buffer_load_dwordx4 v[80:83], v6, s[16:19], s27 offen offset:0
    buffer_load_dwordx4 v[84:87], v6, s[16:19], s27 offen offset:16
    buffer_load_dwordx4 v[88:91], v6, s[16:19], s28 offen offset:0
    buffer_load_dwordx4 v[92:95], v6, s[16:19], s28 offen offset:16
    s_nop 7
    s_waitcnt vmcnt(0)
    v_cvt_pk_bf16_f32 v8, v48, v49
    v_lshlrev_b32 v9, 16, v8
    v_and_b32 v8, 0xffff0000, v8
    v_lshlrev_b32 v10, 16, v80
    v_and_b32 v11, 0xffff0000, v80
    v_add_f32 v9, v9, v10
    v_add_f32 v8, v8, v11
    v_cvt_pk_bf16_f32 v96, v9, v8
    v_cvt_pk_bf16_f32 v8, v50, v51
    v_lshlrev_b32 v9, 16, v8
    v_and_b32 v8, 0xffff0000, v8
    v_lshlrev_b32 v10, 16, v81
    v_and_b32 v11, 0xffff0000, v81
    v_add_f32 v9, v9, v10
    v_add_f32 v8, v8, v11
    v_cvt_pk_bf16_f32 v97, v9, v8
    v_cvt_pk_bf16_f32 v8, v52, v53
    v_lshlrev_b32 v9, 16, v8
    v_and_b32 v8, 0xffff0000, v8
    v_lshlrev_b32 v10, 16, v82
    v_and_b32 v11, 0xffff0000, v82
    v_add_f32 v9, v9, v10
    v_add_f32 v8, v8, v11
    v_cvt_pk_bf16_f32 v98, v9, v8
    v_cvt_pk_bf16_f32 v8, v54, v55
    v_lshlrev_b32 v9, 16, v8
    v_and_b32 v8, 0xffff0000, v8
    v_lshlrev_b32 v10, 16, v83
    v_and_b32 v11, 0xffff0000, v83
    v_add_f32 v9, v9, v10
    v_add_f32 v8, v8, v11
    v_cvt_pk_bf16_f32 v99, v9, v8
    v_cvt_pk_bf16_f32 v8, v56, v57
    v_lshlrev_b32 v9, 16, v8
    v_and_b32 v8, 0xffff0000, v8
    v_lshlrev_b32 v10, 16, v84
    v_and_b32 v11, 0xffff0000, v84
    v_add_f32 v9, v9, v10
    v_add_f32 v8, v8, v11
    v_cvt_pk_bf16_f32 v100, v9, v8
    v_cvt_pk_bf16_f32 v8, v58, v59
    v_lshlrev_b32 v9, 16, v8
    v_and_b32 v8, 0xffff0000, v8
    v_lshlrev_b32 v10, 16, v85
    v_and_b32 v11, 0xffff0000, v85
    v_add_f32 v9, v9, v10
    v_add_f32 v8, v8, v11
    v_cvt_pk_bf16_f32 v101, v9, v8
    v_cvt_pk_bf16_f32 v8, v60, v61
    v_lshlrev_b32 v9, 16, v8
    v_and_b32 v8, 0xffff0000, v8
    v_lshlrev_b32 v10, 16, v86
    v_and_b32 v11, 0xffff0000, v86
    v_add_f32 v9, v9, v10
    v_add_f32 v8, v8, v11
    v_cvt_pk_bf16_f32 v102, v9, v8
    v_cvt_pk_bf16_f32 v8, v62, v63
    v_lshlrev_b32 v9, 16, v8
    v_and_b32 v8, 0xffff0000, v8
    v_lshlrev_b32 v10, 16, v87
    v_and_b32 v11, 0xffff0000, v87
    v_add_f32 v9, v9, v10
    v_add_f32 v8, v8, v11
    v_cvt_pk_bf16_f32 v103, v9, v8
    buffer_store_dwordx4 v[96:99], v6, s[36:39], s27 offen offset:0
    buffer_store_dwordx4 v[100:103], v6, s[36:39], s27 offen offset:16
    v_cvt_pk_bf16_f32 v8, v64, v65
    v_lshlrev_b32 v9, 16, v8
    v_and_b32 v8, 0xffff0000, v8
    v_lshlrev_b32 v10, 16, v88
    v_and_b32 v11, 0xffff0000, v88
    v_add_f32 v9, v9, v10
    v_add_f32 v8, v8, v11
    v_cvt_pk_bf16_f32 v104, v9, v8
    v_cvt_pk_bf16_f32 v8, v66, v67
    v_lshlrev_b32 v9, 16, v8
    v_and_b32 v8, 0xffff0000, v8
    v_lshlrev_b32 v10, 16, v89
    v_and_b32 v11, 0xffff0000, v89
    v_add_f32 v9, v9, v10
    v_add_f32 v8, v8, v11
    v_cvt_pk_bf16_f32 v105, v9, v8
    v_cvt_pk_bf16_f32 v8, v68, v69
    v_lshlrev_b32 v9, 16, v8
    v_and_b32 v8, 0xffff0000, v8
    v_lshlrev_b32 v10, 16, v90
    v_and_b32 v11, 0xffff0000, v90
    v_add_f32 v9, v9, v10
    v_add_f32 v8, v8, v11
    v_cvt_pk_bf16_f32 v106, v9, v8
    v_cvt_pk_bf16_f32 v8, v70, v71
    v_lshlrev_b32 v9, 16, v8
    v_and_b32 v8, 0xffff0000, v8
    v_lshlrev_b32 v10, 16, v91
    v_and_b32 v11, 0xffff0000, v91
    v_add_f32 v9, v9, v10
    v_add_f32 v8, v8, v11
    v_cvt_pk_bf16_f32 v107, v9, v8
    v_cvt_pk_bf16_f32 v8, v72, v73
    v_lshlrev_b32 v9, 16, v8
    v_and_b32 v8, 0xffff0000, v8
    v_lshlrev_b32 v10, 16, v92
    v_and_b32 v11, 0xffff0000, v92
    v_add_f32 v9, v9, v10
    v_add_f32 v8, v8, v11
    v_cvt_pk_bf16_f32 v108, v9, v8
    v_cvt_pk_bf16_f32 v8, v74, v75
    v_lshlrev_b32 v9, 16, v8
    v_and_b32 v8, 0xffff0000, v8
    v_lshlrev_b32 v10, 16, v93
    v_and_b32 v11, 0xffff0000, v93
    v_add_f32 v9, v9, v10
    v_add_f32 v8, v8, v11
    v_cvt_pk_bf16_f32 v109, v9, v8
    v_cvt_pk_bf16_f32 v8, v76, v77
    v_lshlrev_b32 v9, 16, v8
    v_and_b32 v8, 0xffff0000, v8
    v_lshlrev_b32 v10, 16, v94
    v_and_b32 v11, 0xffff0000, v94
    v_add_f32 v9, v9, v10
    v_add_f32 v8, v8, v11
    v_cvt_pk_bf16_f32 v110, v9, v8
    v_cvt_pk_bf16_f32 v8, v78, v79
    v_lshlrev_b32 v9, 16, v8
    v_and_b32 v8, 0xffff0000, v8
    v_lshlrev_b32 v10, 16, v95
    v_and_b32 v11, 0xffff0000, v95
    v_add_f32 v9, v9, v10
    v_add_f32 v8, v8, v11
    v_cvt_pk_bf16_f32 v111, v9, v8
    buffer_store_dwordx4 v[104:107], v6, s[36:39], s28 offen offset:0
    buffer_store_dwordx4 v[108:111], v6, s[36:39], s28 offen offset:16
wo1_kernel_exit1:
    s_endpgm
.section .rodata,"a"
.p2align 6
.amdhsa_kernel wo1_kernel
  .amdhsa_next_free_vgpr 112
  .amdhsa_next_free_sgpr 56
  .amdhsa_accum_offset 112
  .amdhsa_group_segment_fixed_size 0
  .amdhsa_kernarg_size 88
  .amdhsa_user_sgpr_count 2
  .amdhsa_user_sgpr_kernarg_segment_ptr 1
  .amdhsa_system_sgpr_workgroup_id_x 1
.end_amdhsa_kernel

.text
.globl ln2_1_kernel
.p2align 8
.type ln2_1_kernel,@function
ln2_1_kernel:
    s_cmp_ge_u32 s2, 256
    s_cbranch_scc1 ln2_1_kernel_exit1
    s_load_dwordx2 s[10:11], s[0:1], 80
    s_load_dwordx2 s[8:9], s[0:1], 32
    s_load_dwordx2 s[6:7], s[0:1], 64
    v_lshrrev_b32 v1, 6, v0
    v_and_b32 v0, 63, v0
    s_nop 0
    v_readfirstlane_b32 s20, v1
    s_lshl_b32 s21, s2, 3
    s_add_u32 s22, s21, s20
    s_lshl_b32 s23, s22, 11
    v_lshlrev_b32 v2, 5, v0
    s_waitcnt lgkmcnt(0)
    s_add_u32 s12, s10, 0x1400000
    s_addc_u32 s13, s11, 0
    s_and_b32 s13, s13, 0xffff
    s_mov_b32 s14, 0x400000
    s_mov_b32 s15, 0x20000
    s_mov_b32 s16, s8
    s_and_b32 s17, s9, 0xffff
    s_mov_b32 s18, 0x800
    s_mov_b32 s19, 0x20000
    s_add_u32 s24, s10, 0x1c00000
    s_addc_u32 s25, s11, 0
    s_and_b32 s25, s25, 0xffff
    s_mov_b32 s26, 0x400000
    s_mov_b32 s27, 0x20000
    s_add_u32 s28, s10, 0x2210000
    s_addc_u32 s29, s11, 0
    s_and_b32 s29, s29, 0xffff
    s_mov_b32 s30, 0x2000
    s_mov_b32 s31, 0x20000
    s_mov_b32 s32, s6
    s_and_b32 s33, s7, 0xffff
    s_mov_b32 s34, 0x400000
    s_mov_b32 s35, 0x20000
    buffer_load_dwordx4 v[8:11], v2, s[12:15], s23 offen
    buffer_load_dwordx4 v[12:15], v2, s[12:15], s23 offen offset:16
    buffer_load_dwordx4 v[16:19], v2, s[16:19], 0 offen
    buffer_load_dwordx4 v[20:23], v2, s[16:19], 0 offen offset:16
    s_waitcnt vmcnt(2)
    v_lshlrev_b32 v32, 16, v8
    v_and_b32 v33, 0xffff0000, v8
    v_lshlrev_b32 v34, 16, v9
    v_and_b32 v35, 0xffff0000, v9
    v_lshlrev_b32 v36, 16, v10
    v_and_b32 v37, 0xffff0000, v10
    v_lshlrev_b32 v38, 16, v11
    v_and_b32 v39, 0xffff0000, v11
    v_lshlrev_b32 v40, 16, v12
    v_and_b32 v41, 0xffff0000, v12
    v_lshlrev_b32 v42, 16, v13
    v_and_b32 v43, 0xffff0000, v13
    v_lshlrev_b32 v44, 16, v14
    v_and_b32 v45, 0xffff0000, v14
    v_lshlrev_b32 v46, 16, v15
    v_and_b32 v47, 0xffff0000, v15
    v_add_f32 v48, v32, v33
    v_add_f32 v49, v34, v35
    v_add_f32 v48, v48, v36
    v_add_f32 v49, v49, v37
    v_add_f32 v48, v48, v38
    v_add_f32 v49, v49, v39
    v_add_f32 v48, v48, v40
    v_add_f32 v49, v49, v41
    v_add_f32 v48, v48, v42
    v_add_f32 v49, v49, v43
    v_add_f32 v48, v48, v44
    v_add_f32 v49, v49, v45
    v_add_f32 v48, v48, v46
    v_add_f32 v49, v49, v47
    v_add_f32 v48, v48, v49
    s_nop 1
    v_add_f32_dpp v48, v48, v48 quad_perm:[1,0,3,2] row_mask:0xf bank_mask:0xf
    s_nop 1
    v_add_f32_dpp v48, v48, v48 quad_perm:[2,3,0,1] row_mask:0xf bank_mask:0xf
    s_nop 1
    v_add_f32_dpp v48, v48, v48 row_half_mirror row_mask:0xf bank_mask:0xf
    s_nop 1
    v_add_f32_dpp v48, v48, v48 row_mirror row_mask:0xf bank_mask:0xf
    s_nop 1
    v_readlane_b32 s40, v48, 0
    v_readlane_b32 s41, v48, 16
    v_readlane_b32 s42, v48, 32
    v_readlane_b32 s43, v48, 48
    s_nop 1
    v_mov_b32 v48, s40
    v_add_f32 v48, s41, v48
    v_add_f32 v48, s42, v48
    v_add_f32 v48, s43, v48
    v_mul_f32 v50, 0x3a800000, v48
    v_mov_b32 v48, 0
    v_mov_b32 v49, 0
    v_sub_f32 v54, v32, v50
    v_sub_f32 v55, v33, v50
    v_fmac_f32 v48, v54, v54
    v_fmac_f32 v49, v55, v55
    v_sub_f32 v54, v34, v50
    v_sub_f32 v55, v35, v50
    v_fmac_f32 v48, v54, v54
    v_fmac_f32 v49, v55, v55
    v_sub_f32 v54, v36, v50
    v_sub_f32 v55, v37, v50
    v_fmac_f32 v48, v54, v54
    v_fmac_f32 v49, v55, v55
    v_sub_f32 v54, v38, v50
    v_sub_f32 v55, v39, v50
    v_fmac_f32 v48, v54, v54
    v_fmac_f32 v49, v55, v55
    v_sub_f32 v54, v40, v50
    v_sub_f32 v55, v41, v50
    v_fmac_f32 v48, v54, v54
    v_fmac_f32 v49, v55, v55
    v_sub_f32 v54, v42, v50
    v_sub_f32 v55, v43, v50
    v_fmac_f32 v48, v54, v54
    v_fmac_f32 v49, v55, v55
    v_sub_f32 v54, v44, v50
    v_sub_f32 v55, v45, v50
    v_fmac_f32 v48, v54, v54
    v_fmac_f32 v49, v55, v55
    v_sub_f32 v54, v46, v50
    v_sub_f32 v55, v47, v50
    v_fmac_f32 v48, v54, v54
    v_fmac_f32 v49, v55, v55
    v_add_f32 v48, v48, v49
    s_nop 1
    v_add_f32_dpp v48, v48, v48 quad_perm:[1,0,3,2] row_mask:0xf bank_mask:0xf
    s_nop 1
    v_add_f32_dpp v48, v48, v48 quad_perm:[2,3,0,1] row_mask:0xf bank_mask:0xf
    s_nop 1
    v_add_f32_dpp v48, v48, v48 row_half_mirror row_mask:0xf bank_mask:0xf
    s_nop 1
    v_add_f32_dpp v48, v48, v48 row_mirror row_mask:0xf bank_mask:0xf
    s_nop 1
    v_readlane_b32 s40, v48, 0
    v_readlane_b32 s41, v48, 16
    v_readlane_b32 s42, v48, 32
    v_readlane_b32 s43, v48, 48
    s_nop 1
    v_mov_b32 v48, s40
    v_add_f32 v48, s41, v48
    v_add_f32 v48, s42, v48
    v_add_f32 v48, s43, v48
    v_mul_f32 v48, 0x3a800000, v48
    v_cvt_pk_bf16_f32 v54, v50, v48
    v_lshlrev_b32 v51, 16, v54
    v_and_b32 v48, 0xffff0000, v54
    v_add_f32 v48, 0x3727c5ac, v48
    v_cvt_pk_bf16_f32 v48, v48, v48
    v_lshlrev_b32 v48, 16, v48
    v_sqrt_f32 v48, v48
    s_nop 0
    v_cvt_pk_bf16_f32 v48, v48, v48
    v_lshlrev_b32 v52, 16, v48
    v_rcp_f32 v53, v52
    s_nop 0
    v_sub_f32 v48, v32, v51
    v_sub_f32 v49, v33, v51
    v_cvt_pk_bf16_f32 v48, v48, v49
    v_and_b32 v49, 0xffff0000, v48
    v_lshlrev_b32 v48, 16, v48
    v_mul_f32 v54, v48, v53
    v_mul_f32 v55, v49, v53
    v_fma_f32 v56, -v54, v52, v48
    v_fma_f32 v57, -v55, v52, v49
    v_fma_f32 v54, v56, v53, v54
    v_fma_f32 v55, v57, v53, v55
    v_cvt_pk_bf16_f32 v24, v54, v55
    v_sub_f32 v48, v34, v51
    v_sub_f32 v49, v35, v51
    v_cvt_pk_bf16_f32 v48, v48, v49
    v_and_b32 v49, 0xffff0000, v48
    v_lshlrev_b32 v48, 16, v48
    v_mul_f32 v54, v48, v53
    v_mul_f32 v55, v49, v53
    v_fma_f32 v56, -v54, v52, v48
    v_fma_f32 v57, -v55, v52, v49
    v_fma_f32 v54, v56, v53, v54
    v_fma_f32 v55, v57, v53, v55
    v_cvt_pk_bf16_f32 v25, v54, v55
    v_sub_f32 v48, v36, v51
    v_sub_f32 v49, v37, v51
    v_cvt_pk_bf16_f32 v48, v48, v49
    v_and_b32 v49, 0xffff0000, v48
    v_lshlrev_b32 v48, 16, v48
    v_mul_f32 v54, v48, v53
    v_mul_f32 v55, v49, v53
    v_fma_f32 v56, -v54, v52, v48
    v_fma_f32 v57, -v55, v52, v49
    v_fma_f32 v54, v56, v53, v54
    v_fma_f32 v55, v57, v53, v55
    v_cvt_pk_bf16_f32 v26, v54, v55
    v_sub_f32 v48, v38, v51
    v_sub_f32 v49, v39, v51
    v_cvt_pk_bf16_f32 v48, v48, v49
    v_and_b32 v49, 0xffff0000, v48
    v_lshlrev_b32 v48, 16, v48
    v_mul_f32 v54, v48, v53
    v_mul_f32 v55, v49, v53
    v_fma_f32 v56, -v54, v52, v48
    v_fma_f32 v57, -v55, v52, v49
    v_fma_f32 v54, v56, v53, v54
    v_fma_f32 v55, v57, v53, v55
    v_cvt_pk_bf16_f32 v27, v54, v55
    v_sub_f32 v48, v40, v51
    v_sub_f32 v49, v41, v51
    v_cvt_pk_bf16_f32 v48, v48, v49
    v_and_b32 v49, 0xffff0000, v48
    v_lshlrev_b32 v48, 16, v48
    v_mul_f32 v54, v48, v53
    v_mul_f32 v55, v49, v53
    v_fma_f32 v56, -v54, v52, v48
    v_fma_f32 v57, -v55, v52, v49
    v_fma_f32 v54, v56, v53, v54
    v_fma_f32 v55, v57, v53, v55
    v_cvt_pk_bf16_f32 v28, v54, v55
    v_sub_f32 v48, v42, v51
    v_sub_f32 v49, v43, v51
    v_cvt_pk_bf16_f32 v48, v48, v49
    v_and_b32 v49, 0xffff0000, v48
    v_lshlrev_b32 v48, 16, v48
    v_mul_f32 v54, v48, v53
    v_mul_f32 v55, v49, v53
    v_fma_f32 v56, -v54, v52, v48
    v_fma_f32 v57, -v55, v52, v49
    v_fma_f32 v54, v56, v53, v54
    v_fma_f32 v55, v57, v53, v55
    v_cvt_pk_bf16_f32 v29, v54, v55
    v_sub_f32 v48, v44, v51
    v_sub_f32 v49, v45, v51
    v_cvt_pk_bf16_f32 v48, v48, v49
    v_and_b32 v49, 0xffff0000, v48
    v_lshlrev_b32 v48, 16, v48
    v_mul_f32 v54, v48, v53
    v_mul_f32 v55, v49, v53
    v_fma_f32 v56, -v54, v52, v48
    v_fma_f32 v57, -v55, v52, v49
    v_fma_f32 v54, v56, v53, v54
    v_fma_f32 v55, v57, v53, v55
    v_cvt_pk_bf16_f32 v30, v54, v55
    v_sub_f32 v48, v46, v51
    v_sub_f32 v49, v47, v51
    v_cvt_pk_bf16_f32 v48, v48, v49
    v_and_b32 v49, 0xffff0000, v48
    v_lshlrev_b32 v48, 16, v48
    v_mul_f32 v54, v48, v53
    v_mul_f32 v55, v49, v53
    v_fma_f32 v56, -v54, v52, v48
    v_fma_f32 v57, -v55, v52, v49
    v_fma_f32 v54, v56, v53, v54
    v_fma_f32 v55, v57, v53, v55
    v_cvt_pk_bf16_f32 v31, v54, v55
    buffer_store_dwordx4 v[24:27], v2, s[24:27], s23 offen
    buffer_store_dwordx4 v[28:31], v2, s[24:27], s23 offen offset:16
    s_waitcnt vmcnt(2)
    v_mov_b32 v52, 0
    v_mov_b32 v53, 0
    v_lshlrev_b32 v48, 16, v24
    v_and_b32 v49, 0xffff0000, v24
    v_lshlrev_b32 v50, 16, v16
    v_and_b32 v51, 0xffff0000, v16
    v_fmac_f32 v52, v48, v50
    v_fmac_f32 v53, v49, v51
    v_add_f32 v32, v32, v48
    v_add_f32 v33, v33, v49
    v_cvt_pk_bf16_f32 v8, v32, v33
    v_lshlrev_b32 v48, 16, v25
    v_and_b32 v49, 0xffff0000, v25
    v_lshlrev_b32 v50, 16, v17
    v_and_b32 v51, 0xffff0000, v17
    v_fmac_f32 v52, v48, v50
    v_fmac_f32 v53, v49, v51
    v_add_f32 v34, v34, v48
    v_add_f32 v35, v35, v49
    v_cvt_pk_bf16_f32 v9, v34, v35
    v_lshlrev_b32 v48, 16, v26
    v_and_b32 v49, 0xffff0000, v26
    v_lshlrev_b32 v50, 16, v18
    v_and_b32 v51, 0xffff0000, v18
    v_fmac_f32 v52, v48, v50
    v_fmac_f32 v53, v49, v51
    v_add_f32 v36, v36, v48
    v_add_f32 v37, v37, v49
    v_cvt_pk_bf16_f32 v10, v36, v37
    v_lshlrev_b32 v48, 16, v27
    v_and_b32 v49, 0xffff0000, v27
    v_lshlrev_b32 v50, 16, v19
    v_and_b32 v51, 0xffff0000, v19
    v_fmac_f32 v52, v48, v50
    v_fmac_f32 v53, v49, v51
    v_add_f32 v38, v38, v48
    v_add_f32 v39, v39, v49
    v_cvt_pk_bf16_f32 v11, v38, v39
    v_lshlrev_b32 v48, 16, v28
    v_and_b32 v49, 0xffff0000, v28
    v_lshlrev_b32 v50, 16, v20
    v_and_b32 v51, 0xffff0000, v20
    v_fmac_f32 v52, v48, v50
    v_fmac_f32 v53, v49, v51
    v_add_f32 v40, v40, v48
    v_add_f32 v41, v41, v49
    v_cvt_pk_bf16_f32 v12, v40, v41
    v_lshlrev_b32 v48, 16, v29
    v_and_b32 v49, 0xffff0000, v29
    v_lshlrev_b32 v50, 16, v21
    v_and_b32 v51, 0xffff0000, v21
    v_fmac_f32 v52, v48, v50
    v_fmac_f32 v53, v49, v51
    v_add_f32 v42, v42, v48
    v_add_f32 v43, v43, v49
    v_cvt_pk_bf16_f32 v13, v42, v43
    v_lshlrev_b32 v48, 16, v30
    v_and_b32 v49, 0xffff0000, v30
    v_lshlrev_b32 v50, 16, v22
    v_and_b32 v51, 0xffff0000, v22
    v_fmac_f32 v52, v48, v50
    v_fmac_f32 v53, v49, v51
    v_add_f32 v44, v44, v48
    v_add_f32 v45, v45, v49
    v_cvt_pk_bf16_f32 v14, v44, v45
    v_lshlrev_b32 v48, 16, v31
    v_and_b32 v49, 0xffff0000, v31
    v_lshlrev_b32 v50, 16, v23
    v_and_b32 v51, 0xffff0000, v23
    v_fmac_f32 v52, v48, v50
    v_fmac_f32 v53, v49, v51
    v_add_f32 v46, v46, v48
    v_add_f32 v47, v47, v49
    v_cvt_pk_bf16_f32 v15, v46, v47
    buffer_store_dwordx4 v[8:11], v2, s[32:35], s23 offen
    buffer_store_dwordx4 v[12:15], v2, s[32:35], s23 offen offset:16
    v_add_f32 v52, v52, v53
    s_nop 1
    v_add_f32_dpp v52, v52, v52 quad_perm:[1,0,3,2] row_mask:0xf bank_mask:0xf
    s_nop 1
    v_add_f32_dpp v52, v52, v52 quad_perm:[2,3,0,1] row_mask:0xf bank_mask:0xf
    s_nop 1
    v_add_f32_dpp v52, v52, v52 row_half_mirror row_mask:0xf bank_mask:0xf
    s_nop 1
    v_add_f32_dpp v52, v52, v52 row_mirror row_mask:0xf bank_mask:0xf
    s_nop 1
    v_readlane_b32 s40, v52, 0
    v_readlane_b32 s41, v52, 16
    v_readlane_b32 s42, v52, 32
    v_readlane_b32 s43, v52, 48
    s_nop 1
    v_mov_b32 v52, s40
    v_add_f32 v52, s41, v52
    v_add_f32 v52, s42, v52
    v_add_f32 v52, s43, v52
    v_cvt_pk_bf16_f32 v52, v52, v52
    v_and_b32 v48, 0xffff, v52
    v_xor_b32 v49, 0xffff, v48
    v_or_b32 v50, 0x8000, v48
    v_cmp_lt_u32 vcc, 0x7fff, v48
    s_sub_u32 s44, 0xffff, s22
    s_lshl_b32 s45, s22, 2
    v_cndmask_b32 v48, v50, v49, vcc
    v_lshl_or_b32 v48, v48, 16, s44
    v_mov_b32 v49, 0
    v_cmp_eq_u32 vcc, 0, v0
    s_and_saveexec_b64 s[46:47], vcc
    buffer_store_dword v48, v49, s[28:31], s45 offen
    s_mov_b64 exec, s[46:47]
ln2_1_kernel_exit1:
    s_endpgm
.section .rodata,"a"
.p2align 6
.amdhsa_kernel ln2_1_kernel
  .amdhsa_next_free_vgpr 64
  .amdhsa_next_free_sgpr 56
  .amdhsa_accum_offset 64
  .amdhsa_group_segment_fixed_size 0
  .amdhsa_kernarg_size 88
  .amdhsa_user_sgpr_count 2
  .amdhsa_user_sgpr_kernarg_segment_ptr 1
  .amdhsa_system_sgpr_workgroup_id_x 1
.end_amdhsa_kernel

.text
.globl fix1_kernel
.p2align 8
.type fix1_kernel,@function
fix1_kernel:
    s_cmp_ge_u32 s2, 8
    s_cbranch_scc1 fix1_kernel_exit1
    s_load_dwordx2 s[10:11], s[0:1], 80
    s_load_dwordx2 s[6:7], s[0:1], 64
    s_waitcnt lgkmcnt(0)
    s_add_u32 s12, s10, 0x2500000
    s_addc_u32 s13, s11, 0
    s_and_b32 s13, s13, 0xffff
    s_mov_b32 s14, 0x100000
    s_mov_b32 s15, 0x20000
    s_add_u32 s16, s10, 0x1c00000
    s_addc_u32 s17, s11, 0
    s_and_b32 s17, s17, 0xffff
    s_mov_b32 s18, 0x400000
    s_mov_b32 s19, 0x20000
    s_add_u32 s24, s10, 0x1400000
    s_addc_u32 s25, s11, 0
    s_and_b32 s25, s25, 0xffff
    s_mov_b32 s26, 0x400000
    s_mov_b32 s27, 0x20000
    s_mov_b32 s28, s6
    s_and_b32 s29, s7, 0xffff
    s_mov_b32 s30, 0x400000
    s_mov_b32 s31, 0x20000
    s_add_u32 s36, s10, 0x2214000
    s_addc_u32 s37, s11, 0
    s_lshl_b32 s21, s2, 2
    s_load_dword s22, s[36:37], s21
    v_lshlrev_b32 v1, 4, v0
    s_lshl_b32 s23, s2, 12
    buffer_load_dwordx4 v[16:19], v1, s[12:15], s23 offen
    s_add_u32 s23, s23, 32768
    buffer_load_dwordx4 v[20:23], v1, s[12:15], s23 offen
    s_add_u32 s23, s23, 32768
    buffer_load_dwordx4 v[24:27], v1, s[12:15], s23 offen
    s_add_u32 s23, s23, 32768
    buffer_load_dwordx4 v[28:31], v1, s[12:15], s23 offen
    s_add_u32 s23, s23, 32768
    buffer_load_dwordx4 v[32:35], v1, s[12:15], s23 offen
    s_add_u32 s23, s23, 32768
    buffer_load_dwordx4 v[36:39], v1, s[12:15], s23 offen
    s_add_u32 s23, s23, 32768
    buffer_load_dwordx4 v[40:43], v1, s[12:15], s23 offen
    s_add_u32 s23, s23, 32768
    buffer_load_dwordx4 v[44:47], v1, s[12:15], s23 offen
    s_add_u32 s23, s23, 32768
    buffer_load_dwordx4 v[48:51], v1, s[12:15], s23 offen
    s_add_u32 s23, s23, 32768
    buffer_load_dwordx4 v[52:55], v1, s[12:15], s23 offen
    s_add_u32 s23, s23, 32768
    buffer_load_dwordx4 v[56:59], v1, s[12:15], s23 offen
    s_add_u32 s23, s23, 32768
    buffer_load_dwordx4 v[60:63], v1, s[12:15], s23 offen
    s_add_u32 s23, s23, 32768
    buffer_load_dwordx4 v[64:67], v1, s[12:15], s23 offen
    s_add_u32 s23, s23, 32768
    buffer_load_dwordx4 v[68:71], v1, s[12:15], s23 offen
    s_add_u32 s23, s23, 32768
    buffer_load_dwordx4 v[72:75], v1, s[12:15], s23 offen
    s_add_u32 s23, s23, 32768
    buffer_load_dwordx4 v[76:79], v1, s[12:15], s23 offen
    s_add_u32 s23, s23, 32768
    buffer_load_dwordx4 v[80:83], v1, s[12:15], s23 offen
    s_add_u32 s23, s23, 32768
    buffer_load_dwordx4 v[84:87], v1, s[12:15], s23 offen
    s_add_u32 s23, s23, 32768
    buffer_load_dwordx4 v[88:91], v1, s[12:15], s23 offen
    s_add_u32 s23, s23, 32768
    buffer_load_dwordx4 v[92:95], v1, s[12:15], s23 offen
    s_add_u32 s23, s23, 32768
    buffer_load_dwordx4 v[96:99], v1, s[12:15], s23 offen
    s_add_u32 s23, s23, 32768
    buffer_load_dwordx4 v[100:103], v1, s[12:15], s23 offen
    s_add_u32 s23, s23, 32768
    buffer_load_dwordx4 v[104:107], v1, s[12:15], s23 offen
    s_add_u32 s23, s23, 32768
    buffer_load_dwordx4 v[108:111], v1, s[12:15], s23 offen
    s_add_u32 s23, s23, 32768
    buffer_load_dwordx4 v[112:115], v1, s[12:15], s23 offen
    s_add_u32 s23, s23, 32768
    buffer_load_dwordx4 v[116:119], v1, s[12:15], s23 offen
    s_add_u32 s23, s23, 32768
    buffer_load_dwordx4 v[120:123], v1, s[12:15], s23 offen
    s_add_u32 s23, s23, 32768
    buffer_load_dwordx4 v[124:127], v1, s[12:15], s23 offen
    s_add_u32 s23, s23, 32768
    s_waitcnt lgkmcnt(0)
    s_and_b32 s38, s22, 0xffff
    s_sub_u32 s38, 0xffff, s38
    s_lshl_b32 s39, s38, 11
    v_lshlrev_b32 v2, 3, v0
    buffer_load_dwordx2 v[4:5], v2, s[16:19], s39 offen
    buffer_load_dwordx2 v[6:7], v2, s[24:27], s39 offen
    s_lshr_b32 s40, s22, 16
    s_and_b32 s41, s40, 0x8000
    s_and_b32 s42, s40, 0x7fff
    s_xor_b32 s43, s40, 0xffff
    s_cmp_lg_u32 s41, 0
    s_cselect_b32 s40, s42, s43
    s_lshl_b32 s40, s40, 16
    v_mov_b32 v8, s40
    v_mul_f32 v9, 0x3fb8aa3b, v8
    v_exp_f32 v9, -v9
    s_nop 0
    v_add_f32 v9, 1.0, v9
    v_rcp_f32 v10, v9
    s_nop 0
    v_fma_f32 v11, -v10, v9, 1.0
    v_fma_f32 v10, v11, v10, v10
    v_cvt_pk_bf16_f32 v10, v10, v10
    v_lshlrev_b32 v10, 16, v10
    s_waitcnt vmcnt(0)
    v_add_f32 v16, v16, v20
    v_add_f32 v16, v16, v24
    v_add_f32 v16, v16, v28
    v_add_f32 v16, v16, v32
    v_add_f32 v16, v16, v36
    v_add_f32 v16, v16, v40
    v_add_f32 v16, v16, v44
    v_add_f32 v16, v16, v48
    v_add_f32 v16, v16, v52
    v_add_f32 v16, v16, v56
    v_add_f32 v16, v16, v60
    v_add_f32 v16, v16, v64
    v_add_f32 v16, v16, v68
    v_add_f32 v16, v16, v72
    v_add_f32 v16, v16, v76
    v_add_f32 v16, v16, v80
    v_add_f32 v16, v16, v84
    v_add_f32 v16, v16, v88
    v_add_f32 v16, v16, v92
    v_add_f32 v16, v16, v96
    v_add_f32 v16, v16, v100
    v_add_f32 v16, v16, v104
    v_add_f32 v16, v16, v108
    v_add_f32 v16, v16, v112
    v_add_f32 v16, v16, v116
    v_add_f32 v16, v16, v120
    v_add_f32 v16, v16, v124
    v_add_f32 v17, v17, v21
    v_add_f32 v17, v17, v25
    v_add_f32 v17, v17, v29
    v_add_f32 v17, v17, v33
    v_add_f32 v17, v17, v37
    v_add_f32 v17, v17, v41
    v_add_f32 v17, v17, v45
    v_add_f32 v17, v17, v49
    v_add_f32 v17, v17, v53
    v_add_f32 v17, v17, v57
    v_add_f32 v17, v17, v61
    v_add_f32 v17, v17, v65
    v_add_f32 v17, v17, v69
    v_add_f32 v17, v17, v73
    v_add_f32 v17, v17, v77
    v_add_f32 v17, v17, v81
    v_add_f32 v17, v17, v85
    v_add_f32 v17, v17, v89
    v_add_f32 v17, v17, v93
    v_add_f32 v17, v17, v97
    v_add_f32 v17, v17, v101
    v_add_f32 v17, v17, v105
    v_add_f32 v17, v17, v109
    v_add_f32 v17, v17, v113
    v_add_f32 v17, v17, v117
    v_add_f32 v17, v17, v121
    v_add_f32 v17, v17, v125
    v_add_f32 v18, v18, v22
    v_add_f32 v18, v18, v26
    v_add_f32 v18, v18, v30
    v_add_f32 v18, v18, v34
    v_add_f32 v18, v18, v38
    v_add_f32 v18, v18, v42
    v_add_f32 v18, v18, v46
    v_add_f32 v18, v18, v50
    v_add_f32 v18, v18, v54
    v_add_f32 v18, v18, v58
    v_add_f32 v18, v18, v62
    v_add_f32 v18, v18, v66
    v_add_f32 v18, v18, v70
    v_add_f32 v18, v18, v74
    v_add_f32 v18, v18, v78
    v_add_f32 v18, v18, v82
    v_add_f32 v18, v18, v86
    v_add_f32 v18, v18, v90
    v_add_f32 v18, v18, v94
    v_add_f32 v18, v18, v98
    v_add_f32 v18, v18, v102
    v_add_f32 v18, v18, v106
    v_add_f32 v18, v18, v110
    v_add_f32 v18, v18, v114
    v_add_f32 v18, v18, v118
    v_add_f32 v18, v18, v122
    v_add_f32 v18, v18, v126
    v_add_f32 v19, v19, v23
    v_add_f32 v19, v19, v27
    v_add_f32 v19, v19, v31
    v_add_f32 v19, v19, v35
    v_add_f32 v19, v19, v39
    v_add_f32 v19, v19, v43
    v_add_f32 v19, v19, v47
    v_add_f32 v19, v19, v51
    v_add_f32 v19, v19, v55
    v_add_f32 v19, v19, v59
    v_add_f32 v19, v19, v63
    v_add_f32 v19, v19, v67
    v_add_f32 v19, v19, v71
    v_add_f32 v19, v19, v75
    v_add_f32 v19, v19, v79
    v_add_f32 v19, v19, v83
    v_add_f32 v19, v19, v87
    v_add_f32 v19, v19, v91
    v_add_f32 v19, v19, v95
    v_add_f32 v19, v19, v99
    v_add_f32 v19, v19, v103
    v_add_f32 v19, v19, v107
    v_add_f32 v19, v19, v111
    v_add_f32 v19, v19, v115
    v_add_f32 v19, v19, v119
    v_add_f32 v19, v19, v123
    v_add_f32 v19, v19, v127
    v_cvt_pk_bf16_f32 v8, v16, v16
    v_lshlrev_b32 v8, 16, v8
    v_mul_f32 v8, v8, v10
    v_cvt_pk_bf16_f32 v8, v8, v8
    v_lshlrev_b32 v8, 16, v8
    v_lshlrev_b32 v9, 16, v4
    v_lshlrev_b32 v11, 16, v6
    v_add_f32 v8, v8, v9
    v_cvt_pk_bf16_f32 v8, v8, v8
    v_lshlrev_b32 v8, 16, v8
    v_add_f32 v8, v8, v11
    v_cvt_pk_bf16_f32 v8, v8, v8
    v_lshlrev_b32 v12, 16, v8
    v_cvt_pk_bf16_f32 v8, v17, v17
    v_lshlrev_b32 v8, 16, v8
    v_mul_f32 v8, v8, v10
    v_cvt_pk_bf16_f32 v8, v8, v8
    v_lshlrev_b32 v8, 16, v8
    v_and_b32 v9, 0xffff0000, v4
    v_and_b32 v11, 0xffff0000, v6
    v_add_f32 v8, v8, v9
    v_cvt_pk_bf16_f32 v8, v8, v8
    v_lshlrev_b32 v8, 16, v8
    v_add_f32 v8, v8, v11
    v_cvt_pk_bf16_f32 v8, v8, v8
    v_lshlrev_b32 v13, 16, v8
    v_cvt_pk_bf16_f32 v8, v18, v18
    v_lshlrev_b32 v8, 16, v8
    v_mul_f32 v8, v8, v10
    v_cvt_pk_bf16_f32 v8, v8, v8
    v_lshlrev_b32 v8, 16, v8
    v_lshlrev_b32 v9, 16, v5
    v_lshlrev_b32 v11, 16, v7
    v_add_f32 v8, v8, v9
    v_cvt_pk_bf16_f32 v8, v8, v8
    v_lshlrev_b32 v8, 16, v8
    v_add_f32 v8, v8, v11
    v_cvt_pk_bf16_f32 v8, v8, v8
    v_lshlrev_b32 v14, 16, v8
    v_cvt_pk_bf16_f32 v8, v19, v19
    v_lshlrev_b32 v8, 16, v8
    v_mul_f32 v8, v8, v10
    v_cvt_pk_bf16_f32 v8, v8, v8
    v_lshlrev_b32 v8, 16, v8
    v_and_b32 v9, 0xffff0000, v5
    v_and_b32 v11, 0xffff0000, v7
    v_add_f32 v8, v8, v9
    v_cvt_pk_bf16_f32 v8, v8, v8
    v_lshlrev_b32 v8, 16, v8
    v_add_f32 v8, v8, v11
    v_cvt_pk_bf16_f32 v8, v8, v8
    v_lshlrev_b32 v15, 16, v8
    v_lshrrev_b32 v8, 16, v12
    v_or_b32 v4, v13, v8
    v_lshrrev_b32 v8, 16, v14
    v_or_b32 v5, v15, v8
    buffer_store_dwordx2 v[4:5], v2, s[28:31], s39 offen
fix1_kernel_exit1:
    s_endpgm
.section .rodata,"a"
.p2align 6
.amdhsa_kernel fix1_kernel
  .amdhsa_next_free_vgpr 136
  .amdhsa_next_free_sgpr 56
  .amdhsa_accum_offset 136
  .amdhsa_group_segment_fixed_size 0
  .amdhsa_kernarg_size 88
  .amdhsa_user_sgpr_count 2
  .amdhsa_user_sgpr_kernarg_segment_ptr 1
  .amdhsa_system_sgpr_workgroup_id_x 1
.end_amdhsa_kernel
```
